```python
import torch

def _softmax(x, axis=-1):
    return torch.softmax(x, dim=axis)
def _gelu(x):
    return torch.nn.functional.gelu(x, approximate="tanh")
def _silu(x):
    return torch.nn.functional.silu(x)
def _sigmoid(x):
    return torch.sigmoid(x)
def _layernorm(x, axis=-1, eps=1e-5):
    m = x.mean(dim=axis, keepdim=True)
    v = x.var(dim=axis, keepdim=True, unbiased=False)
    return (x - m) / torch.sqrt(v + eps)
def _scatter_add(tgt, idx, src, axis=0):
    return tgt.clone().index_add_(axis, idx, src)
def _segment_sum(src, seg, n):
    out = torch.zeros((n,) + src.shape[1:], dtype=src.dtype)
    return out.index_add_(0, seg, src)
def _pad(x, pw):
    flat = tuple(v for pair in reversed(pw) for v in pair)
    return torch.nn.functional.pad(x, flat)

kernel_name = 'concat_heads__sliding_block_cached__mha_block_cached__decode'

def setup_inputs():

    _w = (lambda a: (lambda t: t.to(torch.bfloat16) if t.is_floating_point() else t)(torch.as_tensor(a)))
    def _A_setup():
        B, Sq, D = 8, 1, 640
        Hq, Hkv, Sk, Dh = 32, 32, 4096, 128
        assert Hq % Hkv == 0, (Hq, Hkv)
        return {
            "x": _w((lambda *s: torch.randn(*s, dtype=torch.bfloat16) * 0.8)(B, Sq, D)),
            "k_cache": _w((lambda *s: torch.randn(*s, dtype=torch.bfloat16) * 1.6)(B, Hkv, Sk, Dh)),
            "v_cache": _w((lambda *s: torch.randn(*s, dtype=torch.bfloat16) * 0.2)(B, Hkv, Sk, Dh)),
            "wq": _w((lambda *s: torch.randn(*s, dtype=torch.bfloat16) * 1.6)(D, Hq * Dh) * (D ** -0.5)),
            "wo": _w((lambda *s: torch.randn(*s, dtype=torch.bfloat16) * 0.2)(Hq * Dh, D) * ((Hq * Dh) ** -0.5)),
        }
    _A_in = _A_setup()

    def _B_setup():
        B, Sq, D = 8, 1, 640
        H, Sk, Dh = 32, 4096, 128
        return {
            "x": _w((lambda *s: torch.randn(*s, dtype=torch.bfloat16) * 0.8)(B, Sq, D)),
            "k_cache": _w((lambda *s: torch.randn(*s, dtype=torch.bfloat16) * 1.6)(B, H, Sk, Dh)),
            "v_cache": _w((lambda *s: torch.randn(*s, dtype=torch.bfloat16) * 0.2)(B, H, Sk, Dh)),
            "wq": _w((lambda *s: torch.randn(*s, dtype=torch.bfloat16) * 1.6)(D, H * Dh) * (D ** -0.5)),
            "wo": _w((lambda *s: torch.randn(*s, dtype=torch.bfloat16) * 0.2)(H * Dh, D) * ((H * Dh) ** -0.5)),
        }
    _B_in = _B_setup()

    return {
        "A_x": _A_in["x"],
        "A_k_cache": _A_in["k_cache"],
        "A_v_cache": _A_in["v_cache"],
        "A_wq": _A_in["wq"],
        "A_wo": _A_in["wo"],
        "B_x": _B_in["x"],
        "B_k_cache": _B_in["k_cache"],
        "B_v_cache": _B_in["v_cache"],
        "B_wq": _B_in["wq"],
        "B_wo": _B_in["wo"],
    }

def reference(A_x, A_k_cache, A_v_cache, A_wq, A_wo, B_x, B_k_cache, B_v_cache, B_wq, B_wo):
    def _A_ref(x, k_cache, v_cache, wq, wo):
        B, Sq, D = x.shape
        Hq, Dh = 32, 128
        Hkv, Sk = k_cache.shape[1], k_cache.shape[2]
        W = min(4096, max(256, Sk // 4))
        rep = Hq // Hkv
        q = (lambda x, *d: x.permute(*d))((x @ wq).reshape(B, Sq, Hq, Dh), 0, 2, 1, 3)
        k = (lambda x, n, axis: torch.repeat_interleave(x, n, dim=axis))(k_cache[:, :, Sk - W:, :], rep, axis=1)
        v = (lambda x, n, axis: torch.repeat_interleave(x, n, dim=axis))(v_cache[:, :, Sk - W:, :], rep, axis=1)
        scores = torch.einsum("bhqd,bhkd->bhqk", q, k) * (Dh ** -0.5)
        p = _softmax(scores, axis=-1)
        o = torch.einsum("bhqk,bhkd->bhqd", p, v)
        return (lambda x, *d: x.permute(*d))(o, 0, 2, 1, 3).reshape(B, Sq, Hq * Dh) @ wo

    def _B_ref(x, k_cache, v_cache, wq, wo):
        B, Sq, D = x.shape
        H, Dh = 32, 128
        q = (lambda x, *d: x.permute(*d))((x @ wq).reshape(B, Sq, H, Dh), 0, 2, 1, 3)
        scores = torch.einsum("bhqd,bhkd->bhqk", q, k_cache) * (Dh ** -0.5)
        p = _softmax(scores, axis=-1)
        o = torch.einsum("bhqk,bhkd->bhqd", p, v_cache)
        return (lambda x, *d: x.permute(*d))(o, 0, 2, 1, 3).reshape(B, Sq, H * Dh) @ wo

    a = _A_ref(A_x, A_k_cache, A_v_cache, A_wq, A_wo)
    b = _B_ref(B_x, B_k_cache, B_v_cache, B_wq, B_wo)
    return torch.concatenate([a, b], axis=-1)
```

```asm
; @launch kernel=concat_heads__sliding_block_cached__mha_block_cached__decode_kernel grid=(256,1,1) block=(256,1,1) lds=98304
; @launch kernel=reduce_kernel grid=(160,1,1) block=(64,1,1) lds=0
.amdgcn_target "amdgcn-amd-amdhsa--gfx950"
.text
.globl concat_heads__sliding_block_cached__mha_block_cached__decode_kernel
.p2align 8
.type concat_heads__sliding_block_cached__mha_block_cached__decode_kernel,@function
concat_heads__sliding_block_cached__mha_block_cached__decode_kernel:
    s_cmp_ge_u32 s2, 256
    s_cbranch_scc1 L_end
    s_load_dwordx16 s[64:79], s[0:1], 0
    s_load_dwordx8 s[80:87], s[0:1], 64
    s_load_dwordx2 s[88:89], s[0:1], 96
    v_lshrrev_b32 v1, 6, v0
    v_and_b32 v7, 63, v0
    v_readfirstlane_b32 s38, v1
    v_lshlrev_b32 v2, 4, v7
    v_add_u32 v3, 4096, v2
    v_lshrrev_b32 v104, 4, v7
    v_and_b32 v105, 15, v7
    v_lshlrev_b32 v30, 4, v105
    v_lshl_add_u32 v5, v104, 13, v30
    v_mul_u32_u24 v6, 1280, v104
    v_add_u32 v6, v6, v30
    s_lshr_b32 s39, s2, 5
    s_and_b32 s40, s2, 31
    s_lshl_b32 s60, s2, 20
    s_lshr_b32 s61, s2, 12
    s_mov_b32 s45, 0x3db504f3
    s_mov_b32 s46, 0x3fb8aa3b
    s_mov_b32 s47, 0xffff0000
    v_lshl_add_u32 v50, v105, 2, v104
    v_lshlrev_b32 v50, 1, v50
    s_mul_i32 s3, s39, 1280
    s_mul_i32 s4, s38, 320
    s_add_u32 s3, s3, s4
    s_lshl_b32 s5, s40, 8
    s_mul_i32 s63, s40, 163840
    s_mul_i32 s34, s38, 1310720
    s_lshl_b32 s41, s38, 13
    s_mov_b32 s32, s41
    s_waitcnt lgkmcnt(0)
    s_add_u32 s24, s70, s5
    s_addc_u32 s25, s71, 0
    s_mov_b32 s26, 0
    s_mov_b32 s27, 0x20000
    s_sub_u32 s26, 5242880, s5
    s_mov_b32 s28, s64
    s_mov_b32 s29, s65
    s_mov_b32 s30, 10240
    s_mov_b32 s31, 0x20000
    buffer_load_ushort v44, v50, s[28:31], s3 offen offset:0
    buffer_load_ushort v45, v50, s[28:31], s3 offen offset:128
    buffer_load_ushort v46, v50, s[28:31], s3 offen offset:256
    buffer_load_dwordx4 a[0:3], v5, s[24:27], s34 offen
    s_add_u32 s34, s34, 32768
    s_add_u32 s8, s66, s60
    s_addc_u32 s9, s67, s61
    s_add_u32 s8, s8, 786432
    s_addc_u32 s9, s9, 0
    s_mov_b32 s10, 262144
    s_mov_b32 s11, 0x20000
    buffer_load_dwordx4 v[128:131], v2, s[8:11], s32 offen offset:0 nt
    buffer_load_dwordx4 a[4:7], v5, s[24:27], s34 offen
    s_add_u32 s34, s34, 32768
    buffer_load_dwordx4 v[132:135], v2, s[8:11], s32 offen offset:1024 nt
    buffer_load_dwordx4 a[8:11], v5, s[24:27], s34 offen
    s_add_u32 s34, s34, 32768
    buffer_load_dwordx4 v[136:139], v2, s[8:11], s32 offen offset:2048 nt
    buffer_load_dwordx4 v[140:143], v2, s[8:11], s32 offen offset:3072 nt
    buffer_load_dwordx4 a[12:15], v5, s[24:27], s34 offen
    s_add_u32 s34, s34, 32768
    buffer_load_dwordx4 v[144:147], v3, s[8:11], s32 offen offset:0 nt
    buffer_load_dwordx4 a[16:19], v5, s[24:27], s34 offen
    s_add_u32 s34, s34, 32768
    buffer_load_dwordx4 v[148:151], v3, s[8:11], s32 offen offset:1024 nt
    buffer_load_dwordx4 v[152:155], v3, s[8:11], s32 offen offset:2048 nt
    buffer_load_dwordx4 a[20:23], v5, s[24:27], s34 offen
    s_add_u32 s34, s34, 32768
    buffer_load_dwordx4 v[156:159], v3, s[8:11], s32 offen offset:3072 nt
    s_add_u32 s32, s32, 32768
    buffer_load_dwordx4 a[24:27], v5, s[24:27], s34 offen
    s_add_u32 s34, s34, 32768
    buffer_load_dwordx4 v[160:163], v2, s[8:11], s32 offen offset:0 nt
    buffer_load_dwordx4 a[28:31], v5, s[24:27], s34 offen
    s_add_u32 s34, s34, 32768
    buffer_load_dwordx4 v[164:167], v2, s[8:11], s32 offen offset:1024 nt
    buffer_load_dwordx4 v[168:171], v2, s[8:11], s32 offen offset:2048 nt
    buffer_load_dwordx4 a[32:35], v5, s[24:27], s34 offen
    s_add_u32 s34, s34, 32768
    buffer_load_dwordx4 v[172:175], v2, s[8:11], s32 offen offset:3072 nt
    buffer_load_dwordx4 a[36:39], v5, s[24:27], s34 offen
    s_add_u32 s34, s34, 32768
    buffer_load_dwordx4 v[176:179], v3, s[8:11], s32 offen offset:0 nt
    buffer_load_dwordx4 v[180:183], v3, s[8:11], s32 offen offset:1024 nt
    buffer_load_dwordx4 a[40:43], v5, s[24:27], s34 offen
    s_add_u32 s34, s34, 32768
    buffer_load_dwordx4 v[184:187], v3, s[8:11], s32 offen offset:2048 nt
    buffer_load_dwordx4 a[44:47], v5, s[24:27], s34 offen
    s_add_u32 s34, s34, 32768
    buffer_load_dwordx4 v[188:191], v3, s[8:11], s32 offen offset:3072 nt
    s_add_u32 s32, s32, 32768
    buffer_load_dwordx4 a[48:51], v5, s[24:27], s34 offen
    s_add_u32 s34, s34, 32768
    buffer_load_dwordx4 v[192:195], v2, s[8:11], s32 offen offset:0 nt
    buffer_load_dwordx4 v[196:199], v2, s[8:11], s32 offen offset:1024 nt
    buffer_load_dwordx4 a[52:55], v5, s[24:27], s34 offen
    s_add_u32 s34, s34, 32768
    buffer_load_dwordx4 v[200:203], v2, s[8:11], s32 offen offset:2048 nt
    buffer_load_dwordx4 a[56:59], v5, s[24:27], s34 offen
    s_add_u32 s34, s34, 32768
    buffer_load_dwordx4 v[204:207], v2, s[8:11], s32 offen offset:3072 nt
    buffer_load_dwordx4 v[208:211], v3, s[8:11], s32 offen offset:0 nt
    buffer_load_dwordx4 a[60:63], v5, s[24:27], s34 offen
    s_add_u32 s34, s34, 32768
    buffer_load_dwordx4 v[212:215], v3, s[8:11], s32 offen offset:1024 nt
    s_add_u32 s12, s68, s60
    s_addc_u32 s13, s69, s61
    s_add_u32 s12, s12, 786432
    s_addc_u32 s13, s13, 0
    s_mov_b32 s14, 262144
    s_mov_b32 s15, 0x20000
    s_add_u32 s16, s76, s60
    s_addc_u32 s17, s77, s61
    s_mov_b32 s18, 1048576
    s_mov_b32 s19, 0x20000
    s_add_u32 s20, s78, s60
    s_addc_u32 s21, s79, s61
    s_mov_b32 s22, 1048576
    s_mov_b32 s23, 0x20000
    s_mov_b32 s28, s74
    s_mov_b32 s29, s75
    s_mov_b32 s30, 10240
    s_mov_b32 s31, 0x20000
    s_mov_b32 s48, s88
    s_mov_b32 s49, s89
    s_mov_b32 s50, 1310720
    s_mov_b32 s51, 0x20000
    v_and_b32 v30, 1, v105
    v_cmp_eq_u32 vcc, 1, v30
    v_mov_b32 v30, 0xffff
    v_mov_b32 v31, s47
    v_cndmask_b32 v30, v30, v31, vcc
    v_lshrrev_b32 v31, 1, v105
    v_cmp_eq_u32 vcc, 0, v31
    s_nop 1
    v_cndmask_b32 v8, 0, v30, vcc
    v_cmp_eq_u32 vcc, 1, v31
    s_nop 1
    v_cndmask_b32 v9, 0, v30, vcc
    v_cmp_eq_u32 vcc, 2, v31
    s_nop 1
    v_cndmask_b32 v10, 0, v30, vcc
    v_cmp_eq_u32 vcc, 3, v31
    s_nop 1
    v_cndmask_b32 v11, 0, v30, vcc
    v_lshlrev_b32 v51, 5, v105
    v_lshl_add_u32 v51, v104, 4, v51
    s_mul_i32 s4, s38, 2560
    v_add_u32 v108, s4, v51
    s_lshl_b32 s4, s38, 9
    v_add_u32 v51, s4, v51
    v_lshlrev_b32 v106, 5, v105
    v_and_b32 v107, 7, v105
    v_lshl_add_u32 v107, v107, 2, v104
    s_lshl_b32 s4, s38, 5
    v_add_u32 v107, s4, v107
    v_lshlrev_b32 v107, 2, v107
    s_lshl_b32 s4, s38, 3
    v_mov_b32 v4, s4
    v_mov_b32 v16, 0
    v_mov_b32 v17, 0
    v_mov_b32 v18, 0
    v_mov_b32 v19, 0
    v_mov_b32 v28, 0xff7fffff
    v_mov_b32 v29, 0
    s_lshl_b32 s4, s38, 14
    s_add_u32 s4, s4, 32768
    v_lshl_add_u32 v116, v7, 3, s4
    v_mov_b32 v117, v116
    s_waitcnt vmcnt(38)
    v_lshl_or_b32 v44, v44, 16, v44
    v_lshl_or_b32 v45, v45, 16, v45
    v_lshl_or_b32 v46, v46, 16, v46
    v_mov_b32 v52, 0
    v_mov_b32 v53, 0
    v_mov_b32 v54, 0
    v_mov_b32 v55, 0
    buffer_load_dwordx4 a[64:67], v5, s[24:27], s34 offen
    s_add_u32 s34, s34, 32768
    buffer_load_dwordx4 v[216:219], v3, s[8:11], s32 offen offset:2048 nt
    v_and_b32_dpp v36, v44, v8 row_newbcast:0 row_mask:0xf bank_mask:0xf
    v_and_b32_dpp v37, v44, v9 row_newbcast:0 row_mask:0xf bank_mask:0xf
    v_and_b32_dpp v38, v44, v10 row_newbcast:0 row_mask:0xf bank_mask:0xf
    v_and_b32_dpp v39, v44, v11 row_newbcast:0 row_mask:0xf bank_mask:0xf
    s_waitcnt vmcnt(39)
    s_nop 0
    v_mfma_f32_16x16x32_bf16 v[52:55], v[36:39], a[0:3], v[52:55]
    buffer_load_dwordx4 a[68:71], v5, s[24:27], s34 offen
    s_add_u32 s34, s34, 32768
    buffer_load_dwordx4 v[220:223], v3, s[8:11], s32 offen offset:3072 nt
    s_add_u32 s32, s32, 32768
    buffer_load_dwordx4 v[224:227], v2, s[8:11], s32 offen offset:0 nt
    v_and_b32_dpp v40, v44, v8 row_newbcast:1 row_mask:0xf bank_mask:0xf
    v_and_b32_dpp v41, v44, v9 row_newbcast:1 row_mask:0xf bank_mask:0xf
    v_and_b32_dpp v42, v44, v10 row_newbcast:1 row_mask:0xf bank_mask:0xf
    v_and_b32_dpp v43, v44, v11 row_newbcast:1 row_mask:0xf bank_mask:0xf
    s_waitcnt vmcnt(40)
    s_nop 0
    v_mfma_f32_16x16x32_bf16 v[52:55], v[40:43], a[4:7], v[52:55]
    buffer_load_dwordx4 a[72:75], v5, s[24:27], s34 offen
    s_add_u32 s34, s34, 32768
    buffer_load_dwordx4 v[228:231], v2, s[8:11], s32 offen offset:1024 nt
    v_and_b32_dpp v36, v44, v8 row_newbcast:2 row_mask:0xf bank_mask:0xf
    v_and_b32_dpp v37, v44, v9 row_newbcast:2 row_mask:0xf bank_mask:0xf
    v_and_b32_dpp v38, v44, v10 row_newbcast:2 row_mask:0xf bank_mask:0xf
    v_and_b32_dpp v39, v44, v11 row_newbcast:2 row_mask:0xf bank_mask:0xf
    s_waitcnt vmcnt(40)
    s_nop 0
    v_mfma_f32_16x16x32_bf16 v[52:55], v[36:39], a[8:11], v[52:55]
    buffer_load_dwordx4 a[76:79], v5, s[24:27], s34 offen
    s_add_u32 s34, s34, 32768
    buffer_load_dwordx4 v[232:235], v2, s[8:11], s32 offen offset:2048 nt
    buffer_load_dwordx4 v[236:239], v2, s[8:11], s32 offen offset:3072 nt
    v_and_b32_dpp v40, v44, v8 row_newbcast:3 row_mask:0xf bank_mask:0xf
    v_and_b32_dpp v41, v44, v9 row_newbcast:3 row_mask:0xf bank_mask:0xf
    v_and_b32_dpp v42, v44, v10 row_newbcast:3 row_mask:0xf bank_mask:0xf
    v_and_b32_dpp v43, v44, v11 row_newbcast:3 row_mask:0xf bank_mask:0xf
    s_waitcnt vmcnt(40)
    s_nop 0
    v_mfma_f32_16x16x32_bf16 v[52:55], v[40:43], a[12:15], v[52:55]
    buffer_load_dwordx4 a[80:83], v5, s[24:27], s34 offen
    s_add_u32 s34, s34, 32768
    buffer_load_dwordx4 v[240:243], v3, s[8:11], s32 offen offset:0 nt
    v_and_b32_dpp v36, v44, v8 row_newbcast:4 row_mask:0xf bank_mask:0xf
    v_and_b32_dpp v37, v44, v9 row_newbcast:4 row_mask:0xf bank_mask:0xf
    v_and_b32_dpp v38, v44, v10 row_newbcast:4 row_mask:0xf bank_mask:0xf
    v_and_b32_dpp v39, v44, v11 row_newbcast:4 row_mask:0xf bank_mask:0xf
    s_waitcnt vmcnt(40)
    s_nop 0
    v_mfma_f32_16x16x32_bf16 v[52:55], v[36:39], a[16:19], v[52:55]
    buffer_load_dwordx4 a[84:87], v5, s[24:27], s34 offen
    s_add_u32 s34, s34, 32768
    buffer_load_dwordx4 v[244:247], v3, s[8:11], s32 offen offset:1024 nt
    v_and_b32_dpp v40, v44, v8 row_newbcast:5 row_mask:0xf bank_mask:0xf
    v_and_b32_dpp v41, v44, v9 row_newbcast:5 row_mask:0xf bank_mask:0xf
    v_and_b32_dpp v42, v44, v10 row_newbcast:5 row_mask:0xf bank_mask:0xf
    v_and_b32_dpp v43, v44, v11 row_newbcast:5 row_mask:0xf bank_mask:0xf
    s_waitcnt vmcnt(39)
    s_nop 0
    v_mfma_f32_16x16x32_bf16 v[52:55], v[40:43], a[20:23], v[52:55]
    buffer_load_dwordx4 a[88:91], v5, s[24:27], s34 offen
    s_add_u32 s34, s34, 32768
    buffer_load_dwordx4 v[248:251], v3, s[8:11], s32 offen offset:2048 nt
    buffer_load_dwordx4 v[252:255], v3, s[8:11], s32 offen offset:3072 nt
    s_add_u32 s32, s32, 32768
    v_and_b32_dpp v36, v44, v8 row_newbcast:6 row_mask:0xf bank_mask:0xf
    v_and_b32_dpp v37, v44, v9 row_newbcast:6 row_mask:0xf bank_mask:0xf
    v_and_b32_dpp v38, v44, v10 row_newbcast:6 row_mask:0xf bank_mask:0xf
    v_and_b32_dpp v39, v44, v11 row_newbcast:6 row_mask:0xf bank_mask:0xf
    s_waitcnt vmcnt(40)
    s_nop 0
    v_mfma_f32_16x16x32_bf16 v[52:55], v[36:39], a[24:27], v[52:55]
    buffer_load_dwordx4 a[92:95], v5, s[24:27], s34 offen
    s_add_u32 s34, s34, 32768
    buffer_load_dwordx4 a[160:163], v2, s[8:11], s32 offen offset:0 nt
    v_and_b32_dpp v40, v44, v8 row_newbcast:7 row_mask:0xf bank_mask:0xf
    v_and_b32_dpp v41, v44, v9 row_newbcast:7 row_mask:0xf bank_mask:0xf
    v_and_b32_dpp v42, v44, v10 row_newbcast:7 row_mask:0xf bank_mask:0xf
    v_and_b32_dpp v43, v44, v11 row_newbcast:7 row_mask:0xf bank_mask:0xf
    s_waitcnt vmcnt(40)
    s_nop 0
    v_mfma_f32_16x16x32_bf16 v[52:55], v[40:43], a[28:31], v[52:55]
    buffer_load_dwordx4 a[96:99], v5, s[24:27], s34 offen
    s_add_u32 s34, s34, 32768
    buffer_load_dwordx4 a[164:167], v2, s[8:11], s32 offen offset:1024 nt
    buffer_load_dwordx4 a[168:171], v2, s[8:11], s32 offen offset:2048 nt
    v_and_b32_dpp v36, v44, v8 row_newbcast:8 row_mask:0xf bank_mask:0xf
    v_and_b32_dpp v37, v44, v9 row_newbcast:8 row_mask:0xf bank_mask:0xf
    v_and_b32_dpp v38, v44, v10 row_newbcast:8 row_mask:0xf bank_mask:0xf
    v_and_b32_dpp v39, v44, v11 row_newbcast:8 row_mask:0xf bank_mask:0xf
    s_waitcnt vmcnt(40)
    s_nop 0
    v_mfma_f32_16x16x32_bf16 v[52:55], v[36:39], a[32:35], v[52:55]
    buffer_load_dwordx4 a[100:103], v5, s[24:27], s34 offen
    s_add_u32 s34, s34, 32768
    buffer_load_dwordx4 a[172:175], v2, s[8:11], s32 offen offset:3072 nt
    v_and_b32_dpp v40, v44, v8 row_newbcast:9 row_mask:0xf bank_mask:0xf
    v_and_b32_dpp v41, v44, v9 row_newbcast:9 row_mask:0xf bank_mask:0xf
    v_and_b32_dpp v42, v44, v10 row_newbcast:9 row_mask:0xf bank_mask:0xf
    v_and_b32_dpp v43, v44, v11 row_newbcast:9 row_mask:0xf bank_mask:0xf
    s_waitcnt vmcnt(40)
    s_nop 0
    v_mfma_f32_16x16x32_bf16 v[52:55], v[40:43], a[36:39], v[52:55]
    buffer_load_dwordx4 a[104:107], v5, s[24:27], s34 offen
    s_add_u32 s34, s34, 32768
    buffer_load_dwordx4 a[176:179], v3, s[8:11], s32 offen offset:0 nt
    v_and_b32_dpp v36, v44, v8 row_newbcast:10 row_mask:0xf bank_mask:0xf
    v_and_b32_dpp v37, v44, v9 row_newbcast:10 row_mask:0xf bank_mask:0xf
    v_and_b32_dpp v38, v44, v10 row_newbcast:10 row_mask:0xf bank_mask:0xf
    v_and_b32_dpp v39, v44, v11 row_newbcast:10 row_mask:0xf bank_mask:0xf
    s_waitcnt vmcnt(39)
    s_nop 0
    v_mfma_f32_16x16x32_bf16 v[52:55], v[36:39], a[40:43], v[52:55]
    buffer_load_dwordx4 a[108:111], v5, s[24:27], s34 offen
    s_add_u32 s34, s34, 32768
    buffer_load_dwordx4 a[180:183], v3, s[8:11], s32 offen offset:1024 nt
    buffer_load_dwordx4 a[184:187], v3, s[8:11], s32 offen offset:2048 nt
    v_and_b32_dpp v40, v44, v8 row_newbcast:11 row_mask:0xf bank_mask:0xf
    v_and_b32_dpp v41, v44, v9 row_newbcast:11 row_mask:0xf bank_mask:0xf
    v_and_b32_dpp v42, v44, v10 row_newbcast:11 row_mask:0xf bank_mask:0xf
    v_and_b32_dpp v43, v44, v11 row_newbcast:11 row_mask:0xf bank_mask:0xf
    s_waitcnt vmcnt(40)
    s_nop 0
    v_mfma_f32_16x16x32_bf16 v[52:55], v[40:43], a[44:47], v[52:55]
    buffer_load_dwordx4 a[112:115], v5, s[24:27], s34 offen
    s_add_u32 s34, s34, 32768
    buffer_load_dwordx4 a[188:191], v3, s[8:11], s32 offen offset:3072 nt
    s_add_u32 s32, s32, 32768
    v_and_b32_dpp v36, v44, v8 row_newbcast:12 row_mask:0xf bank_mask:0xf
    v_and_b32_dpp v37, v44, v9 row_newbcast:12 row_mask:0xf bank_mask:0xf
    v_and_b32_dpp v38, v44, v10 row_newbcast:12 row_mask:0xf bank_mask:0xf
    v_and_b32_dpp v39, v44, v11 row_newbcast:12 row_mask:0xf bank_mask:0xf
    s_waitcnt vmcnt(40)
    s_nop 0
    v_mfma_f32_16x16x32_bf16 v[52:55], v[36:39], a[48:51], v[52:55]
    buffer_load_dwordx4 a[116:119], v5, s[24:27], s34 offen
    s_add_u32 s34, s34, 32768
    buffer_load_dwordx4 a[192:195], v2, s[8:11], s32 offen offset:0 nt
    buffer_load_dwordx4 a[196:199], v2, s[8:11], s32 offen offset:1024 nt
    v_and_b32_dpp v40, v44, v8 row_newbcast:13 row_mask:0xf bank_mask:0xf
    v_and_b32_dpp v41, v44, v9 row_newbcast:13 row_mask:0xf bank_mask:0xf
    v_and_b32_dpp v42, v44, v10 row_newbcast:13 row_mask:0xf bank_mask:0xf
    v_and_b32_dpp v43, v44, v11 row_newbcast:13 row_mask:0xf bank_mask:0xf
    s_waitcnt vmcnt(40)
    s_nop 0
    v_mfma_f32_16x16x32_bf16 v[52:55], v[40:43], a[52:55], v[52:55]
    buffer_load_dwordx4 a[120:123], v5, s[24:27], s34 offen
    s_add_u32 s34, s34, 32768
    buffer_load_dwordx4 a[200:203], v2, s[8:11], s32 offen offset:2048 nt
    v_and_b32_dpp v36, v44, v8 row_newbcast:14 row_mask:0xf bank_mask:0xf
    v_and_b32_dpp v37, v44, v9 row_newbcast:14 row_mask:0xf bank_mask:0xf
    v_and_b32_dpp v38, v44, v10 row_newbcast:14 row_mask:0xf bank_mask:0xf
    v_and_b32_dpp v39, v44, v11 row_newbcast:14 row_mask:0xf bank_mask:0xf
    s_waitcnt vmcnt(40)
    s_nop 0
    v_mfma_f32_16x16x32_bf16 v[52:55], v[36:39], a[56:59], v[52:55]
    buffer_load_dwordx4 a[124:127], v5, s[24:27], s34 offen
    s_add_u32 s34, s34, 32768
    buffer_load_dwordx4 a[204:207], v2, s[8:11], s32 offen offset:3072 nt
    v_and_b32_dpp v40, v44, v8 row_newbcast:15 row_mask:0xf bank_mask:0xf
    v_and_b32_dpp v41, v44, v9 row_newbcast:15 row_mask:0xf bank_mask:0xf
    v_and_b32_dpp v42, v44, v10 row_newbcast:15 row_mask:0xf bank_mask:0xf
    v_and_b32_dpp v43, v44, v11 row_newbcast:15 row_mask:0xf bank_mask:0xf
    s_waitcnt vmcnt(39)
    s_nop 0
    v_mfma_f32_16x16x32_bf16 v[52:55], v[40:43], a[60:63], v[52:55]
    buffer_load_dwordx4 a[128:131], v5, s[24:27], s34 offen
    s_add_u32 s34, s34, 32768
    buffer_load_dwordx4 a[208:211], v3, s[8:11], s32 offen offset:0 nt
    buffer_load_dwordx4 a[212:215], v3, s[8:11], s32 offen offset:1024 nt
    v_and_b32_dpp v36, v45, v8 row_newbcast:0 row_mask:0xf bank_mask:0xf
    v_and_b32_dpp v37, v45, v9 row_newbcast:0 row_mask:0xf bank_mask:0xf
    v_and_b32_dpp v38, v45, v10 row_newbcast:0 row_mask:0xf bank_mask:0xf
    v_and_b32_dpp v39, v45, v11 row_newbcast:0 row_mask:0xf bank_mask:0xf
    s_waitcnt vmcnt(40)
    s_nop 0
    v_mfma_f32_16x16x32_bf16 v[52:55], v[36:39], a[64:67], v[52:55]
    buffer_load_dwordx4 a[132:135], v5, s[24:27], s34 offen
    s_add_u32 s34, s34, 32768
    buffer_load_dwordx4 a[216:219], v3, s[8:11], s32 offen offset:2048 nt
    v_and_b32_dpp v40, v45, v8 row_newbcast:1 row_mask:0xf bank_mask:0xf
    v_and_b32_dpp v41, v45, v9 row_newbcast:1 row_mask:0xf bank_mask:0xf
    v_and_b32_dpp v42, v45, v10 row_newbcast:1 row_mask:0xf bank_mask:0xf
    v_and_b32_dpp v43, v45, v11 row_newbcast:1 row_mask:0xf bank_mask:0xf
    s_waitcnt vmcnt(40)
    s_nop 0
    v_mfma_f32_16x16x32_bf16 v[52:55], v[40:43], a[68:71], v[52:55]
    buffer_load_dwordx4 a[136:139], v5, s[24:27], s34 offen
    s_add_u32 s34, s34, 32768
    buffer_load_dwordx4 a[220:223], v3, s[8:11], s32 offen offset:3072 nt
    s_add_u32 s32, s32, 32768
    buffer_load_dwordx4 a[224:227], v2, s[8:11], s32 offen offset:0 nt
    v_and_b32_dpp v36, v45, v8 row_newbcast:2 row_mask:0xf bank_mask:0xf
    v_and_b32_dpp v37, v45, v9 row_newbcast:2 row_mask:0xf bank_mask:0xf
    v_and_b32_dpp v38, v45, v10 row_newbcast:2 row_mask:0xf bank_mask:0xf
    v_and_b32_dpp v39, v45, v11 row_newbcast:2 row_mask:0xf bank_mask:0xf
    s_waitcnt vmcnt(40)
    s_nop 0
    v_mfma_f32_16x16x32_bf16 v[52:55], v[36:39], a[72:75], v[52:55]
    buffer_load_dwordx4 a[140:143], v5, s[24:27], s34 offen
    s_add_u32 s34, s34, 32768
    buffer_load_dwordx4 a[228:231], v2, s[8:11], s32 offen offset:1024 nt
    v_and_b32_dpp v40, v45, v8 row_newbcast:3 row_mask:0xf bank_mask:0xf
    v_and_b32_dpp v41, v45, v9 row_newbcast:3 row_mask:0xf bank_mask:0xf
    v_and_b32_dpp v42, v45, v10 row_newbcast:3 row_mask:0xf bank_mask:0xf
    v_and_b32_dpp v43, v45, v11 row_newbcast:3 row_mask:0xf bank_mask:0xf
    s_waitcnt vmcnt(40)
    s_nop 0
    v_mfma_f32_16x16x32_bf16 v[52:55], v[40:43], a[76:79], v[52:55]
    buffer_load_dwordx4 a[144:147], v5, s[24:27], s34 offen
    s_add_u32 s34, s34, 32768
    buffer_load_dwordx4 a[232:235], v2, s[8:11], s32 offen offset:2048 nt
    v_and_b32_dpp v36, v45, v8 row_newbcast:4 row_mask:0xf bank_mask:0xf
    v_and_b32_dpp v37, v45, v9 row_newbcast:4 row_mask:0xf bank_mask:0xf
    v_and_b32_dpp v38, v45, v10 row_newbcast:4 row_mask:0xf bank_mask:0xf
    v_and_b32_dpp v39, v45, v11 row_newbcast:4 row_mask:0xf bank_mask:0xf
    s_waitcnt vmcnt(39)
    s_nop 0
    v_mfma_f32_16x16x32_bf16 v[52:55], v[36:39], a[80:83], v[52:55]
    buffer_load_dwordx4 a[148:151], v5, s[24:27], s34 offen
    s_add_u32 s34, s34, 32768
    buffer_load_dwordx4 a[236:239], v2, s[8:11], s32 offen offset:3072 nt
    buffer_load_dwordx4 a[240:243], v3, s[8:11], s32 offen offset:0 nt
    v_and_b32_dpp v40, v45, v8 row_newbcast:5 row_mask:0xf bank_mask:0xf
    v_and_b32_dpp v41, v45, v9 row_newbcast:5 row_mask:0xf bank_mask:0xf
    v_and_b32_dpp v42, v45, v10 row_newbcast:5 row_mask:0xf bank_mask:0xf
    v_and_b32_dpp v43, v45, v11 row_newbcast:5 row_mask:0xf bank_mask:0xf
    s_waitcnt vmcnt(40)
    s_nop 0
    v_mfma_f32_16x16x32_bf16 v[52:55], v[40:43], a[84:87], v[52:55]
    buffer_load_dwordx4 a[152:155], v5, s[24:27], s34 offen
    s_add_u32 s34, s34, 32768
    buffer_load_dwordx4 a[244:247], v3, s[8:11], s32 offen offset:1024 nt
    v_and_b32_dpp v36, v45, v8 row_newbcast:6 row_mask:0xf bank_mask:0xf
    v_and_b32_dpp v37, v45, v9 row_newbcast:6 row_mask:0xf bank_mask:0xf
    v_and_b32_dpp v38, v45, v10 row_newbcast:6 row_mask:0xf bank_mask:0xf
    v_and_b32_dpp v39, v45, v11 row_newbcast:6 row_mask:0xf bank_mask:0xf
    s_waitcnt vmcnt(40)
    s_nop 0
    v_mfma_f32_16x16x32_bf16 v[52:55], v[36:39], a[88:91], v[52:55]
    buffer_load_dwordx4 a[156:159], v5, s[24:27], s34 offen
    s_add_u32 s34, s34, 32768
    buffer_load_dwordx4 a[248:251], v3, s[8:11], s32 offen offset:2048 nt
    buffer_load_dwordx4 a[252:255], v3, s[8:11], s32 offen offset:3072 nt
    s_add_u32 s32, s32, 32768
    v_and_b32_dpp v40, v45, v8 row_newbcast:7 row_mask:0xf bank_mask:0xf
    v_and_b32_dpp v41, v45, v9 row_newbcast:7 row_mask:0xf bank_mask:0xf
    v_and_b32_dpp v42, v45, v10 row_newbcast:7 row_mask:0xf bank_mask:0xf
    v_and_b32_dpp v43, v45, v11 row_newbcast:7 row_mask:0xf bank_mask:0xf
    s_waitcnt vmcnt(40)
    s_nop 0
    v_mfma_f32_16x16x32_bf16 v[52:55], v[40:43], a[92:95], v[52:55]
    v_and_b32_dpp v36, v45, v8 row_newbcast:8 row_mask:0xf bank_mask:0xf
    v_and_b32_dpp v37, v45, v9 row_newbcast:8 row_mask:0xf bank_mask:0xf
    v_and_b32_dpp v38, v45, v10 row_newbcast:8 row_mask:0xf bank_mask:0xf
    v_and_b32_dpp v39, v45, v11 row_newbcast:8 row_mask:0xf bank_mask:0xf
    s_waitcnt vmcnt(38)
    s_nop 0
    v_mfma_f32_16x16x32_bf16 v[52:55], v[36:39], a[96:99], v[52:55]
    v_and_b32_dpp v40, v45, v8 row_newbcast:9 row_mask:0xf bank_mask:0xf
    v_and_b32_dpp v41, v45, v9 row_newbcast:9 row_mask:0xf bank_mask:0xf
    v_and_b32_dpp v42, v45, v10 row_newbcast:9 row_mask:0xf bank_mask:0xf
    v_and_b32_dpp v43, v45, v11 row_newbcast:9 row_mask:0xf bank_mask:0xf
    s_waitcnt vmcnt(35)
    s_nop 0
    v_mfma_f32_16x16x32_bf16 v[52:55], v[40:43], a[100:103], v[52:55]
    v_and_b32_dpp v36, v45, v8 row_newbcast:10 row_mask:0xf bank_mask:0xf
    v_and_b32_dpp v37, v45, v9 row_newbcast:10 row_mask:0xf bank_mask:0xf
    v_and_b32_dpp v38, v45, v10 row_newbcast:10 row_mask:0xf bank_mask:0xf
    v_and_b32_dpp v39, v45, v11 row_newbcast:10 row_mask:0xf bank_mask:0xf
    s_waitcnt vmcnt(33)
    s_nop 0
    v_mfma_f32_16x16x32_bf16 v[52:55], v[36:39], a[104:107], v[52:55]
    v_and_b32_dpp v40, v45, v8 row_newbcast:11 row_mask:0xf bank_mask:0xf
    v_and_b32_dpp v41, v45, v9 row_newbcast:11 row_mask:0xf bank_mask:0xf
    v_and_b32_dpp v42, v45, v10 row_newbcast:11 row_mask:0xf bank_mask:0xf
    v_and_b32_dpp v43, v45, v11 row_newbcast:11 row_mask:0xf bank_mask:0xf
    s_waitcnt vmcnt(31)
    s_nop 0
    v_mfma_f32_16x16x32_bf16 v[52:55], v[40:43], a[108:111], v[52:55]
    v_and_b32_dpp v36, v45, v8 row_newbcast:12 row_mask:0xf bank_mask:0xf
    v_and_b32_dpp v37, v45, v9 row_newbcast:12 row_mask:0xf bank_mask:0xf
    v_and_b32_dpp v38, v45, v10 row_newbcast:12 row_mask:0xf bank_mask:0xf
    v_and_b32_dpp v39, v45, v11 row_newbcast:12 row_mask:0xf bank_mask:0xf
    s_waitcnt vmcnt(28)
    s_nop 0
    v_mfma_f32_16x16x32_bf16 v[52:55], v[36:39], a[112:115], v[52:55]
    v_and_b32_dpp v40, v45, v8 row_newbcast:13 row_mask:0xf bank_mask:0xf
    v_and_b32_dpp v41, v45, v9 row_newbcast:13 row_mask:0xf bank_mask:0xf
    v_and_b32_dpp v42, v45, v10 row_newbcast:13 row_mask:0xf bank_mask:0xf
    v_and_b32_dpp v43, v45, v11 row_newbcast:13 row_mask:0xf bank_mask:0xf
    s_waitcnt vmcnt(26)
    s_nop 0
    v_mfma_f32_16x16x32_bf16 v[52:55], v[40:43], a[116:119], v[52:55]
    v_and_b32_dpp v36, v45, v8 row_newbcast:14 row_mask:0xf bank_mask:0xf
    v_and_b32_dpp v37, v45, v9 row_newbcast:14 row_mask:0xf bank_mask:0xf
    v_and_b32_dpp v38, v45, v10 row_newbcast:14 row_mask:0xf bank_mask:0xf
    v_and_b32_dpp v39, v45, v11 row_newbcast:14 row_mask:0xf bank_mask:0xf
    s_waitcnt vmcnt(23)
    s_nop 0
    v_mfma_f32_16x16x32_bf16 v[52:55], v[36:39], a[120:123], v[52:55]
    v_and_b32_dpp v40, v45, v8 row_newbcast:15 row_mask:0xf bank_mask:0xf
    v_and_b32_dpp v41, v45, v9 row_newbcast:15 row_mask:0xf bank_mask:0xf
    v_and_b32_dpp v42, v45, v10 row_newbcast:15 row_mask:0xf bank_mask:0xf
    v_and_b32_dpp v43, v45, v11 row_newbcast:15 row_mask:0xf bank_mask:0xf
    s_waitcnt vmcnt(21)
    s_nop 0
    v_mfma_f32_16x16x32_bf16 v[52:55], v[40:43], a[124:127], v[52:55]
    v_and_b32_dpp v36, v46, v8 row_newbcast:0 row_mask:0xf bank_mask:0xf
    v_and_b32_dpp v37, v46, v9 row_newbcast:0 row_mask:0xf bank_mask:0xf
    v_and_b32_dpp v38, v46, v10 row_newbcast:0 row_mask:0xf bank_mask:0xf
    v_and_b32_dpp v39, v46, v11 row_newbcast:0 row_mask:0xf bank_mask:0xf
    s_waitcnt vmcnt(19)
    s_nop 0
    v_mfma_f32_16x16x32_bf16 v[52:55], v[36:39], a[128:131], v[52:55]
    v_and_b32_dpp v40, v46, v8 row_newbcast:1 row_mask:0xf bank_mask:0xf
    v_and_b32_dpp v41, v46, v9 row_newbcast:1 row_mask:0xf bank_mask:0xf
    v_and_b32_dpp v42, v46, v10 row_newbcast:1 row_mask:0xf bank_mask:0xf
    v_and_b32_dpp v43, v46, v11 row_newbcast:1 row_mask:0xf bank_mask:0xf
    s_waitcnt vmcnt(16)
    s_nop 0
    v_mfma_f32_16x16x32_bf16 v[52:55], v[40:43], a[132:135], v[52:55]
    v_and_b32_dpp v36, v46, v8 row_newbcast:2 row_mask:0xf bank_mask:0xf
    v_and_b32_dpp v37, v46, v9 row_newbcast:2 row_mask:0xf bank_mask:0xf
    v_and_b32_dpp v38, v46, v10 row_newbcast:2 row_mask:0xf bank_mask:0xf
    v_and_b32_dpp v39, v46, v11 row_newbcast:2 row_mask:0xf bank_mask:0xf
    s_waitcnt vmcnt(14)
    s_nop 0
    v_mfma_f32_16x16x32_bf16 v[52:55], v[36:39], a[136:139], v[52:55]
    v_and_b32_dpp v40, v46, v8 row_newbcast:3 row_mask:0xf bank_mask:0xf
    v_and_b32_dpp v41, v46, v9 row_newbcast:3 row_mask:0xf bank_mask:0xf
    v_and_b32_dpp v42, v46, v10 row_newbcast:3 row_mask:0xf bank_mask:0xf
    v_and_b32_dpp v43, v46, v11 row_newbcast:3 row_mask:0xf bank_mask:0xf
    s_waitcnt vmcnt(11)
    s_nop 0
    v_mfma_f32_16x16x32_bf16 v[52:55], v[40:43], a[140:143], v[52:55]
    v_and_b32_dpp v36, v46, v8 row_newbcast:4 row_mask:0xf bank_mask:0xf
    v_and_b32_dpp v37, v46, v9 row_newbcast:4 row_mask:0xf bank_mask:0xf
    v_and_b32_dpp v38, v46, v10 row_newbcast:4 row_mask:0xf bank_mask:0xf
    v_and_b32_dpp v39, v46, v11 row_newbcast:4 row_mask:0xf bank_mask:0xf
    s_waitcnt vmcnt(9)
    s_nop 0
    v_mfma_f32_16x16x32_bf16 v[52:55], v[36:39], a[144:147], v[52:55]
    v_and_b32_dpp v40, v46, v8 row_newbcast:5 row_mask:0xf bank_mask:0xf
    v_and_b32_dpp v41, v46, v9 row_newbcast:5 row_mask:0xf bank_mask:0xf
    v_and_b32_dpp v42, v46, v10 row_newbcast:5 row_mask:0xf bank_mask:0xf
    v_and_b32_dpp v43, v46, v11 row_newbcast:5 row_mask:0xf bank_mask:0xf
    s_waitcnt vmcnt(7)
    s_nop 0
    v_mfma_f32_16x16x32_bf16 v[52:55], v[40:43], a[148:151], v[52:55]
    v_and_b32_dpp v36, v46, v8 row_newbcast:6 row_mask:0xf bank_mask:0xf
    v_and_b32_dpp v37, v46, v9 row_newbcast:6 row_mask:0xf bank_mask:0xf
    v_and_b32_dpp v38, v46, v10 row_newbcast:6 row_mask:0xf bank_mask:0xf
    v_and_b32_dpp v39, v46, v11 row_newbcast:6 row_mask:0xf bank_mask:0xf
    s_waitcnt vmcnt(4)
    s_nop 0
    v_mfma_f32_16x16x32_bf16 v[52:55], v[36:39], a[152:155], v[52:55]
    v_and_b32_dpp v40, v46, v8 row_newbcast:7 row_mask:0xf bank_mask:0xf
    v_and_b32_dpp v41, v46, v9 row_newbcast:7 row_mask:0xf bank_mask:0xf
    v_and_b32_dpp v42, v46, v10 row_newbcast:7 row_mask:0xf bank_mask:0xf
    v_and_b32_dpp v43, v46, v11 row_newbcast:7 row_mask:0xf bank_mask:0xf
    s_waitcnt vmcnt(2)
    s_nop 0
    v_mfma_f32_16x16x32_bf16 v[52:55], v[40:43], a[156:159], v[52:55]
    s_mov_b32 exec_hi, 0
    s_nop 6
    ds_write_b128 v51, v[52:55] offset:0
    s_mov_b64 exec, -1
    buffer_load_ushort v47, v50, s[28:31], s3 offen offset:0
    buffer_load_ushort v48, v50, s[28:31], s3 offen offset:128
    buffer_load_ushort v49, v50, s[28:31], s3 offen offset:256
    s_add_u32 s24, s80, s5
    s_addc_u32 s25, s81, 0
    s_mov_b32 s26, 0
    s_mov_b32 s27, 0x20000
    s_sub_u32 s26, 5242880, s5
    s_mul_i32 s34, s38, 1310720
    s_add_u32 s28, s72, s63
    s_addc_u32 s29, s73, 0
    s_mov_b32 s30, 163840
    s_mov_b32 s31, 0x20000
    s_lshl_b32 s4, s39, 2
    s_add_u32 s4, s4, s38
    s_mul_i32 s4, s4, 40
    v_add_u32 v125, s4, v7
    v_and_b32 v126, 1, v125
    v_lshlrev_b32 v126, 7, v126
    v_lshrrev_b32 v125, 1, v125
    v_lshl_add_u32 v125, v125, 13, v126
    s_mov_b32 exec_hi, 0xff
    buffer_load_dword v126, v125, s[24:27], 0 offen
    s_mov_b64 exec, -1
    s_waitcnt lgkmcnt(0)
    s_barrier
    ds_read_b128 v[72:75], v106 offset:0
    ds_read_b128 v[76:79], v106 offset:16
    ds_read_b128 v[80:83], v106 offset:512
    ds_read_b128 v[84:87], v106 offset:528
    ds_read_b128 v[88:91], v106 offset:1024
    ds_read_b128 v[92:95], v106 offset:1040
    ds_read_b128 v[96:99], v106 offset:1536
    ds_read_b128 v[100:103], v106 offset:1552
    s_waitcnt lgkmcnt(0)
    v_add_f32 v72, v72, v80
    v_add_f32 v73, v73, v81
    v_add_f32 v74, v74, v82
    v_add_f32 v75, v75, v83
    v_add_f32 v76, v76, v84
    v_add_f32 v77, v77, v85
    v_add_f32 v78, v78, v86
    v_add_f32 v79, v79, v87
    v_add_f32 v72, v72, v88
    v_add_f32 v73, v73, v89
    v_add_f32 v74, v74, v90
    v_add_f32 v75, v75, v91
    v_add_f32 v76, v76, v92
    v_add_f32 v77, v77, v93
    v_add_f32 v78, v78, v94
    v_add_f32 v79, v79, v95
    v_add_f32 v72, v72, v96
    v_add_f32 v73, v73, v97
    v_add_f32 v74, v74, v98
    v_add_f32 v75, v75, v99
    v_add_f32 v76, v76, v100
    v_add_f32 v77, v77, v101
    v_add_f32 v78, v78, v102
    v_add_f32 v79, v79, v103
    v_cvt_pk_bf16_f32 v12, v72, v73
    v_cvt_pk_bf16_f32 v13, v74, v75
    v_cvt_pk_bf16_f32 v14, v76, v77
    v_cvt_pk_bf16_f32 v15, v78, v79
    v_dot2_f32_bf16 v20, v128, v12, 0
    v_dot2_f32_bf16 v20, v129, v13, v20
    v_dot2_f32_bf16 v20, v130, v14, v20
    v_dot2_f32_bf16 v20, v131, v15, v20
    v_dot2_f32_bf16 v21, v132, v12, 0
    v_dot2_f32_bf16 v21, v133, v13, v21
    v_dot2_f32_bf16 v21, v134, v14, v21
    v_dot2_f32_bf16 v21, v135, v15, v21
    buffer_load_dwordx4 a[0:3], v5, s[24:27], s34 offen
    s_add_u32 s34, s34, 32768
    v_dot2_f32_bf16 v22, v136, v12, 0
    v_dot2_f32_bf16 v22, v137, v13, v22
    v_dot2_f32_bf16 v22, v138, v14, v22
    v_dot2_f32_bf16 v22, v139, v15, v22
    v_dot2_f32_bf16 v23, v140, v12, 0
    v_dot2_f32_bf16 v23, v141, v13, v23
    v_dot2_f32_bf16 v23, v142, v14, v23
    v_dot2_f32_bf16 v23, v143, v15, v23
    buffer_load_dwordx4 a[4:7], v5, s[24:27], s34 offen
    s_add_u32 s34, s34, 32768
    v_dot2_f32_bf16 v24, v144, v12, 0
    v_dot2_f32_bf16 v24, v145, v13, v24
    v_dot2_f32_bf16 v24, v146, v14, v24
    v_dot2_f32_bf16 v24, v147, v15, v24
    v_add_f32_dpp v20, v20, v20 row_mirror row_mask:0xf bank_mask:0xf
    v_add_f32_dpp v21, v21, v21 row_mirror row_mask:0xf bank_mask:0xf
    s_nop 0
    v_add_f32_dpp v20, v22, v22 row_mirror row_mask:0xf bank_mask:0xc
    v_add_f32_dpp v21, v23, v23 row_mirror row_mask:0xf bank_mask:0xc
    s_nop 0
    v_add_f32_dpp v20, v20, v20 row_half_mirror row_mask:0xf bank_mask:0xf
    s_nop 1
    v_add_f32_dpp v20, v21, v21 row_half_mirror row_mask:0xf bank_mask:0xa
    s_nop 1
    v_add_f32_dpp v20, v20, v20 quad_perm:[1,0,3,2] row_mask:0xf bank_mask:0xf
    s_nop 1
    v_add_f32_dpp v20, v20, v20 quad_perm:[2,3,0,1] row_mask:0xf bank_mask:0xf
    v_cvt_pk_bf16_f32 v20, v20, v20
    v_and_b32 v20, s47, v20
    v_mul_f32 v20, s45, v20
    v_cvt_pk_bf16_f32 v20, v20, v20
    v_and_b32 v110, s47, v20
    buffer_load_dwordx4 a[8:11], v5, s[24:27], s34 offen
    s_add_u32 s34, s34, 32768
    v_dot2_f32_bf16 v25, v148, v12, 0
    v_dot2_f32_bf16 v25, v149, v13, v25
    v_dot2_f32_bf16 v25, v150, v14, v25
    v_dot2_f32_bf16 v25, v151, v15, v25
    buffer_load_dwordx4 a[12:15], v5, s[24:27], s34 offen
    s_add_u32 s34, s34, 32768
    v_dot2_f32_bf16 v26, v152, v12, 0
    v_dot2_f32_bf16 v26, v153, v13, v26
    v_dot2_f32_bf16 v26, v154, v14, v26
    v_dot2_f32_bf16 v26, v155, v15, v26
    v_dot2_f32_bf16 v27, v156, v12, 0
    v_dot2_f32_bf16 v27, v157, v13, v27
    v_dot2_f32_bf16 v27, v158, v14, v27
    v_dot2_f32_bf16 v27, v159, v15, v27
    v_add_f32_dpp v24, v24, v24 row_mirror row_mask:0xf bank_mask:0xf
    v_add_f32_dpp v25, v25, v25 row_mirror row_mask:0xf bank_mask:0xf
    s_nop 0
    v_add_f32_dpp v24, v26, v26 row_mirror row_mask:0xf bank_mask:0xc
    v_add_f32_dpp v25, v27, v27 row_mirror row_mask:0xf bank_mask:0xc
    s_nop 0
    v_add_f32_dpp v24, v24, v24 row_half_mirror row_mask:0xf bank_mask:0xf
    s_nop 1
    v_add_f32_dpp v24, v25, v25 row_half_mirror row_mask:0xf bank_mask:0xa
    s_nop 1
    v_add_f32_dpp v24, v24, v24 quad_perm:[1,0,3,2] row_mask:0xf bank_mask:0xf
    s_nop 1
    v_add_f32_dpp v24, v24, v24 quad_perm:[2,3,0,1] row_mask:0xf bank_mask:0xf
    v_cvt_pk_bf16_f32 v24, v24, v24
    v_and_b32 v24, s47, v24
    v_mul_f32 v24, s45, v24
    v_cvt_pk_bf16_f32 v24, v24, v24
    v_and_b32 v111, s47, v24
    ds_write_b64 v116, v[110:111]
    v_max3_f32 v28, v28, v110, v111
    v_add_u32 v116, 512, v116
    buffer_load_dwordx4 a[16:19], v5, s[24:27], s34 offen
    s_add_u32 s34, s34, 32768
    v_dot2_f32_bf16 v20, v160, v12, 0
    v_dot2_f32_bf16 v20, v161, v13, v20
    v_dot2_f32_bf16 v20, v162, v14, v20
    v_dot2_f32_bf16 v20, v163, v15, v20
    s_mov_b32 s50, 0x164000
    s_and_b32 s35, s2, 7
    s_getreg_b32 s6, hwreg(HW_REG_XCC_ID)
    s_and_b32 s6, s6, 7
    s_cmp_eq_u32 s6, s35
    s_cselect_b32 s36, -1, 0
    s_lshl_b32 s35, s35, 8
    s_add_u32 s35, s35, 1376256
    s_lshl_b32 s6, s2, 8
    s_add_u32 s6, s6, 1392640
    s_cmp_eq_u32 s36, 0
    s_cselect_b32 s35, s6, s35
    v_and_b32 v122, 31, v7
    v_lshlrev_b32 v122, 2, v122
    s_lshr_b32 s4, s2, 3
    s_lshl_b32 s4, s4, 2
    v_mov_b32 v124, s4
    v_mov_b32 v123, 0
    s_mov_b32 s33, 0
    s_and_b32 s3, s40, 7
    s_lshl_b32 s3, s3, 2
    s_lshr_b32 s42, 1146373204, s3
    s_and_b32 s42, s42, 15
    s_add_u32 s42, s42, 16
    s_add_u32 s52, s42, 0
    s_lshr_b32 s52, s52, 2
    s_add_u32 s53, s42, 1
    s_lshr_b32 s53, s53, 2
    s_add_u32 s54, s42, 2
    s_lshr_b32 s54, s54, 2
    s_add_u32 s55, s42, 3
    s_lshr_b32 s55, s55, 2
    s_cmp_lg_u32 s38, 0
    s_cbranch_scc1 L_ci1
    s_mov_b64 exec, 1
    buffer_store_dword v123, v124, s[48:51], s35 offen
    s_mov_b64 exec, -1
L_ci1:
    v_dot2_f32_bf16 v21, v164, v12, 0
    v_dot2_f32_bf16 v21, v165, v13, v21
    v_dot2_f32_bf16 v21, v166, v14, v21
    v_dot2_f32_bf16 v21, v167, v15, v21
    buffer_load_dwordx4 a[20:23], v5, s[24:27], s34 offen
    s_add_u32 s34, s34, 32768
    v_dot2_f32_bf16 v22, v168, v12, 0
    v_dot2_f32_bf16 v22, v169, v13, v22
    v_dot2_f32_bf16 v22, v170, v14, v22
    v_dot2_f32_bf16 v22, v171, v15, v22
    v_dot2_f32_bf16 v23, v172, v12, 0
    v_dot2_f32_bf16 v23, v173, v13, v23
    v_dot2_f32_bf16 v23, v174, v14, v23
    v_dot2_f32_bf16 v23, v175, v15, v23
    buffer_load_dwordx4 a[24:27], v5, s[24:27], s34 offen
    s_add_u32 s34, s34, 32768
    v_dot2_f32_bf16 v24, v176, v12, 0
    v_dot2_f32_bf16 v24, v177, v13, v24
    v_dot2_f32_bf16 v24, v178, v14, v24
    v_dot2_f32_bf16 v24, v179, v15, v24
    v_add_f32_dpp v20, v20, v20 row_mirror row_mask:0xf bank_mask:0xf
    v_add_f32_dpp v21, v21, v21 row_mirror row_mask:0xf bank_mask:0xf
    s_nop 0
    v_add_f32_dpp v20, v22, v22 row_mirror row_mask:0xf bank_mask:0xc
    v_add_f32_dpp v21, v23, v23 row_mirror row_mask:0xf bank_mask:0xc
    s_nop 0
    v_add_f32_dpp v20, v20, v20 row_half_mirror row_mask:0xf bank_mask:0xf
    s_nop 1
    v_add_f32_dpp v20, v21, v21 row_half_mirror row_mask:0xf bank_mask:0xa
    s_nop 1
    v_add_f32_dpp v20, v20, v20 quad_perm:[1,0,3,2] row_mask:0xf bank_mask:0xf
    s_nop 1
    v_add_f32_dpp v20, v20, v20 quad_perm:[2,3,0,1] row_mask:0xf bank_mask:0xf
    v_cvt_pk_bf16_f32 v20, v20, v20
    v_and_b32 v20, s47, v20
    v_mul_f32 v20, s45, v20
    v_cvt_pk_bf16_f32 v20, v20, v20
    v_and_b32 v110, s47, v20
    buffer_load_dwordx4 a[28:31], v5, s[24:27], s34 offen
    s_add_u32 s34, s34, 32768
    v_dot2_f32_bf16 v25, v180, v12, 0
    v_dot2_f32_bf16 v25, v181, v13, v25
    v_dot2_f32_bf16 v25, v182, v14, v25
    v_dot2_f32_bf16 v25, v183, v15, v25
    buffer_load_dwordx4 a[32:35], v5, s[24:27], s34 offen
    s_add_u32 s34, s34, 32768
    v_dot2_f32_bf16 v26, v184, v12, 0
    v_dot2_f32_bf16 v26, v185, v13, v26
    v_dot2_f32_bf16 v26, v186, v14, v26
    v_dot2_f32_bf16 v26, v187, v15, v26
    v_dot2_f32_bf16 v27, v188, v12, 0
    v_dot2_f32_bf16 v27, v189, v13, v27
    v_dot2_f32_bf16 v27, v190, v14, v27
    v_dot2_f32_bf16 v27, v191, v15, v27
    v_add_f32_dpp v24, v24, v24 row_mirror row_mask:0xf bank_mask:0xf
    v_add_f32_dpp v25, v25, v25 row_mirror row_mask:0xf bank_mask:0xf
    s_nop 0
    v_add_f32_dpp v24, v26, v26 row_mirror row_mask:0xf bank_mask:0xc
    v_add_f32_dpp v25, v27, v27 row_mirror row_mask:0xf bank_mask:0xc
    s_nop 0
    v_add_f32_dpp v24, v24, v24 row_half_mirror row_mask:0xf bank_mask:0xf
    s_nop 1
    v_add_f32_dpp v24, v25, v25 row_half_mirror row_mask:0xf bank_mask:0xa
    s_nop 1
    v_add_f32_dpp v24, v24, v24 quad_perm:[1,0,3,2] row_mask:0xf bank_mask:0xf
    s_nop 1
    v_add_f32_dpp v24, v24, v24 quad_perm:[2,3,0,1] row_mask:0xf bank_mask:0xf
    v_cvt_pk_bf16_f32 v24, v24, v24
    v_and_b32 v24, s47, v24
    v_mul_f32 v24, s45, v24
    v_cvt_pk_bf16_f32 v24, v24, v24
    v_and_b32 v111, s47, v24
    ds_write_b64 v116, v[110:111]
    v_max3_f32 v28, v28, v110, v111
    v_add_u32 v116, 512, v116
    buffer_load_dwordx4 a[36:39], v5, s[24:27], s34 offen
    s_add_u32 s34, s34, 32768
    v_dot2_f32_bf16 v20, v192, v12, 0
    v_dot2_f32_bf16 v20, v193, v13, v20
    v_dot2_f32_bf16 v20, v194, v14, v20
    v_dot2_f32_bf16 v20, v195, v15, v20
    v_dot2_f32_bf16 v21, v196, v12, 0
    v_dot2_f32_bf16 v21, v197, v13, v21
    v_dot2_f32_bf16 v21, v198, v14, v21
    v_dot2_f32_bf16 v21, v199, v15, v21
    buffer_load_dwordx4 a[40:43], v5, s[24:27], s34 offen
    s_add_u32 s34, s34, 32768
    v_dot2_f32_bf16 v22, v200, v12, 0
    v_dot2_f32_bf16 v22, v201, v13, v22
    v_dot2_f32_bf16 v22, v202, v14, v22
    v_dot2_f32_bf16 v22, v203, v15, v22
    v_dot2_f32_bf16 v23, v204, v12, 0
    v_dot2_f32_bf16 v23, v205, v13, v23
    v_dot2_f32_bf16 v23, v206, v14, v23
    v_dot2_f32_bf16 v23, v207, v15, v23
    buffer_load_dwordx4 a[44:47], v5, s[24:27], s34 offen
    s_add_u32 s34, s34, 32768
    v_dot2_f32_bf16 v24, v208, v12, 0
    v_dot2_f32_bf16 v24, v209, v13, v24
    v_dot2_f32_bf16 v24, v210, v14, v24
    v_dot2_f32_bf16 v24, v211, v15, v24
    v_add_f32_dpp v20, v20, v20 row_mirror row_mask:0xf bank_mask:0xf
    v_add_f32_dpp v21, v21, v21 row_mirror row_mask:0xf bank_mask:0xf
    s_nop 0
    v_add_f32_dpp v20, v22, v22 row_mirror row_mask:0xf bank_mask:0xc
    v_add_f32_dpp v21, v23, v23 row_mirror row_mask:0xf bank_mask:0xc
    s_nop 0
    v_add_f32_dpp v20, v20, v20 row_half_mirror row_mask:0xf bank_mask:0xf
    s_nop 1
    v_add_f32_dpp v20, v21, v21 row_half_mirror row_mask:0xf bank_mask:0xa
    s_nop 1
    v_add_f32_dpp v20, v20, v20 quad_perm:[1,0,3,2] row_mask:0xf bank_mask:0xf
    s_nop 1
    v_add_f32_dpp v20, v20, v20 quad_perm:[2,3,0,1] row_mask:0xf bank_mask:0xf
    v_cvt_pk_bf16_f32 v20, v20, v20
    v_and_b32 v20, s47, v20
    v_mul_f32 v20, s45, v20
    v_cvt_pk_bf16_f32 v20, v20, v20
    v_and_b32 v110, s47, v20
    buffer_load_dwordx4 a[48:51], v5, s[24:27], s34 offen
    s_add_u32 s34, s34, 32768
    v_dot2_f32_bf16 v25, v212, v12, 0
    v_dot2_f32_bf16 v25, v213, v13, v25
    v_dot2_f32_bf16 v25, v214, v14, v25
    v_dot2_f32_bf16 v25, v215, v15, v25
    buffer_load_dwordx4 a[52:55], v5, s[24:27], s34 offen
    s_add_u32 s34, s34, 32768
    v_dot2_f32_bf16 v26, v216, v12, 0
    v_dot2_f32_bf16 v26, v217, v13, v26
    v_dot2_f32_bf16 v26, v218, v14, v26
    v_dot2_f32_bf16 v26, v219, v15, v26
    v_dot2_f32_bf16 v27, v220, v12, 0
    v_dot2_f32_bf16 v27, v221, v13, v27
    v_dot2_f32_bf16 v27, v222, v14, v27
    v_dot2_f32_bf16 v27, v223, v15, v27
    v_add_f32_dpp v24, v24, v24 row_mirror row_mask:0xf bank_mask:0xf
    v_add_f32_dpp v25, v25, v25 row_mirror row_mask:0xf bank_mask:0xf
    s_nop 0
    v_add_f32_dpp v24, v26, v26 row_mirror row_mask:0xf bank_mask:0xc
    v_add_f32_dpp v25, v27, v27 row_mirror row_mask:0xf bank_mask:0xc
    s_nop 0
    v_add_f32_dpp v24, v24, v24 row_half_mirror row_mask:0xf bank_mask:0xf
    s_nop 1
    v_add_f32_dpp v24, v25, v25 row_half_mirror row_mask:0xf bank_mask:0xa
    s_nop 1
    v_add_f32_dpp v24, v24, v24 quad_perm:[1,0,3,2] row_mask:0xf bank_mask:0xf
    s_nop 1
    v_add_f32_dpp v24, v24, v24 quad_perm:[2,3,0,1] row_mask:0xf bank_mask:0xf
    v_cvt_pk_bf16_f32 v24, v24, v24
    v_and_b32 v24, s47, v24
    v_mul_f32 v24, s45, v24
    v_cvt_pk_bf16_f32 v24, v24, v24
    v_and_b32 v111, s47, v24
    ds_write_b64 v116, v[110:111]
    v_max3_f32 v28, v28, v110, v111
    v_add_u32 v116, 512, v116
    buffer_load_dwordx4 a[56:59], v5, s[24:27], s34 offen
    s_add_u32 s34, s34, 32768
    v_dot2_f32_bf16 v20, v224, v12, 0
    v_dot2_f32_bf16 v20, v225, v13, v20
    v_dot2_f32_bf16 v20, v226, v14, v20
    v_dot2_f32_bf16 v20, v227, v15, v20
    s_waitcnt vmcnt(27)
    buffer_load_dwordx4 v[224:227], v2, s[8:11], s32 offen offset:0 nt
    v_dot2_f32_bf16 v21, v228, v12, 0
    v_dot2_f32_bf16 v21, v229, v13, v21
    v_dot2_f32_bf16 v21, v230, v14, v21
    v_dot2_f32_bf16 v21, v231, v15, v21
    s_waitcnt vmcnt(26)
    buffer_load_dwordx4 v[228:231], v2, s[8:11], s32 offen offset:1024 nt
    buffer_load_dwordx4 a[60:63], v5, s[24:27], s34 offen
    s_add_u32 s34, s34, 32768
    v_dot2_f32_bf16 v22, v232, v12, 0
    v_dot2_f32_bf16 v22, v233, v13, v22
    v_dot2_f32_bf16 v22, v234, v14, v22
    v_dot2_f32_bf16 v22, v235, v15, v22
    s_waitcnt vmcnt(27)
    buffer_load_dwordx4 v[232:235], v2, s[8:11], s32 offen offset:2048 nt
    v_dot2_f32_bf16 v23, v236, v12, 0
    v_dot2_f32_bf16 v23, v237, v13, v23
    v_dot2_f32_bf16 v23, v238, v14, v23
    v_dot2_f32_bf16 v23, v239, v15, v23
    s_waitcnt vmcnt(26)
    buffer_load_dwordx4 v[236:239], v2, s[8:11], s32 offen offset:3072 nt
    buffer_load_dwordx4 a[64:67], v5, s[24:27], s34 offen
    s_add_u32 s34, s34, 32768
    v_dot2_f32_bf16 v24, v240, v12, 0
    v_dot2_f32_bf16 v24, v241, v13, v24
    v_dot2_f32_bf16 v24, v242, v14, v24
    v_dot2_f32_bf16 v24, v243, v15, v24
    s_waitcnt vmcnt(26)
    buffer_load_dwordx4 v[240:243], v3, s[8:11], s32 offen offset:0 nt
    v_add_f32_dpp v20, v20, v20 row_mirror row_mask:0xf bank_mask:0xf
    v_add_f32_dpp v21, v21, v21 row_mirror row_mask:0xf bank_mask:0xf
    s_nop 0
    v_add_f32_dpp v20, v22, v22 row_mirror row_mask:0xf bank_mask:0xc
    v_add_f32_dpp v21, v23, v23 row_mirror row_mask:0xf bank_mask:0xc
    s_nop 0
    v_add_f32_dpp v20, v20, v20 row_half_mirror row_mask:0xf bank_mask:0xf
    s_nop 1
    v_add_f32_dpp v20, v21, v21 row_half_mirror row_mask:0xf bank_mask:0xa
    s_nop 1
    v_add_f32_dpp v20, v20, v20 quad_perm:[1,0,3,2] row_mask:0xf bank_mask:0xf
    s_nop 1
    v_add_f32_dpp v20, v20, v20 quad_perm:[2,3,0,1] row_mask:0xf bank_mask:0xf
    v_cvt_pk_bf16_f32 v20, v20, v20
    v_and_b32 v20, s47, v20
    v_mul_f32 v20, s45, v20
    v_cvt_pk_bf16_f32 v20, v20, v20
    v_and_b32 v110, s47, v20
    buffer_load_dwordx4 a[68:71], v5, s[24:27], s34 offen
    s_add_u32 s34, s34, 32768
    v_dot2_f32_bf16 v25, v244, v12, 0
    v_dot2_f32_bf16 v25, v245, v13, v25
    v_dot2_f32_bf16 v25, v246, v14, v25
    v_dot2_f32_bf16 v25, v247, v15, v25
    s_waitcnt vmcnt(27)
    buffer_load_dwordx4 v[244:247], v3, s[8:11], s32 offen offset:1024 nt
    buffer_load_dwordx4 a[72:75], v5, s[24:27], s34 offen
    s_add_u32 s34, s34, 32768
    v_dot2_f32_bf16 v26, v248, v12, 0
    v_dot2_f32_bf16 v26, v249, v13, v26
    v_dot2_f32_bf16 v26, v250, v14, v26
    v_dot2_f32_bf16 v26, v251, v15, v26
    s_waitcnt vmcnt(9)
    buffer_load_dwordx4 v[248:251], v3, s[8:11], s32 offen offset:2048 nt
    v_dot2_f32_bf16 v27, v252, v12, 0
    v_dot2_f32_bf16 v27, v253, v13, v27
    v_dot2_f32_bf16 v27, v254, v14, v27
    v_dot2_f32_bf16 v27, v255, v15, v27
    s_waitcnt vmcnt(9)
    buffer_load_dwordx4 v[252:255], v3, s[8:11], s32 offen offset:3072 nt
    v_add_f32_dpp v24, v24, v24 row_mirror row_mask:0xf bank_mask:0xf
    v_add_f32_dpp v25, v25, v25 row_mirror row_mask:0xf bank_mask:0xf
    s_nop 0
    v_add_f32_dpp v24, v26, v26 row_mirror row_mask:0xf bank_mask:0xc
    v_add_f32_dpp v25, v27, v27 row_mirror row_mask:0xf bank_mask:0xc
    s_nop 0
    v_add_f32_dpp v24, v24, v24 row_half_mirror row_mask:0xf bank_mask:0xf
    s_nop 1
    v_add_f32_dpp v24, v25, v25 row_half_mirror row_mask:0xf bank_mask:0xa
    s_nop 1
    v_add_f32_dpp v24, v24, v24 quad_perm:[1,0,3,2] row_mask:0xf bank_mask:0xf
    s_nop 1
    v_add_f32_dpp v24, v24, v24 quad_perm:[2,3,0,1] row_mask:0xf bank_mask:0xf
    v_cvt_pk_bf16_f32 v24, v24, v24
    v_and_b32 v24, s47, v24
    v_mul_f32 v24, s45, v24
    v_cvt_pk_bf16_f32 v24, v24, v24
    v_and_b32 v111, s47, v24
    ds_write_b64 v116, v[110:111]
    v_max3_f32 v28, v28, v110, v111
    v_add_u32 v116, 512, v116
    buffer_load_dwordx4 a[76:79], v5, s[24:27], s34 offen
    s_add_u32 s34, s34, 32768
    s_mov_b32 s8, s12
    s_mov_b32 s9, s13
    s_mov_b32 s10, s14
    s_mov_b32 s32, s41
    v_accvgpr_read_b32 v72, a160
    v_accvgpr_read_b32 v73, a161
    v_accvgpr_read_b32 v74, a162
    v_accvgpr_read_b32 v75, a163
    v_dot2_f32_bf16 v20, v72, v12, 0
    v_dot2_f32_bf16 v20, v73, v13, v20
    v_dot2_f32_bf16 v20, v74, v14, v20
    v_dot2_f32_bf16 v20, v75, v15, v20
    s_waitcnt vmcnt(9)
    buffer_load_dwordx4 v[128:131], v2, s[8:11], s32 offen offset:0 nt
    v_accvgpr_read_b32 v76, a164
    v_accvgpr_read_b32 v77, a165
    v_accvgpr_read_b32 v78, a166
    v_accvgpr_read_b32 v79, a167
    v_dot2_f32_bf16 v21, v76, v12, 0
    v_dot2_f32_bf16 v21, v77, v13, v21
    v_dot2_f32_bf16 v21, v78, v14, v21
    v_dot2_f32_bf16 v21, v79, v15, v21
    s_waitcnt vmcnt(9)
    buffer_load_dwordx4 v[132:135], v2, s[8:11], s32 offen offset:1024 nt
    buffer_load_dwordx4 a[80:83], v5, s[24:27], s34 offen
    s_add_u32 s34, s34, 32768
    v_accvgpr_read_b32 v72, a168
    v_accvgpr_read_b32 v73, a169
    v_accvgpr_read_b32 v74, a170
    v_accvgpr_read_b32 v75, a171
    v_dot2_f32_bf16 v22, v72, v12, 0
    v_dot2_f32_bf16 v22, v73, v13, v22
    v_dot2_f32_bf16 v22, v74, v14, v22
    v_dot2_f32_bf16 v22, v75, v15, v22
    s_waitcnt vmcnt(9)
    buffer_load_dwordx4 v[136:139], v2, s[8:11], s32 offen offset:2048 nt
    v_accvgpr_read_b32 v76, a172
    v_accvgpr_read_b32 v77, a173
    v_accvgpr_read_b32 v78, a174
    v_accvgpr_read_b32 v79, a175
    v_dot2_f32_bf16 v23, v76, v12, 0
    v_dot2_f32_bf16 v23, v77, v13, v23
    v_dot2_f32_bf16 v23, v78, v14, v23
    v_dot2_f32_bf16 v23, v79, v15, v23
    s_waitcnt vmcnt(8)
    buffer_load_dwordx4 v[140:143], v2, s[8:11], s32 offen offset:3072 nt
    buffer_load_dwordx4 a[84:87], v5, s[24:27], s34 offen
    s_add_u32 s34, s34, 32768
    v_accvgpr_read_b32 v72, a176
    v_accvgpr_read_b32 v73, a177
    v_accvgpr_read_b32 v74, a178
    v_accvgpr_read_b32 v75, a179
    v_dot2_f32_bf16 v24, v72, v12, 0
    v_dot2_f32_bf16 v24, v73, v13, v24
    v_dot2_f32_bf16 v24, v74, v14, v24
    v_dot2_f32_bf16 v24, v75, v15, v24
    s_waitcnt vmcnt(8)
    buffer_load_dwordx4 v[144:147], v3, s[8:11], s32 offen offset:0 nt
    v_add_f32_dpp v20, v20, v20 row_mirror row_mask:0xf bank_mask:0xf
    v_add_f32_dpp v21, v21, v21 row_mirror row_mask:0xf bank_mask:0xf
    s_nop 0
    v_add_f32_dpp v20, v22, v22 row_mirror row_mask:0xf bank_mask:0xc
    v_add_f32_dpp v21, v23, v23 row_mirror row_mask:0xf bank_mask:0xc
    s_nop 0
    v_add_f32_dpp v20, v20, v20 row_half_mirror row_mask:0xf bank_mask:0xf
    s_nop 1
    v_add_f32_dpp v20, v21, v21 row_half_mirror row_mask:0xf bank_mask:0xa
    s_nop 1
    v_add_f32_dpp v20, v20, v20 quad_perm:[1,0,3,2] row_mask:0xf bank_mask:0xf
    s_nop 1
    v_add_f32_dpp v20, v20, v20 quad_perm:[2,3,0,1] row_mask:0xf bank_mask:0xf
    v_cvt_pk_bf16_f32 v20, v20, v20
    v_and_b32 v20, s47, v20
    v_mul_f32 v20, s45, v20
    v_cvt_pk_bf16_f32 v20, v20, v20
    v_and_b32 v110, s47, v20
    buffer_load_dwordx4 a[88:91], v5, s[24:27], s34 offen
    s_add_u32 s34, s34, 32768
    v_accvgpr_read_b32 v76, a180
    v_accvgpr_read_b32 v77, a181
    v_accvgpr_read_b32 v78, a182
    v_accvgpr_read_b32 v79, a183
    v_dot2_f32_bf16 v25, v76, v12, 0
    v_dot2_f32_bf16 v25, v77, v13, v25
    v_dot2_f32_bf16 v25, v78, v14, v25
    v_dot2_f32_bf16 v25, v79, v15, v25
    s_waitcnt vmcnt(9)
    buffer_load_dwordx4 v[148:151], v3, s[8:11], s32 offen offset:1024 nt
    buffer_load_dwordx4 a[92:95], v5, s[24:27], s34 offen
    s_add_u32 s34, s34, 32768
    v_accvgpr_read_b32 v72, a184
    v_accvgpr_read_b32 v73, a185
    v_accvgpr_read_b32 v74, a186
    v_accvgpr_read_b32 v75, a187
    v_dot2_f32_bf16 v26, v72, v12, 0
    v_dot2_f32_bf16 v26, v73, v13, v26
    v_dot2_f32_bf16 v26, v74, v14, v26
    v_dot2_f32_bf16 v26, v75, v15, v26
    s_waitcnt vmcnt(9)
    buffer_load_dwordx4 v[152:155], v3, s[8:11], s32 offen offset:2048 nt
    v_accvgpr_read_b32 v76, a188
    v_accvgpr_read_b32 v77, a189
    v_accvgpr_read_b32 v78, a190
    v_accvgpr_read_b32 v79, a191
    v_dot2_f32_bf16 v27, v76, v12, 0
    v_dot2_f32_bf16 v27, v77, v13, v27
    v_dot2_f32_bf16 v27, v78, v14, v27
    v_dot2_f32_bf16 v27, v79, v15, v27
    s_waitcnt vmcnt(9)
    buffer_load_dwordx4 v[156:159], v3, s[8:11], s32 offen offset:3072 nt
    v_add_f32_dpp v24, v24, v24 row_mirror row_mask:0xf bank_mask:0xf
    v_add_f32_dpp v25, v25, v25 row_mirror row_mask:0xf bank_mask:0xf
    s_nop 0
    v_add_f32_dpp v24, v26, v26 row_mirror row_mask:0xf bank_mask:0xc
    v_add_f32_dpp v25, v27, v27 row_mirror row_mask:0xf bank_mask:0xc
    s_nop 0
    v_add_f32_dpp v24, v24, v24 row_half_mirror row_mask:0xf bank_mask:0xf
    s_nop 1
    v_add_f32_dpp v24, v25, v25 row_half_mirror row_mask:0xf bank_mask:0xa
    s_nop 1
    v_add_f32_dpp v24, v24, v24 quad_perm:[1,0,3,2] row_mask:0xf bank_mask:0xf
    s_nop 1
    v_add_f32_dpp v24, v24, v24 quad_perm:[2,3,0,1] row_mask:0xf bank_mask:0xf
    v_cvt_pk_bf16_f32 v24, v24, v24
    v_and_b32 v24, s47, v24
    v_mul_f32 v24, s45, v24
    v_cvt_pk_bf16_f32 v24, v24, v24
    v_and_b32 v111, s47, v24
    ds_write_b64 v116, v[110:111]
    v_max3_f32 v28, v28, v110, v111
    v_add_u32 v116, 512, v116
    buffer_load_dwordx4 a[96:99], v5, s[24:27], s34 offen
    s_add_u32 s34, s34, 32768
    s_add_u32 s32, s32, 32768
    v_accvgpr_read_b32 v72, a192
    v_accvgpr_read_b32 v73, a193
    v_accvgpr_read_b32 v74, a194
    v_accvgpr_read_b32 v75, a195
    v_dot2_f32_bf16 v20, v72, v12, 0
    v_dot2_f32_bf16 v20, v73, v13, v20
    v_dot2_f32_bf16 v20, v74, v14, v20
    v_dot2_f32_bf16 v20, v75, v15, v20
    s_waitcnt vmcnt(9)
    buffer_load_dwordx4 v[160:163], v2, s[8:11], s32 offen offset:0 nt
    v_accvgpr_read_b32 v76, a196
    v_accvgpr_read_b32 v77, a197
    v_accvgpr_read_b32 v78, a198
    v_accvgpr_read_b32 v79, a199
    v_dot2_f32_bf16 v21, v76, v12, 0
    v_dot2_f32_bf16 v21, v77, v13, v21
    v_dot2_f32_bf16 v21, v78, v14, v21
    v_dot2_f32_bf16 v21, v79, v15, v21
    s_waitcnt vmcnt(9)
    buffer_load_dwordx4 v[164:167], v2, s[8:11], s32 offen offset:1024 nt
    buffer_load_dwordx4 a[100:103], v5, s[24:27], s34 offen
    s_add_u32 s34, s34, 32768
    v_accvgpr_read_b32 v72, a200
    v_accvgpr_read_b32 v73, a201
    v_accvgpr_read_b32 v74, a202
    v_accvgpr_read_b32 v75, a203
    v_dot2_f32_bf16 v22, v72, v12, 0
    v_dot2_f32_bf16 v22, v73, v13, v22
    v_dot2_f32_bf16 v22, v74, v14, v22
    v_dot2_f32_bf16 v22, v75, v15, v22
    s_waitcnt vmcnt(9)
    buffer_load_dwordx4 v[168:171], v2, s[8:11], s32 offen offset:2048 nt
    v_accvgpr_read_b32 v76, a204
    v_accvgpr_read_b32 v77, a205
    v_accvgpr_read_b32 v78, a206
    v_accvgpr_read_b32 v79, a207
    v_dot2_f32_bf16 v23, v76, v12, 0
    v_dot2_f32_bf16 v23, v77, v13, v23
    v_dot2_f32_bf16 v23, v78, v14, v23
    v_dot2_f32_bf16 v23, v79, v15, v23
    s_waitcnt vmcnt(8)
    buffer_load_dwordx4 v[172:175], v2, s[8:11], s32 offen offset:3072 nt
    buffer_load_dwordx4 a[104:107], v5, s[24:27], s34 offen
    s_add_u32 s34, s34, 32768
    v_accvgpr_read_b32 v72, a208
    v_accvgpr_read_b32 v73, a209
    v_accvgpr_read_b32 v74, a210
    v_accvgpr_read_b32 v75, a211
    v_dot2_f32_bf16 v24, v72, v12, 0
    v_dot2_f32_bf16 v24, v73, v13, v24
    v_dot2_f32_bf16 v24, v74, v14, v24
    v_dot2_f32_bf16 v24, v75, v15, v24
    s_waitcnt vmcnt(8)
    buffer_load_dwordx4 v[176:179], v3, s[8:11], s32 offen offset:0 nt
    v_add_f32_dpp v20, v20, v20 row_mirror row_mask:0xf bank_mask:0xf
    v_add_f32_dpp v21, v21, v21 row_mirror row_mask:0xf bank_mask:0xf
    s_nop 0
    v_add_f32_dpp v20, v22, v22 row_mirror row_mask:0xf bank_mask:0xc
    v_add_f32_dpp v21, v23, v23 row_mirror row_mask:0xf bank_mask:0xc
    s_nop 0
    v_add_f32_dpp v20, v20, v20 row_half_mirror row_mask:0xf bank_mask:0xf
    s_nop 1
    v_add_f32_dpp v20, v21, v21 row_half_mirror row_mask:0xf bank_mask:0xa
    s_nop 1
    v_add_f32_dpp v20, v20, v20 quad_perm:[1,0,3,2] row_mask:0xf bank_mask:0xf
    s_nop 1
    v_add_f32_dpp v20, v20, v20 quad_perm:[2,3,0,1] row_mask:0xf bank_mask:0xf
    v_cvt_pk_bf16_f32 v20, v20, v20
    v_and_b32 v20, s47, v20
    v_mul_f32 v20, s45, v20
    v_cvt_pk_bf16_f32 v20, v20, v20
    v_and_b32 v110, s47, v20
    buffer_load_dwordx4 a[108:111], v5, s[24:27], s34 offen
    s_add_u32 s34, s34, 32768
    v_accvgpr_read_b32 v76, a212
    v_accvgpr_read_b32 v77, a213
    v_accvgpr_read_b32 v78, a214
    v_accvgpr_read_b32 v79, a215
    v_dot2_f32_bf16 v25, v76, v12, 0
    v_dot2_f32_bf16 v25, v77, v13, v25
    v_dot2_f32_bf16 v25, v78, v14, v25
    v_dot2_f32_bf16 v25, v79, v15, v25
    s_waitcnt vmcnt(9)
    buffer_load_dwordx4 v[180:183], v3, s[8:11], s32 offen offset:1024 nt
    buffer_load_dwordx4 a[112:115], v5, s[24:27], s34 offen
    s_add_u32 s34, s34, 32768
    v_accvgpr_read_b32 v72, a216
    v_accvgpr_read_b32 v73, a217
    v_accvgpr_read_b32 v74, a218
    v_accvgpr_read_b32 v75, a219
    v_dot2_f32_bf16 v26, v72, v12, 0
    v_dot2_f32_bf16 v26, v73, v13, v26
    v_dot2_f32_bf16 v26, v74, v14, v26
    v_dot2_f32_bf16 v26, v75, v15, v26
    s_waitcnt vmcnt(9)
    buffer_load_dwordx4 v[184:187], v3, s[8:11], s32 offen offset:2048 nt
    v_accvgpr_read_b32 v76, a220
    v_accvgpr_read_b32 v77, a221
    v_accvgpr_read_b32 v78, a222
    v_accvgpr_read_b32 v79, a223
    v_dot2_f32_bf16 v27, v76, v12, 0
    v_dot2_f32_bf16 v27, v77, v13, v27
    v_dot2_f32_bf16 v27, v78, v14, v27
    v_dot2_f32_bf16 v27, v79, v15, v27
    s_waitcnt vmcnt(9)
    buffer_load_dwordx4 v[188:191], v3, s[8:11], s32 offen offset:3072 nt
    v_add_f32_dpp v24, v24, v24 row_mirror row_mask:0xf bank_mask:0xf
    v_add_f32_dpp v25, v25, v25 row_mirror row_mask:0xf bank_mask:0xf
    s_nop 0
    v_add_f32_dpp v24, v26, v26 row_mirror row_mask:0xf bank_mask:0xc
    v_add_f32_dpp v25, v27, v27 row_mirror row_mask:0xf bank_mask:0xc
    s_nop 0
    v_add_f32_dpp v24, v24, v24 row_half_mirror row_mask:0xf bank_mask:0xf
    s_nop 1
    v_add_f32_dpp v24, v25, v25 row_half_mirror row_mask:0xf bank_mask:0xa
    s_nop 1
    v_add_f32_dpp v24, v24, v24 quad_perm:[1,0,3,2] row_mask:0xf bank_mask:0xf
    s_nop 1
    v_add_f32_dpp v24, v24, v24 quad_perm:[2,3,0,1] row_mask:0xf bank_mask:0xf
    v_cvt_pk_bf16_f32 v24, v24, v24
    v_and_b32 v24, s47, v24
    v_mul_f32 v24, s45, v24
    v_cvt_pk_bf16_f32 v24, v24, v24
    v_and_b32 v111, s47, v24
    ds_write_b64 v116, v[110:111]
    v_max3_f32 v28, v28, v110, v111
    v_add_u32 v116, 512, v116
    buffer_load_dwordx4 a[116:119], v5, s[24:27], s34 offen
    s_add_u32 s34, s34, 32768
    s_add_u32 s32, s32, 32768
    v_accvgpr_read_b32 v72, a224
    v_accvgpr_read_b32 v73, a225
    v_accvgpr_read_b32 v74, a226
    v_accvgpr_read_b32 v75, a227
    v_dot2_f32_bf16 v20, v72, v12, 0
    v_dot2_f32_bf16 v20, v73, v13, v20
    v_dot2_f32_bf16 v20, v74, v14, v20
    v_dot2_f32_bf16 v20, v75, v15, v20
    s_waitcnt vmcnt(9)
    buffer_load_dwordx4 v[192:195], v2, s[8:11], s32 offen offset:0 nt
    v_accvgpr_read_b32 v76, a228
    v_accvgpr_read_b32 v77, a229
    v_accvgpr_read_b32 v78, a230
    v_accvgpr_read_b32 v79, a231
    v_dot2_f32_bf16 v21, v76, v12, 0
    v_dot2_f32_bf16 v21, v77, v13, v21
    v_dot2_f32_bf16 v21, v78, v14, v21
    v_dot2_f32_bf16 v21, v79, v15, v21
    s_waitcnt vmcnt(9)
    buffer_load_dwordx4 v[196:199], v2, s[8:11], s32 offen offset:1024 nt
    buffer_load_dwordx4 a[120:123], v5, s[24:27], s34 offen
    s_add_u32 s34, s34, 32768
    v_accvgpr_read_b32 v72, a232
    v_accvgpr_read_b32 v73, a233
    v_accvgpr_read_b32 v74, a234
    v_accvgpr_read_b32 v75, a235
    v_dot2_f32_bf16 v22, v72, v12, 0
    v_dot2_f32_bf16 v22, v73, v13, v22
    v_dot2_f32_bf16 v22, v74, v14, v22
    v_dot2_f32_bf16 v22, v75, v15, v22
    s_waitcnt vmcnt(9)
    buffer_load_dwordx4 v[200:203], v2, s[8:11], s32 offen offset:2048 nt
    v_accvgpr_read_b32 v76, a236
    v_accvgpr_read_b32 v77, a237
    v_accvgpr_read_b32 v78, a238
    v_accvgpr_read_b32 v79, a239
    v_dot2_f32_bf16 v23, v76, v12, 0
    v_dot2_f32_bf16 v23, v77, v13, v23
    v_dot2_f32_bf16 v23, v78, v14, v23
    v_dot2_f32_bf16 v23, v79, v15, v23
    s_waitcnt vmcnt(8)
    buffer_load_dwordx4 v[204:207], v2, s[8:11], s32 offen offset:3072 nt
    buffer_load_dwordx4 a[124:127], v5, s[24:27], s34 offen
    s_add_u32 s34, s34, 32768
    v_accvgpr_read_b32 v72, a240
    v_accvgpr_read_b32 v73, a241
    v_accvgpr_read_b32 v74, a242
    v_accvgpr_read_b32 v75, a243
    v_dot2_f32_bf16 v24, v72, v12, 0
    v_dot2_f32_bf16 v24, v73, v13, v24
    v_dot2_f32_bf16 v24, v74, v14, v24
    v_dot2_f32_bf16 v24, v75, v15, v24
    s_waitcnt vmcnt(8)
    buffer_load_dwordx4 v[208:211], v3, s[8:11], s32 offen offset:0 nt
    v_add_f32_dpp v20, v20, v20 row_mirror row_mask:0xf bank_mask:0xf
    v_add_f32_dpp v21, v21, v21 row_mirror row_mask:0xf bank_mask:0xf
    s_nop 0
    v_add_f32_dpp v20, v22, v22 row_mirror row_mask:0xf bank_mask:0xc
    v_add_f32_dpp v21, v23, v23 row_mirror row_mask:0xf bank_mask:0xc
    s_nop 0
    v_add_f32_dpp v20, v20, v20 row_half_mirror row_mask:0xf bank_mask:0xf
    s_nop 1
    v_add_f32_dpp v20, v21, v21 row_half_mirror row_mask:0xf bank_mask:0xa
    s_nop 1
    v_add_f32_dpp v20, v20, v20 quad_perm:[1,0,3,2] row_mask:0xf bank_mask:0xf
    s_nop 1
    v_add_f32_dpp v20, v20, v20 quad_perm:[2,3,0,1] row_mask:0xf bank_mask:0xf
    v_cvt_pk_bf16_f32 v20, v20, v20
    v_and_b32 v20, s47, v20
    v_mul_f32 v20, s45, v20
    v_cvt_pk_bf16_f32 v20, v20, v20
    v_and_b32 v110, s47, v20
    buffer_load_dwordx4 a[128:131], v5, s[24:27], s34 offen
    s_add_u32 s34, s34, 32768
    v_accvgpr_read_b32 v76, a244
    v_accvgpr_read_b32 v77, a245
    v_accvgpr_read_b32 v78, a246
    v_accvgpr_read_b32 v79, a247
    v_dot2_f32_bf16 v25, v76, v12, 0
    v_dot2_f32_bf16 v25, v77, v13, v25
    v_dot2_f32_bf16 v25, v78, v14, v25
    v_dot2_f32_bf16 v25, v79, v15, v25
    s_waitcnt vmcnt(9)
    buffer_load_dwordx4 v[212:215], v3, s[8:11], s32 offen offset:1024 nt
    buffer_load_dwordx4 a[132:135], v5, s[24:27], s34 offen
    s_add_u32 s34, s34, 32768
    v_accvgpr_read_b32 v72, a248
    v_accvgpr_read_b32 v73, a249
    v_accvgpr_read_b32 v74, a250
    v_accvgpr_read_b32 v75, a251
    v_dot2_f32_bf16 v26, v72, v12, 0
    v_dot2_f32_bf16 v26, v73, v13, v26
    v_dot2_f32_bf16 v26, v74, v14, v26
    v_dot2_f32_bf16 v26, v75, v15, v26
    s_waitcnt vmcnt(9)
    buffer_load_dwordx4 v[216:219], v3, s[8:11], s32 offen offset:2048 nt
    v_accvgpr_read_b32 v76, a252
    v_accvgpr_read_b32 v77, a253
    v_accvgpr_read_b32 v78, a254
    v_accvgpr_read_b32 v79, a255
    v_dot2_f32_bf16 v27, v76, v12, 0
    v_dot2_f32_bf16 v27, v77, v13, v27
    v_dot2_f32_bf16 v27, v78, v14, v27
    v_dot2_f32_bf16 v27, v79, v15, v27
    s_waitcnt vmcnt(9)
    buffer_load_dwordx4 v[220:223], v3, s[8:11], s32 offen offset:3072 nt
    v_add_f32_dpp v24, v24, v24 row_mirror row_mask:0xf bank_mask:0xf
    v_add_f32_dpp v25, v25, v25 row_mirror row_mask:0xf bank_mask:0xf
    s_nop 0
    v_add_f32_dpp v24, v26, v26 row_mirror row_mask:0xf bank_mask:0xc
    v_add_f32_dpp v25, v27, v27 row_mirror row_mask:0xf bank_mask:0xc
    s_nop 0
    v_add_f32_dpp v24, v24, v24 row_half_mirror row_mask:0xf bank_mask:0xf
    s_nop 1
    v_add_f32_dpp v24, v25, v25 row_half_mirror row_mask:0xf bank_mask:0xa
    s_nop 1
    v_add_f32_dpp v24, v24, v24 quad_perm:[1,0,3,2] row_mask:0xf bank_mask:0xf
    s_nop 1
    v_add_f32_dpp v24, v24, v24 quad_perm:[2,3,0,1] row_mask:0xf bank_mask:0xf
    v_cvt_pk_bf16_f32 v24, v24, v24
    v_and_b32 v24, s47, v24
    v_mul_f32 v24, s45, v24
    v_cvt_pk_bf16_f32 v24, v24, v24
    v_and_b32 v111, s47, v24
    ds_write_b64 v116, v[110:111]
    v_max3_f32 v28, v28, v110, v111
    v_add_u32 v116, 512, v116
    buffer_load_dwordx4 a[136:139], v5, s[24:27], s34 offen
    s_add_u32 s34, s34, 32768
    s_add_u32 s32, s32, 32768
    v_dot2_f32_bf16 v20, v224, v12, 0
    v_dot2_f32_bf16 v20, v225, v13, v20
    v_dot2_f32_bf16 v20, v226, v14, v20
    v_dot2_f32_bf16 v20, v227, v15, v20
    s_waitcnt vmcnt(9)
    buffer_load_dwordx4 v[224:227], v2, s[8:11], s32 offen offset:0 nt
    v_dot2_f32_bf16 v21, v228, v12, 0
    v_dot2_f32_bf16 v21, v229, v13, v21
    v_dot2_f32_bf16 v21, v230, v14, v21
    v_dot2_f32_bf16 v21, v231, v15, v21
    s_waitcnt vmcnt(9)
    buffer_load_dwordx4 v[228:231], v2, s[8:11], s32 offen offset:1024 nt
    buffer_load_dwordx4 a[140:143], v5, s[24:27], s34 offen
    s_add_u32 s34, s34, 32768
    v_dot2_f32_bf16 v22, v232, v12, 0
    v_dot2_f32_bf16 v22, v233, v13, v22
    v_dot2_f32_bf16 v22, v234, v14, v22
    v_dot2_f32_bf16 v22, v235, v15, v22
    s_waitcnt vmcnt(9)
    buffer_load_dwordx4 v[232:235], v2, s[8:11], s32 offen offset:2048 nt
    v_dot2_f32_bf16 v23, v236, v12, 0
    v_dot2_f32_bf16 v23, v237, v13, v23
    v_dot2_f32_bf16 v23, v238, v14, v23
    v_dot2_f32_bf16 v23, v239, v15, v23
    s_waitcnt vmcnt(8)
    buffer_load_dwordx4 v[236:239], v2, s[8:11], s32 offen offset:3072 nt
    buffer_load_dwordx4 a[144:147], v5, s[24:27], s34 offen
    s_add_u32 s34, s34, 32768
    v_dot2_f32_bf16 v24, v240, v12, 0
    v_dot2_f32_bf16 v24, v241, v13, v24
    v_dot2_f32_bf16 v24, v242, v14, v24
    v_dot2_f32_bf16 v24, v243, v15, v24
    s_waitcnt vmcnt(8)
    buffer_load_dwordx4 v[240:243], v3, s[8:11], s32 offen offset:0 nt
    v_add_f32_dpp v20, v20, v20 row_mirror row_mask:0xf bank_mask:0xf
    v_add_f32_dpp v21, v21, v21 row_mirror row_mask:0xf bank_mask:0xf
    s_nop 0
    v_add_f32_dpp v20, v22, v22 row_mirror row_mask:0xf bank_mask:0xc
    v_add_f32_dpp v21, v23, v23 row_mirror row_mask:0xf bank_mask:0xc
    s_nop 0
    v_add_f32_dpp v20, v20, v20 row_half_mirror row_mask:0xf bank_mask:0xf
    s_nop 1
    v_add_f32_dpp v20, v21, v21 row_half_mirror row_mask:0xf bank_mask:0xa
    s_nop 1
    v_add_f32_dpp v20, v20, v20 quad_perm:[1,0,3,2] row_mask:0xf bank_mask:0xf
    s_nop 1
    v_add_f32_dpp v20, v20, v20 quad_perm:[2,3,0,1] row_mask:0xf bank_mask:0xf
    v_cvt_pk_bf16_f32 v20, v20, v20
    v_and_b32 v20, s47, v20
    v_mul_f32 v20, s45, v20
    v_cvt_pk_bf16_f32 v20, v20, v20
    v_and_b32 v110, s47, v20
    buffer_load_dwordx4 a[148:151], v5, s[24:27], s34 offen
    s_add_u32 s34, s34, 32768
    v_dot2_f32_bf16 v25, v244, v12, 0
    v_dot2_f32_bf16 v25, v245, v13, v25
    v_dot2_f32_bf16 v25, v246, v14, v25
    v_dot2_f32_bf16 v25, v247, v15, v25
    s_waitcnt vmcnt(9)
    buffer_load_dwordx4 v[244:247], v3, s[8:11], s32 offen offset:1024 nt
    buffer_load_dwordx4 a[152:155], v5, s[24:27], s34 offen
    s_add_u32 s34, s34, 32768
    v_dot2_f32_bf16 v26, v248, v12, 0
    v_dot2_f32_bf16 v26, v249, v13, v26
    v_dot2_f32_bf16 v26, v250, v14, v26
    v_dot2_f32_bf16 v26, v251, v15, v26
    s_waitcnt vmcnt(9)
    buffer_load_dwordx4 v[248:251], v3, s[8:11], s32 offen offset:2048 nt
    v_dot2_f32_bf16 v27, v252, v12, 0
    v_dot2_f32_bf16 v27, v253, v13, v27
    v_dot2_f32_bf16 v27, v254, v14, v27
    v_dot2_f32_bf16 v27, v255, v15, v27
    s_waitcnt vmcnt(9)
    buffer_load_dwordx4 v[252:255], v3, s[8:11], s32 offen offset:3072 nt
    v_add_f32_dpp v24, v24, v24 row_mirror row_mask:0xf bank_mask:0xf
    v_add_f32_dpp v25, v25, v25 row_mirror row_mask:0xf bank_mask:0xf
    s_nop 0
    v_add_f32_dpp v24, v26, v26 row_mirror row_mask:0xf bank_mask:0xc
    v_add_f32_dpp v25, v27, v27 row_mirror row_mask:0xf bank_mask:0xc
    s_nop 0
    v_add_f32_dpp v24, v24, v24 row_half_mirror row_mask:0xf bank_mask:0xf
    s_nop 1
    v_add_f32_dpp v24, v25, v25 row_half_mirror row_mask:0xf bank_mask:0xa
    s_nop 1
    v_add_f32_dpp v24, v24, v24 quad_perm:[1,0,3,2] row_mask:0xf bank_mask:0xf
    s_nop 1
    v_add_f32_dpp v24, v24, v24 quad_perm:[2,3,0,1] row_mask:0xf bank_mask:0xf
    v_cvt_pk_bf16_f32 v24, v24, v24
    v_and_b32 v24, s47, v24
    v_mul_f32 v24, s45, v24
    v_cvt_pk_bf16_f32 v24, v24, v24
    v_and_b32 v111, s47, v24
    ds_write_b64 v116, v[110:111]
    v_max3_f32 v28, v28, v110, v111
    v_add_u32 v116, 512, v116
    buffer_load_dwordx4 a[156:159], v5, s[24:27], s34 offen
    s_add_u32 s34, s34, 32768
    v_max_f32_dpp v28, v28, v28 row_half_mirror row_mask:0xf bank_mask:0xf
    s_nop 1
    v_max_f32_dpp v28, v28, v28 row_mirror row_mask:0xf bank_mask:0xf
    s_nop 1
    v_max_f32_dpp v28, v28, v28 row_bcast:15 row_mask:0xa bank_mask:0xf
    s_nop 1
    v_max_f32_dpp v28, v28, v28 row_bcast:31 row_mask:0xc bank_mask:0xf
    s_nop 0
    v_readlane_b32 s44, v28, 63
    s_waitcnt lgkmcnt(0)
    ds_read_b64 v[34:35], v117
    v_add_u32 v117, 512, v117
    v_mov_b32 v28, s44
    s_add_u32 s32, s32, 32768
    s_waitcnt lgkmcnt(0)
    v_sub_f32 v30, v34, v28
    v_sub_f32 v31, v35, v28
    ds_read_b64 v[34:35], v117
    v_add_u32 v117, 512, v117
    v_mul_f32 v30, s46, v30
    v_mul_f32 v31, s46, v31
    v_exp_f32 v30, v30
    v_exp_f32 v31, v31
    v_cvt_pk_bf16_f32 v32, v30, v30
    v_cvt_pk_bf16_f32 v33, v31, v31
    v_add_f32 v29, v29, v30
    v_add_f32 v29, v29, v31
    v_and_b32_dpp v36, v32, v8 row_newbcast:0 row_mask:0xf bank_mask:0xf
    v_and_b32_dpp v37, v32, v9 row_newbcast:0 row_mask:0xf bank_mask:0xf
    v_and_b32_dpp v38, v32, v10 row_newbcast:0 row_mask:0xf bank_mask:0xf
    v_and_b32_dpp v39, v32, v11 row_newbcast:0 row_mask:0xf bank_mask:0xf
    s_nop 1
    v_mfma_f32_16x16x32_bf16 v[16:19], v[36:39], v[128:131], v[16:19]
    s_waitcnt vmcnt(9)
    buffer_load_dwordx4 v[128:131], v2, s[8:11], s32 offen offset:0 nt
    v_lshl_or_b32 v47, v47, 16, v47
    v_lshl_or_b32 v48, v48, 16, v48
    v_lshl_or_b32 v49, v49, 16, v49
    v_mov_b32 v52, 0
    v_mov_b32 v53, 0
    v_mov_b32 v54, 0
    v_mov_b32 v55, 0
    s_mul_i32 s34, s38, 40960
    v_and_b32_dpp v40, v47, v8 row_newbcast:0 row_mask:0xf bank_mask:0xf
    v_and_b32_dpp v41, v47, v9 row_newbcast:0 row_mask:0xf bank_mask:0xf
    v_and_b32_dpp v42, v47, v10 row_newbcast:0 row_mask:0xf bank_mask:0xf
    v_and_b32_dpp v43, v47, v11 row_newbcast:0 row_mask:0xf bank_mask:0xf
    s_nop 1
    v_mfma_f32_16x16x32_bf16 v[52:55], v[40:43], a[0:3], v[52:55]
    v_and_b32_dpp v36, v32, v8 row_newbcast:4 row_mask:0xf bank_mask:0xf
    v_and_b32_dpp v37, v32, v9 row_newbcast:4 row_mask:0xf bank_mask:0xf
    v_and_b32_dpp v38, v32, v10 row_newbcast:4 row_mask:0xf bank_mask:0xf
    v_and_b32_dpp v39, v32, v11 row_newbcast:4 row_mask:0xf bank_mask:0xf
    s_nop 1
    v_mfma_f32_16x16x32_bf16 v[16:19], v[36:39], v[132:135], v[16:19]
    s_waitcnt vmcnt(9)
    buffer_load_dwordx4 v[132:135], v2, s[8:11], s32 offen offset:1024 nt
    v_and_b32_dpp v40, v47, v8 row_newbcast:1 row_mask:0xf bank_mask:0xf
    v_and_b32_dpp v41, v47, v9 row_newbcast:1 row_mask:0xf bank_mask:0xf
    v_and_b32_dpp v42, v47, v10 row_newbcast:1 row_mask:0xf bank_mask:0xf
    v_and_b32_dpp v43, v47, v11 row_newbcast:1 row_mask:0xf bank_mask:0xf
    s_nop 1
    v_mfma_f32_16x16x32_bf16 v[52:55], v[40:43], a[4:7], v[52:55]
    v_and_b32_dpp v36, v32, v8 row_newbcast:8 row_mask:0xf bank_mask:0xf
    v_and_b32_dpp v37, v32, v9 row_newbcast:8 row_mask:0xf bank_mask:0xf
    v_and_b32_dpp v38, v32, v10 row_newbcast:8 row_mask:0xf bank_mask:0xf
    v_and_b32_dpp v39, v32, v11 row_newbcast:8 row_mask:0xf bank_mask:0xf
    s_nop 1
    v_mfma_f32_16x16x32_bf16 v[16:19], v[36:39], v[136:139], v[16:19]
    s_waitcnt vmcnt(8)
    buffer_load_dwordx4 v[136:139], v2, s[8:11], s32 offen offset:2048 nt
    v_and_b32_dpp v40, v47, v8 row_newbcast:2 row_mask:0xf bank_mask:0xf
    v_and_b32_dpp v41, v47, v9 row_newbcast:2 row_mask:0xf bank_mask:0xf
    v_and_b32_dpp v42, v47, v10 row_newbcast:2 row_mask:0xf bank_mask:0xf
    v_and_b32_dpp v43, v47, v11 row_newbcast:2 row_mask:0xf bank_mask:0xf
    s_nop 1
    v_mfma_f32_16x16x32_bf16 v[52:55], v[40:43], a[8:11], v[52:55]
    v_and_b32_dpp v36, v32, v8 row_newbcast:12 row_mask:0xf bank_mask:0xf
    v_and_b32_dpp v37, v32, v9 row_newbcast:12 row_mask:0xf bank_mask:0xf
    v_and_b32_dpp v38, v32, v10 row_newbcast:12 row_mask:0xf bank_mask:0xf
    v_and_b32_dpp v39, v32, v11 row_newbcast:12 row_mask:0xf bank_mask:0xf
    s_nop 1
    v_mfma_f32_16x16x32_bf16 v[16:19], v[36:39], v[140:143], v[16:19]
    s_waitcnt vmcnt(7)
    buffer_load_dwordx4 v[140:143], v2, s[8:11], s32 offen offset:3072 nt
    v_and_b32_dpp v40, v47, v8 row_newbcast:3 row_mask:0xf bank_mask:0xf
    v_and_b32_dpp v41, v47, v9 row_newbcast:3 row_mask:0xf bank_mask:0xf
    v_and_b32_dpp v42, v47, v10 row_newbcast:3 row_mask:0xf bank_mask:0xf
    v_and_b32_dpp v43, v47, v11 row_newbcast:3 row_mask:0xf bank_mask:0xf
    s_nop 1
    v_mfma_f32_16x16x32_bf16 v[52:55], v[40:43], a[12:15], v[52:55]
    v_and_b32_dpp v36, v33, v8 row_newbcast:0 row_mask:0xf bank_mask:0xf
    v_and_b32_dpp v37, v33, v9 row_newbcast:0 row_mask:0xf bank_mask:0xf
    v_and_b32_dpp v38, v33, v10 row_newbcast:0 row_mask:0xf bank_mask:0xf
    v_and_b32_dpp v39, v33, v11 row_newbcast:0 row_mask:0xf bank_mask:0xf
    s_nop 1
    v_mfma_f32_16x16x32_bf16 v[16:19], v[36:39], v[144:147], v[16:19]
    s_waitcnt vmcnt(6)
    buffer_load_dwordx4 v[144:147], v3, s[8:11], s32 offen offset:0 nt
    v_and_b32_dpp v40, v47, v8 row_newbcast:4 row_mask:0xf bank_mask:0xf
    v_and_b32_dpp v41, v47, v9 row_newbcast:4 row_mask:0xf bank_mask:0xf
    v_and_b32_dpp v42, v47, v10 row_newbcast:4 row_mask:0xf bank_mask:0xf
    v_and_b32_dpp v43, v47, v11 row_newbcast:4 row_mask:0xf bank_mask:0xf
    s_nop 1
    v_mfma_f32_16x16x32_bf16 v[52:55], v[40:43], a[16:19], v[52:55]
    v_and_b32_dpp v36, v33, v8 row_newbcast:4 row_mask:0xf bank_mask:0xf
    v_and_b32_dpp v37, v33, v9 row_newbcast:4 row_mask:0xf bank_mask:0xf
    v_and_b32_dpp v38, v33, v10 row_newbcast:4 row_mask:0xf bank_mask:0xf
    v_and_b32_dpp v39, v33, v11 row_newbcast:4 row_mask:0xf bank_mask:0xf
    s_nop 1
    v_mfma_f32_16x16x32_bf16 v[16:19], v[36:39], v[148:151], v[16:19]
    s_waitcnt vmcnt(6)
    buffer_load_dwordx4 v[148:151], v3, s[8:11], s32 offen offset:1024 nt
    v_and_b32_dpp v40, v47, v8 row_newbcast:5 row_mask:0xf bank_mask:0xf
    v_and_b32_dpp v41, v47, v9 row_newbcast:5 row_mask:0xf bank_mask:0xf
    v_and_b32_dpp v42, v47, v10 row_newbcast:5 row_mask:0xf bank_mask:0xf
    v_and_b32_dpp v43, v47, v11 row_newbcast:5 row_mask:0xf bank_mask:0xf
    s_nop 1
    v_mfma_f32_16x16x32_bf16 v[52:55], v[40:43], a[20:23], v[52:55]
    v_and_b32_dpp v36, v33, v8 row_newbcast:8 row_mask:0xf bank_mask:0xf
    v_and_b32_dpp v37, v33, v9 row_newbcast:8 row_mask:0xf bank_mask:0xf
    v_and_b32_dpp v38, v33, v10 row_newbcast:8 row_mask:0xf bank_mask:0xf
    v_and_b32_dpp v39, v33, v11 row_newbcast:8 row_mask:0xf bank_mask:0xf
    s_nop 1
    v_mfma_f32_16x16x32_bf16 v[16:19], v[36:39], v[152:155], v[16:19]
    s_waitcnt vmcnt(5)
    buffer_load_dwordx4 v[152:155], v3, s[8:11], s32 offen offset:2048 nt
    v_and_b32_dpp v40, v47, v8 row_newbcast:6 row_mask:0xf bank_mask:0xf
    v_and_b32_dpp v41, v47, v9 row_newbcast:6 row_mask:0xf bank_mask:0xf
    v_and_b32_dpp v42, v47, v10 row_newbcast:6 row_mask:0xf bank_mask:0xf
    v_and_b32_dpp v43, v47, v11 row_newbcast:6 row_mask:0xf bank_mask:0xf
    s_nop 1
    v_mfma_f32_16x16x32_bf16 v[52:55], v[40:43], a[24:27], v[52:55]
    v_and_b32_dpp v36, v33, v8 row_newbcast:12 row_mask:0xf bank_mask:0xf
    v_and_b32_dpp v37, v33, v9 row_newbcast:12 row_mask:0xf bank_mask:0xf
    v_and_b32_dpp v38, v33, v10 row_newbcast:12 row_mask:0xf bank_mask:0xf
    v_and_b32_dpp v39, v33, v11 row_newbcast:12 row_mask:0xf bank_mask:0xf
    s_nop 1
    v_mfma_f32_16x16x32_bf16 v[16:19], v[36:39], v[156:159], v[16:19]
    s_waitcnt vmcnt(5)
    buffer_load_dwordx4 v[156:159], v3, s[8:11], s32 offen offset:3072 nt
    v_and_b32_dpp v40, v47, v8 row_newbcast:7 row_mask:0xf bank_mask:0xf
    v_and_b32_dpp v41, v47, v9 row_newbcast:7 row_mask:0xf bank_mask:0xf
    v_and_b32_dpp v42, v47, v10 row_newbcast:7 row_mask:0xf bank_mask:0xf
    v_and_b32_dpp v43, v47, v11 row_newbcast:7 row_mask:0xf bank_mask:0xf
    s_nop 1
    v_mfma_f32_16x16x32_bf16 v[52:55], v[40:43], a[28:31], v[52:55]
    buffer_load_dwordx4 a[0:3], v6, s[28:31], s34 offen offset:0
    buffer_load_dwordx4 a[4:7], v6, s[28:31], s34 offen offset:256
    buffer_load_dwordx4 a[8:11], v6, s[28:31], s34 offen offset:512
    buffer_load_dwordx4 a[12:15], v6, s[28:31], s34 offen offset:768
    buffer_load_dwordx4 a[16:19], v6, s[28:31], s34 offen offset:1024
    s_add_u32 s34, s34, 5120
    s_add_u32 s32, s32, 32768
    s_waitcnt lgkmcnt(0)
    v_sub_f32 v30, v34, v28
    v_sub_f32 v31, v35, v28
    ds_read_b64 v[34:35], v117
    v_add_u32 v117, 512, v117
    v_mul_f32 v30, s46, v30
    v_mul_f32 v31, s46, v31
    v_exp_f32 v30, v30
    v_exp_f32 v31, v31
    v_cvt_pk_bf16_f32 v32, v30, v30
    v_cvt_pk_bf16_f32 v33, v31, v31
    v_add_f32 v29, v29, v30
    v_add_f32 v29, v29, v31
    v_and_b32_dpp v36, v32, v8 row_newbcast:0 row_mask:0xf bank_mask:0xf
    v_and_b32_dpp v37, v32, v9 row_newbcast:0 row_mask:0xf bank_mask:0xf
    v_and_b32_dpp v38, v32, v10 row_newbcast:0 row_mask:0xf bank_mask:0xf
    v_and_b32_dpp v39, v32, v11 row_newbcast:0 row_mask:0xf bank_mask:0xf
    s_nop 1
    v_mfma_f32_16x16x32_bf16 v[16:19], v[36:39], v[160:163], v[16:19]
    s_waitcnt vmcnt(10)
    buffer_load_dwordx4 v[160:163], v2, s[8:11], s32 offen offset:0 nt
    v_and_b32_dpp v40, v47, v8 row_newbcast:8 row_mask:0xf bank_mask:0xf
    v_and_b32_dpp v41, v47, v9 row_newbcast:8 row_mask:0xf bank_mask:0xf
    v_and_b32_dpp v42, v47, v10 row_newbcast:8 row_mask:0xf bank_mask:0xf
    v_and_b32_dpp v43, v47, v11 row_newbcast:8 row_mask:0xf bank_mask:0xf
    s_nop 1
    v_mfma_f32_16x16x32_bf16 v[52:55], v[40:43], a[32:35], v[52:55]
    v_and_b32_dpp v36, v32, v8 row_newbcast:4 row_mask:0xf bank_mask:0xf
    v_and_b32_dpp v37, v32, v9 row_newbcast:4 row_mask:0xf bank_mask:0xf
    v_and_b32_dpp v38, v32, v10 row_newbcast:4 row_mask:0xf bank_mask:0xf
    v_and_b32_dpp v39, v32, v11 row_newbcast:4 row_mask:0xf bank_mask:0xf
    s_nop 1
    v_mfma_f32_16x16x32_bf16 v[16:19], v[36:39], v[164:167], v[16:19]
    s_waitcnt vmcnt(10)
    buffer_load_dwordx4 v[164:167], v2, s[8:11], s32 offen offset:1024 nt
    v_and_b32_dpp v40, v47, v8 row_newbcast:9 row_mask:0xf bank_mask:0xf
    v_and_b32_dpp v41, v47, v9 row_newbcast:9 row_mask:0xf bank_mask:0xf
    v_and_b32_dpp v42, v47, v10 row_newbcast:9 row_mask:0xf bank_mask:0xf
    v_and_b32_dpp v43, v47, v11 row_newbcast:9 row_mask:0xf bank_mask:0xf
    s_nop 1
    v_mfma_f32_16x16x32_bf16 v[52:55], v[40:43], a[36:39], v[52:55]
    buffer_load_dwordx4 a[20:23], v6, s[28:31], s34 offen offset:0
    v_and_b32_dpp v36, v32, v8 row_newbcast:8 row_mask:0xf bank_mask:0xf
    v_and_b32_dpp v37, v32, v9 row_newbcast:8 row_mask:0xf bank_mask:0xf
    v_and_b32_dpp v38, v32, v10 row_newbcast:8 row_mask:0xf bank_mask:0xf
    v_and_b32_dpp v39, v32, v11 row_newbcast:8 row_mask:0xf bank_mask:0xf
    s_nop 1
    v_mfma_f32_16x16x32_bf16 v[16:19], v[36:39], v[168:171], v[16:19]
    s_waitcnt vmcnt(11)
    buffer_load_dwordx4 v[168:171], v2, s[8:11], s32 offen offset:2048 nt
    v_and_b32_dpp v40, v47, v8 row_newbcast:10 row_mask:0xf bank_mask:0xf
    v_and_b32_dpp v41, v47, v9 row_newbcast:10 row_mask:0xf bank_mask:0xf
    v_and_b32_dpp v42, v47, v10 row_newbcast:10 row_mask:0xf bank_mask:0xf
    v_and_b32_dpp v43, v47, v11 row_newbcast:10 row_mask:0xf bank_mask:0xf
    s_nop 1
    v_mfma_f32_16x16x32_bf16 v[52:55], v[40:43], a[40:43], v[52:55]
    v_and_b32_dpp v36, v32, v8 row_newbcast:12 row_mask:0xf bank_mask:0xf
    v_and_b32_dpp v37, v32, v9 row_newbcast:12 row_mask:0xf bank_mask:0xf
    v_and_b32_dpp v38, v32, v10 row_newbcast:12 row_mask:0xf bank_mask:0xf
    v_and_b32_dpp v39, v32, v11 row_newbcast:12 row_mask:0xf bank_mask:0xf
    s_nop 1
    v_mfma_f32_16x16x32_bf16 v[16:19], v[36:39], v[172:175], v[16:19]
    s_waitcnt vmcnt(11)
    buffer_load_dwordx4 v[172:175], v2, s[8:11], s32 offen offset:3072 nt
    v_and_b32_dpp v40, v47, v8 row_newbcast:11 row_mask:0xf bank_mask:0xf
    v_and_b32_dpp v41, v47, v9 row_newbcast:11 row_mask:0xf bank_mask:0xf
    v_and_b32_dpp v42, v47, v10 row_newbcast:11 row_mask:0xf bank_mask:0xf
    v_and_b32_dpp v43, v47, v11 row_newbcast:11 row_mask:0xf bank_mask:0xf
    s_nop 1
    v_mfma_f32_16x16x32_bf16 v[52:55], v[40:43], a[44:47], v[52:55]
    buffer_load_dwordx4 a[24:27], v6, s[28:31], s34 offen offset:256
    v_and_b32_dpp v36, v33, v8 row_newbcast:0 row_mask:0xf bank_mask:0xf
    v_and_b32_dpp v37, v33, v9 row_newbcast:0 row_mask:0xf bank_mask:0xf
    v_and_b32_dpp v38, v33, v10 row_newbcast:0 row_mask:0xf bank_mask:0xf
    v_and_b32_dpp v39, v33, v11 row_newbcast:0 row_mask:0xf bank_mask:0xf
    s_nop 1
    v_mfma_f32_16x16x32_bf16 v[16:19], v[36:39], v[176:179], v[16:19]
    s_waitcnt vmcnt(12)
    buffer_load_dwordx4 v[176:179], v3, s[8:11], s32 offen offset:0 nt
    v_and_b32_dpp v40, v47, v8 row_newbcast:12 row_mask:0xf bank_mask:0xf
    v_and_b32_dpp v41, v47, v9 row_newbcast:12 row_mask:0xf bank_mask:0xf
    v_and_b32_dpp v42, v47, v10 row_newbcast:12 row_mask:0xf bank_mask:0xf
    v_and_b32_dpp v43, v47, v11 row_newbcast:12 row_mask:0xf bank_mask:0xf
    s_nop 1
    v_mfma_f32_16x16x32_bf16 v[52:55], v[40:43], a[48:51], v[52:55]
    buffer_load_dwordx4 a[28:31], v6, s[28:31], s34 offen offset:512
    v_and_b32_dpp v36, v33, v8 row_newbcast:4 row_mask:0xf bank_mask:0xf
    v_and_b32_dpp v37, v33, v9 row_newbcast:4 row_mask:0xf bank_mask:0xf
    v_and_b32_dpp v38, v33, v10 row_newbcast:4 row_mask:0xf bank_mask:0xf
    v_and_b32_dpp v39, v33, v11 row_newbcast:4 row_mask:0xf bank_mask:0xf
    s_nop 1
    v_mfma_f32_16x16x32_bf16 v[16:19], v[36:39], v[180:183], v[16:19]
    s_waitcnt vmcnt(13)
    buffer_load_dwordx4 v[180:183], v3, s[8:11], s32 offen offset:1024 nt
    v_and_b32_dpp v40, v47, v8 row_newbcast:13 row_mask:0xf bank_mask:0xf
    v_and_b32_dpp v41, v47, v9 row_newbcast:13 row_mask:0xf bank_mask:0xf
    v_and_b32_dpp v42, v47, v10 row_newbcast:13 row_mask:0xf bank_mask:0xf
    v_and_b32_dpp v43, v47, v11 row_newbcast:13 row_mask:0xf bank_mask:0xf
    s_nop 1
    v_mfma_f32_16x16x32_bf16 v[52:55], v[40:43], a[52:55], v[52:55]
    buffer_load_dwordx4 a[32:35], v6, s[28:31], s34 offen offset:768
    v_and_b32_dpp v36, v33, v8 row_newbcast:8 row_mask:0xf bank_mask:0xf
    v_and_b32_dpp v37, v33, v9 row_newbcast:8 row_mask:0xf bank_mask:0xf
    v_and_b32_dpp v38, v33, v10 row_newbcast:8 row_mask:0xf bank_mask:0xf
    v_and_b32_dpp v39, v33, v11 row_newbcast:8 row_mask:0xf bank_mask:0xf
    s_nop 1
    v_mfma_f32_16x16x32_bf16 v[16:19], v[36:39], v[184:187], v[16:19]
    s_waitcnt vmcnt(9)
    buffer_load_dwordx4 v[184:187], v3, s[8:11], s32 offen offset:2048 nt
    v_and_b32_dpp v40, v47, v8 row_newbcast:14 row_mask:0xf bank_mask:0xf
    v_and_b32_dpp v41, v47, v9 row_newbcast:14 row_mask:0xf bank_mask:0xf
    v_and_b32_dpp v42, v47, v10 row_newbcast:14 row_mask:0xf bank_mask:0xf
    v_and_b32_dpp v43, v47, v11 row_newbcast:14 row_mask:0xf bank_mask:0xf
    s_nop 1
    v_mfma_f32_16x16x32_bf16 v[52:55], v[40:43], a[56:59], v[52:55]
    v_and_b32_dpp v36, v33, v8 row_newbcast:12 row_mask:0xf bank_mask:0xf
    v_and_b32_dpp v37, v33, v9 row_newbcast:12 row_mask:0xf bank_mask:0xf
    v_and_b32_dpp v38, v33, v10 row_newbcast:12 row_mask:0xf bank_mask:0xf
    v_and_b32_dpp v39, v33, v11 row_newbcast:12 row_mask:0xf bank_mask:0xf
    s_nop 1
    v_mfma_f32_16x16x32_bf16 v[16:19], v[36:39], v[188:191], v[16:19]
    s_waitcnt vmcnt(9)
    buffer_load_dwordx4 v[188:191], v3, s[8:11], s32 offen offset:3072 nt
    v_and_b32_dpp v40, v47, v8 row_newbcast:15 row_mask:0xf bank_mask:0xf
    v_and_b32_dpp v41, v47, v9 row_newbcast:15 row_mask:0xf bank_mask:0xf
    v_and_b32_dpp v42, v47, v10 row_newbcast:15 row_mask:0xf bank_mask:0xf
    v_and_b32_dpp v43, v47, v11 row_newbcast:15 row_mask:0xf bank_mask:0xf
    s_nop 1
    v_mfma_f32_16x16x32_bf16 v[52:55], v[40:43], a[60:63], v[52:55]
    buffer_load_dwordx4 a[36:39], v6, s[28:31], s34 offen offset:1024
    s_add_u32 s34, s34, 5120
    s_add_u32 s32, s32, 32768
    s_waitcnt lgkmcnt(0)
    v_sub_f32 v30, v34, v28
    v_sub_f32 v31, v35, v28
    ds_read_b64 v[34:35], v117
    v_add_u32 v117, 512, v117
    v_mul_f32 v30, s46, v30
    v_mul_f32 v31, s46, v31
    v_exp_f32 v30, v30
    v_exp_f32 v31, v31
    v_cvt_pk_bf16_f32 v32, v30, v30
    v_cvt_pk_bf16_f32 v33, v31, v31
    v_add_f32 v29, v29, v30
    v_add_f32 v29, v29, v31
    v_and_b32_dpp v36, v32, v8 row_newbcast:0 row_mask:0xf bank_mask:0xf
    v_and_b32_dpp v37, v32, v9 row_newbcast:0 row_mask:0xf bank_mask:0xf
    v_and_b32_dpp v38, v32, v10 row_newbcast:0 row_mask:0xf bank_mask:0xf
    v_and_b32_dpp v39, v32, v11 row_newbcast:0 row_mask:0xf bank_mask:0xf
    s_nop 1
    v_mfma_f32_16x16x32_bf16 v[16:19], v[36:39], v[192:195], v[16:19]
    s_waitcnt vmcnt(9)
    buffer_load_dwordx4 v[192:195], v2, s[8:11], s32 offen offset:0 nt
    v_and_b32_dpp v40, v48, v8 row_newbcast:0 row_mask:0xf bank_mask:0xf
    v_and_b32_dpp v41, v48, v9 row_newbcast:0 row_mask:0xf bank_mask:0xf
    v_and_b32_dpp v42, v48, v10 row_newbcast:0 row_mask:0xf bank_mask:0xf
    v_and_b32_dpp v43, v48, v11 row_newbcast:0 row_mask:0xf bank_mask:0xf
    s_nop 1
    v_mfma_f32_16x16x32_bf16 v[52:55], v[40:43], a[64:67], v[52:55]
    v_and_b32_dpp v36, v32, v8 row_newbcast:4 row_mask:0xf bank_mask:0xf
    v_and_b32_dpp v37, v32, v9 row_newbcast:4 row_mask:0xf bank_mask:0xf
    v_and_b32_dpp v38, v32, v10 row_newbcast:4 row_mask:0xf bank_mask:0xf
    v_and_b32_dpp v39, v32, v11 row_newbcast:4 row_mask:0xf bank_mask:0xf
    s_nop 1
    v_mfma_f32_16x16x32_bf16 v[16:19], v[36:39], v[196:199], v[16:19]
    s_waitcnt vmcnt(9)
    buffer_load_dwordx4 v[196:199], v2, s[8:11], s32 offen offset:1024 nt
    v_and_b32_dpp v40, v48, v8 row_newbcast:1 row_mask:0xf bank_mask:0xf
    v_and_b32_dpp v41, v48, v9 row_newbcast:1 row_mask:0xf bank_mask:0xf
    v_and_b32_dpp v42, v48, v10 row_newbcast:1 row_mask:0xf bank_mask:0xf
    v_and_b32_dpp v43, v48, v11 row_newbcast:1 row_mask:0xf bank_mask:0xf
    s_nop 1
    v_mfma_f32_16x16x32_bf16 v[52:55], v[40:43], a[68:71], v[52:55]
    buffer_load_dwordx4 a[40:43], v6, s[28:31], s34 offen offset:0
    v_and_b32_dpp v36, v32, v8 row_newbcast:8 row_mask:0xf bank_mask:0xf
    v_and_b32_dpp v37, v32, v9 row_newbcast:8 row_mask:0xf bank_mask:0xf
    v_and_b32_dpp v38, v32, v10 row_newbcast:8 row_mask:0xf bank_mask:0xf
    v_and_b32_dpp v39, v32, v11 row_newbcast:8 row_mask:0xf bank_mask:0xf
    s_nop 1
    v_mfma_f32_16x16x32_bf16 v[16:19], v[36:39], v[200:203], v[16:19]
    s_waitcnt vmcnt(9)
    buffer_load_dwordx4 v[200:203], v2, s[8:11], s32 offen offset:2048 nt
    v_and_b32_dpp v40, v48, v8 row_newbcast:2 row_mask:0xf bank_mask:0xf
    v_and_b32_dpp v41, v48, v9 row_newbcast:2 row_mask:0xf bank_mask:0xf
    v_and_b32_dpp v42, v48, v10 row_newbcast:2 row_mask:0xf bank_mask:0xf
    v_and_b32_dpp v43, v48, v11 row_newbcast:2 row_mask:0xf bank_mask:0xf
    s_nop 1
    v_mfma_f32_16x16x32_bf16 v[52:55], v[40:43], a[72:75], v[52:55]
    v_and_b32_dpp v36, v32, v8 row_newbcast:12 row_mask:0xf bank_mask:0xf
    v_and_b32_dpp v37, v32, v9 row_newbcast:12 row_mask:0xf bank_mask:0xf
    v_and_b32_dpp v38, v32, v10 row_newbcast:12 row_mask:0xf bank_mask:0xf
    v_and_b32_dpp v39, v32, v11 row_newbcast:12 row_mask:0xf bank_mask:0xf
    s_nop 1
    v_mfma_f32_16x16x32_bf16 v[16:19], v[36:39], v[204:207], v[16:19]
    s_waitcnt vmcnt(8)
    buffer_load_dwordx4 v[204:207], v2, s[8:11], s32 offen offset:3072 nt
    v_and_b32_dpp v40, v48, v8 row_newbcast:3 row_mask:0xf bank_mask:0xf
    v_and_b32_dpp v41, v48, v9 row_newbcast:3 row_mask:0xf bank_mask:0xf
    v_and_b32_dpp v42, v48, v10 row_newbcast:3 row_mask:0xf bank_mask:0xf
    v_and_b32_dpp v43, v48, v11 row_newbcast:3 row_mask:0xf bank_mask:0xf
    s_nop 1
    v_mfma_f32_16x16x32_bf16 v[52:55], v[40:43], a[76:79], v[52:55]
    buffer_load_dwordx4 a[44:47], v6, s[28:31], s34 offen offset:256
    v_and_b32_dpp v36, v33, v8 row_newbcast:0 row_mask:0xf bank_mask:0xf
    v_and_b32_dpp v37, v33, v9 row_newbcast:0 row_mask:0xf bank_mask:0xf
    v_and_b32_dpp v38, v33, v10 row_newbcast:0 row_mask:0xf bank_mask:0xf
    v_and_b32_dpp v39, v33, v11 row_newbcast:0 row_mask:0xf bank_mask:0xf
    s_nop 1
    v_mfma_f32_16x16x32_bf16 v[16:19], v[36:39], v[208:211], v[16:19]
    s_waitcnt vmcnt(8)
    buffer_load_dwordx4 v[208:211], v3, s[8:11], s32 offen offset:0 nt
    v_and_b32_dpp v40, v48, v8 row_newbcast:4 row_mask:0xf bank_mask:0xf
    v_and_b32_dpp v41, v48, v9 row_newbcast:4 row_mask:0xf bank_mask:0xf
    v_and_b32_dpp v42, v48, v10 row_newbcast:4 row_mask:0xf bank_mask:0xf
    v_and_b32_dpp v43, v48, v11 row_newbcast:4 row_mask:0xf bank_mask:0xf
    s_nop 1
    v_mfma_f32_16x16x32_bf16 v[52:55], v[40:43], a[80:83], v[52:55]
    buffer_load_dwordx4 a[48:51], v6, s[28:31], s34 offen offset:512
    v_and_b32_dpp v36, v33, v8 row_newbcast:4 row_mask:0xf bank_mask:0xf
    v_and_b32_dpp v37, v33, v9 row_newbcast:4 row_mask:0xf bank_mask:0xf
    v_and_b32_dpp v38, v33, v10 row_newbcast:4 row_mask:0xf bank_mask:0xf
    v_and_b32_dpp v39, v33, v11 row_newbcast:4 row_mask:0xf bank_mask:0xf
    s_nop 1
    v_mfma_f32_16x16x32_bf16 v[16:19], v[36:39], v[212:215], v[16:19]
    s_waitcnt vmcnt(9)
    buffer_load_dwordx4 v[212:215], v3, s[8:11], s32 offen offset:1024 nt
    v_and_b32_dpp v40, v48, v8 row_newbcast:5 row_mask:0xf bank_mask:0xf
    v_and_b32_dpp v41, v48, v9 row_newbcast:5 row_mask:0xf bank_mask:0xf
    v_and_b32_dpp v42, v48, v10 row_newbcast:5 row_mask:0xf bank_mask:0xf
    v_and_b32_dpp v43, v48, v11 row_newbcast:5 row_mask:0xf bank_mask:0xf
    s_nop 1
    v_mfma_f32_16x16x32_bf16 v[52:55], v[40:43], a[84:87], v[52:55]
    buffer_load_dwordx4 a[52:55], v6, s[28:31], s34 offen offset:768
    v_and_b32_dpp v36, v33, v8 row_newbcast:8 row_mask:0xf bank_mask:0xf
    v_and_b32_dpp v37, v33, v9 row_newbcast:8 row_mask:0xf bank_mask:0xf
    v_and_b32_dpp v38, v33, v10 row_newbcast:8 row_mask:0xf bank_mask:0xf
    v_and_b32_dpp v39, v33, v11 row_newbcast:8 row_mask:0xf bank_mask:0xf
    s_nop 1
    v_mfma_f32_16x16x32_bf16 v[16:19], v[36:39], v[216:219], v[16:19]
    s_waitcnt vmcnt(9)
    buffer_load_dwordx4 v[216:219], v3, s[8:11], s32 offen offset:2048 nt
    v_and_b32_dpp v40, v48, v8 row_newbcast:6 row_mask:0xf bank_mask:0xf
    v_and_b32_dpp v41, v48, v9 row_newbcast:6 row_mask:0xf bank_mask:0xf
    v_and_b32_dpp v42, v48, v10 row_newbcast:6 row_mask:0xf bank_mask:0xf
    v_and_b32_dpp v43, v48, v11 row_newbcast:6 row_mask:0xf bank_mask:0xf
    s_nop 1
    v_mfma_f32_16x16x32_bf16 v[52:55], v[40:43], a[88:91], v[52:55]
    v_and_b32_dpp v36, v33, v8 row_newbcast:12 row_mask:0xf bank_mask:0xf
    v_and_b32_dpp v37, v33, v9 row_newbcast:12 row_mask:0xf bank_mask:0xf
    v_and_b32_dpp v38, v33, v10 row_newbcast:12 row_mask:0xf bank_mask:0xf
    v_and_b32_dpp v39, v33, v11 row_newbcast:12 row_mask:0xf bank_mask:0xf
    s_nop 1
    v_mfma_f32_16x16x32_bf16 v[16:19], v[36:39], v[220:223], v[16:19]
    s_waitcnt vmcnt(9)
    buffer_load_dwordx4 v[220:223], v3, s[8:11], s32 offen offset:3072 nt
    v_and_b32_dpp v40, v48, v8 row_newbcast:7 row_mask:0xf bank_mask:0xf
    v_and_b32_dpp v41, v48, v9 row_newbcast:7 row_mask:0xf bank_mask:0xf
    v_and_b32_dpp v42, v48, v10 row_newbcast:7 row_mask:0xf bank_mask:0xf
    v_and_b32_dpp v43, v48, v11 row_newbcast:7 row_mask:0xf bank_mask:0xf
    s_nop 1
    v_mfma_f32_16x16x32_bf16 v[52:55], v[40:43], a[92:95], v[52:55]
    buffer_load_dwordx4 a[56:59], v6, s[28:31], s34 offen offset:1024
    s_add_u32 s34, s34, 5120
    s_add_u32 s32, s32, 32768
    s_waitcnt lgkmcnt(0)
    v_sub_f32 v30, v34, v28
    v_sub_f32 v31, v35, v28
    ds_read_b64 v[34:35], v117
    v_add_u32 v117, 512, v117
    v_mul_f32 v30, s46, v30
    v_mul_f32 v31, s46, v31
    v_exp_f32 v30, v30
    v_exp_f32 v31, v31
    v_cvt_pk_bf16_f32 v32, v30, v30
    v_cvt_pk_bf16_f32 v33, v31, v31
    v_add_f32 v29, v29, v30
    v_add_f32 v29, v29, v31
    v_and_b32_dpp v36, v32, v8 row_newbcast:0 row_mask:0xf bank_mask:0xf
    v_and_b32_dpp v37, v32, v9 row_newbcast:0 row_mask:0xf bank_mask:0xf
    v_and_b32_dpp v38, v32, v10 row_newbcast:0 row_mask:0xf bank_mask:0xf
    v_and_b32_dpp v39, v32, v11 row_newbcast:0 row_mask:0xf bank_mask:0xf
    s_nop 1
    v_mfma_f32_16x16x32_bf16 v[16:19], v[36:39], v[224:227], v[16:19]
    s_waitcnt vmcnt(9)
    buffer_load_dwordx4 v[224:227], v2, s[8:11], s32 offen offset:0 nt
    v_and_b32_dpp v40, v48, v8 row_newbcast:8 row_mask:0xf bank_mask:0xf
    v_and_b32_dpp v41, v48, v9 row_newbcast:8 row_mask:0xf bank_mask:0xf
    v_and_b32_dpp v42, v48, v10 row_newbcast:8 row_mask:0xf bank_mask:0xf
    v_and_b32_dpp v43, v48, v11 row_newbcast:8 row_mask:0xf bank_mask:0xf
    s_nop 1
    v_mfma_f32_16x16x32_bf16 v[52:55], v[40:43], a[96:99], v[52:55]
    v_and_b32_dpp v36, v32, v8 row_newbcast:4 row_mask:0xf bank_mask:0xf
    v_and_b32_dpp v37, v32, v9 row_newbcast:4 row_mask:0xf bank_mask:0xf
    v_and_b32_dpp v38, v32, v10 row_newbcast:4 row_mask:0xf bank_mask:0xf
    v_and_b32_dpp v39, v32, v11 row_newbcast:4 row_mask:0xf bank_mask:0xf
    s_nop 1
    v_mfma_f32_16x16x32_bf16 v[16:19], v[36:39], v[228:231], v[16:19]
    s_waitcnt vmcnt(9)
    buffer_load_dwordx4 v[228:231], v2, s[8:11], s32 offen offset:1024 nt
    v_and_b32_dpp v40, v48, v8 row_newbcast:9 row_mask:0xf bank_mask:0xf
    v_and_b32_dpp v41, v48, v9 row_newbcast:9 row_mask:0xf bank_mask:0xf
    v_and_b32_dpp v42, v48, v10 row_newbcast:9 row_mask:0xf bank_mask:0xf
    v_and_b32_dpp v43, v48, v11 row_newbcast:9 row_mask:0xf bank_mask:0xf
    s_nop 1
    v_mfma_f32_16x16x32_bf16 v[52:55], v[40:43], a[100:103], v[52:55]
    buffer_load_dwordx4 a[60:63], v6, s[28:31], s34 offen offset:0
    v_and_b32_dpp v36, v32, v8 row_newbcast:8 row_mask:0xf bank_mask:0xf
    v_and_b32_dpp v37, v32, v9 row_newbcast:8 row_mask:0xf bank_mask:0xf
    v_and_b32_dpp v38, v32, v10 row_newbcast:8 row_mask:0xf bank_mask:0xf
    v_and_b32_dpp v39, v32, v11 row_newbcast:8 row_mask:0xf bank_mask:0xf
    s_nop 1
    v_mfma_f32_16x16x32_bf16 v[16:19], v[36:39], v[232:235], v[16:19]
    s_waitcnt vmcnt(9)
    buffer_load_dwordx4 v[232:235], v2, s[8:11], s32 offen offset:2048 nt
    v_and_b32_dpp v40, v48, v8 row_newbcast:10 row_mask:0xf bank_mask:0xf
    v_and_b32_dpp v41, v48, v9 row_newbcast:10 row_mask:0xf bank_mask:0xf
    v_and_b32_dpp v42, v48, v10 row_newbcast:10 row_mask:0xf bank_mask:0xf
    v_and_b32_dpp v43, v48, v11 row_newbcast:10 row_mask:0xf bank_mask:0xf
    s_nop 1
    v_mfma_f32_16x16x32_bf16 v[52:55], v[40:43], a[104:107], v[52:55]
    v_and_b32_dpp v36, v32, v8 row_newbcast:12 row_mask:0xf bank_mask:0xf
    v_and_b32_dpp v37, v32, v9 row_newbcast:12 row_mask:0xf bank_mask:0xf
    v_and_b32_dpp v38, v32, v10 row_newbcast:12 row_mask:0xf bank_mask:0xf
    v_and_b32_dpp v39, v32, v11 row_newbcast:12 row_mask:0xf bank_mask:0xf
    s_nop 1
    v_mfma_f32_16x16x32_bf16 v[16:19], v[36:39], v[236:239], v[16:19]
    s_waitcnt vmcnt(8)
    buffer_load_dwordx4 v[236:239], v2, s[8:11], s32 offen offset:3072 nt
    v_and_b32_dpp v40, v48, v8 row_newbcast:11 row_mask:0xf bank_mask:0xf
    v_and_b32_dpp v41, v48, v9 row_newbcast:11 row_mask:0xf bank_mask:0xf
    v_and_b32_dpp v42, v48, v10 row_newbcast:11 row_mask:0xf bank_mask:0xf
    v_and_b32_dpp v43, v48, v11 row_newbcast:11 row_mask:0xf bank_mask:0xf
    s_nop 1
    v_mfma_f32_16x16x32_bf16 v[52:55], v[40:43], a[108:111], v[52:55]
    buffer_load_dwordx4 a[64:67], v6, s[28:31], s34 offen offset:256
    v_and_b32_dpp v36, v33, v8 row_newbcast:0 row_mask:0xf bank_mask:0xf
    v_and_b32_dpp v37, v33, v9 row_newbcast:0 row_mask:0xf bank_mask:0xf
    v_and_b32_dpp v38, v33, v10 row_newbcast:0 row_mask:0xf bank_mask:0xf
    v_and_b32_dpp v39, v33, v11 row_newbcast:0 row_mask:0xf bank_mask:0xf
    s_nop 1
    v_mfma_f32_16x16x32_bf16 v[16:19], v[36:39], v[240:243], v[16:19]
    s_waitcnt vmcnt(8)
    buffer_load_dwordx4 v[240:243], v3, s[8:11], s32 offen offset:0 nt
    v_and_b32_dpp v40, v48, v8 row_newbcast:12 row_mask:0xf bank_mask:0xf
    v_and_b32_dpp v41, v48, v9 row_newbcast:12 row_mask:0xf bank_mask:0xf
    v_and_b32_dpp v42, v48, v10 row_newbcast:12 row_mask:0xf bank_mask:0xf
    v_and_b32_dpp v43, v48, v11 row_newbcast:12 row_mask:0xf bank_mask:0xf
    s_nop 1
    v_mfma_f32_16x16x32_bf16 v[52:55], v[40:43], a[112:115], v[52:55]
    buffer_load_dwordx4 a[68:71], v6, s[28:31], s34 offen offset:512
    v_and_b32_dpp v36, v33, v8 row_newbcast:4 row_mask:0xf bank_mask:0xf
    v_and_b32_dpp v37, v33, v9 row_newbcast:4 row_mask:0xf bank_mask:0xf
    v_and_b32_dpp v38, v33, v10 row_newbcast:4 row_mask:0xf bank_mask:0xf
    v_and_b32_dpp v39, v33, v11 row_newbcast:4 row_mask:0xf bank_mask:0xf
    s_nop 1
    v_mfma_f32_16x16x32_bf16 v[16:19], v[36:39], v[244:247], v[16:19]
    s_waitcnt vmcnt(9)
    buffer_load_dwordx4 v[244:247], v3, s[8:11], s32 offen offset:1024 nt
    v_and_b32_dpp v40, v48, v8 row_newbcast:13 row_mask:0xf bank_mask:0xf
    v_and_b32_dpp v41, v48, v9 row_newbcast:13 row_mask:0xf bank_mask:0xf
    v_and_b32_dpp v42, v48, v10 row_newbcast:13 row_mask:0xf bank_mask:0xf
    v_and_b32_dpp v43, v48, v11 row_newbcast:13 row_mask:0xf bank_mask:0xf
    s_nop 1
    v_mfma_f32_16x16x32_bf16 v[52:55], v[40:43], a[116:119], v[52:55]
    buffer_load_dwordx4 a[72:75], v6, s[28:31], s34 offen offset:768
    v_and_b32_dpp v36, v33, v8 row_newbcast:8 row_mask:0xf bank_mask:0xf
    v_and_b32_dpp v37, v33, v9 row_newbcast:8 row_mask:0xf bank_mask:0xf
    v_and_b32_dpp v38, v33, v10 row_newbcast:8 row_mask:0xf bank_mask:0xf
    v_and_b32_dpp v39, v33, v11 row_newbcast:8 row_mask:0xf bank_mask:0xf
    s_nop 1
    v_mfma_f32_16x16x32_bf16 v[16:19], v[36:39], v[248:251], v[16:19]
    s_waitcnt vmcnt(9)
    buffer_load_dwordx4 v[248:251], v3, s[8:11], s32 offen offset:2048 nt
    v_and_b32_dpp v40, v48, v8 row_newbcast:14 row_mask:0xf bank_mask:0xf
    v_and_b32_dpp v41, v48, v9 row_newbcast:14 row_mask:0xf bank_mask:0xf
    v_and_b32_dpp v42, v48, v10 row_newbcast:14 row_mask:0xf bank_mask:0xf
    v_and_b32_dpp v43, v48, v11 row_newbcast:14 row_mask:0xf bank_mask:0xf
    s_nop 1
    v_mfma_f32_16x16x32_bf16 v[52:55], v[40:43], a[120:123], v[52:55]
    v_and_b32_dpp v36, v33, v8 row_newbcast:12 row_mask:0xf bank_mask:0xf
    v_and_b32_dpp v37, v33, v9 row_newbcast:12 row_mask:0xf bank_mask:0xf
    v_and_b32_dpp v38, v33, v10 row_newbcast:12 row_mask:0xf bank_mask:0xf
    v_and_b32_dpp v39, v33, v11 row_newbcast:12 row_mask:0xf bank_mask:0xf
    s_nop 1
    v_mfma_f32_16x16x32_bf16 v[16:19], v[36:39], v[252:255], v[16:19]
    s_waitcnt vmcnt(9)
    buffer_load_dwordx4 v[252:255], v3, s[8:11], s32 offen offset:3072 nt
    v_and_b32_dpp v40, v48, v8 row_newbcast:15 row_mask:0xf bank_mask:0xf
    v_and_b32_dpp v41, v48, v9 row_newbcast:15 row_mask:0xf bank_mask:0xf
    v_and_b32_dpp v42, v48, v10 row_newbcast:15 row_mask:0xf bank_mask:0xf
    v_and_b32_dpp v43, v48, v11 row_newbcast:15 row_mask:0xf bank_mask:0xf
    s_nop 1
    v_mfma_f32_16x16x32_bf16 v[52:55], v[40:43], a[124:127], v[52:55]
    buffer_load_dwordx4 a[76:79], v6, s[28:31], s34 offen offset:1024
    s_add_u32 s34, s34, 5120
    s_mov_b32 s8, s16
    s_mov_b32 s9, s17
    s_mov_b32 s10, s18
    s_mov_b32 s32, s41
    s_waitcnt lgkmcnt(0)
    v_sub_f32 v30, v34, v28
    v_sub_f32 v31, v35, v28
    ds_read_b64 v[34:35], v117
    v_add_u32 v117, 512, v117
    v_mul_f32 v30, s46, v30
    v_mul_f32 v31, s46, v31
    v_exp_f32 v30, v30
    v_exp_f32 v31, v31
    v_cvt_pk_bf16_f32 v32, v30, v30
    v_cvt_pk_bf16_f32 v33, v31, v31
    v_add_f32 v29, v29, v30
    v_add_f32 v29, v29, v31
    v_and_b32_dpp v36, v32, v8 row_newbcast:0 row_mask:0xf bank_mask:0xf
    v_and_b32_dpp v37, v32, v9 row_newbcast:0 row_mask:0xf bank_mask:0xf
    v_and_b32_dpp v38, v32, v10 row_newbcast:0 row_mask:0xf bank_mask:0xf
    v_and_b32_dpp v39, v32, v11 row_newbcast:0 row_mask:0xf bank_mask:0xf
    s_nop 1
    v_mfma_f32_16x16x32_bf16 v[16:19], v[36:39], v[128:131], v[16:19]
    s_waitcnt vmcnt(9)
    buffer_load_dwordx4 v[128:131], v2, s[8:11], s32 offen offset:0 nt
    v_and_b32_dpp v40, v49, v8 row_newbcast:0 row_mask:0xf bank_mask:0xf
    v_and_b32_dpp v41, v49, v9 row_newbcast:0 row_mask:0xf bank_mask:0xf
    v_and_b32_dpp v42, v49, v10 row_newbcast:0 row_mask:0xf bank_mask:0xf
    v_and_b32_dpp v43, v49, v11 row_newbcast:0 row_mask:0xf bank_mask:0xf
    s_nop 1
    v_mfma_f32_16x16x32_bf16 v[52:55], v[40:43], a[128:131], v[52:55]
    v_and_b32_dpp v36, v32, v8 row_newbcast:4 row_mask:0xf bank_mask:0xf
    v_and_b32_dpp v37, v32, v9 row_newbcast:4 row_mask:0xf bank_mask:0xf
    v_and_b32_dpp v38, v32, v10 row_newbcast:4 row_mask:0xf bank_mask:0xf
    v_and_b32_dpp v39, v32, v11 row_newbcast:4 row_mask:0xf bank_mask:0xf
    s_nop 1
    v_mfma_f32_16x16x32_bf16 v[16:19], v[36:39], v[132:135], v[16:19]
    s_waitcnt vmcnt(9)
    buffer_load_dwordx4 v[132:135], v2, s[8:11], s32 offen offset:1024 nt
    v_and_b32_dpp v40, v49, v8 row_newbcast:1 row_mask:0xf bank_mask:0xf
    v_and_b32_dpp v41, v49, v9 row_newbcast:1 row_mask:0xf bank_mask:0xf
    v_and_b32_dpp v42, v49, v10 row_newbcast:1 row_mask:0xf bank_mask:0xf
    v_and_b32_dpp v43, v49, v11 row_newbcast:1 row_mask:0xf bank_mask:0xf
    s_nop 1
    v_mfma_f32_16x16x32_bf16 v[52:55], v[40:43], a[132:135], v[52:55]
    buffer_load_dwordx4 a[80:83], v6, s[28:31], s34 offen offset:0
    v_and_b32_dpp v36, v32, v8 row_newbcast:8 row_mask:0xf bank_mask:0xf
    v_and_b32_dpp v37, v32, v9 row_newbcast:8 row_mask:0xf bank_mask:0xf
    v_and_b32_dpp v38, v32, v10 row_newbcast:8 row_mask:0xf bank_mask:0xf
    v_and_b32_dpp v39, v32, v11 row_newbcast:8 row_mask:0xf bank_mask:0xf
    s_nop 1
    v_mfma_f32_16x16x32_bf16 v[16:19], v[36:39], v[136:139], v[16:19]
    s_waitcnt vmcnt(9)
    buffer_load_dwordx4 v[136:139], v2, s[8:11], s32 offen offset:2048 nt
    v_and_b32_dpp v40, v49, v8 row_newbcast:2 row_mask:0xf bank_mask:0xf
    v_and_b32_dpp v41, v49, v9 row_newbcast:2 row_mask:0xf bank_mask:0xf
    v_and_b32_dpp v42, v49, v10 row_newbcast:2 row_mask:0xf bank_mask:0xf
    v_and_b32_dpp v43, v49, v11 row_newbcast:2 row_mask:0xf bank_mask:0xf
    s_nop 1
    v_mfma_f32_16x16x32_bf16 v[52:55], v[40:43], a[136:139], v[52:55]
    v_and_b32_dpp v36, v32, v8 row_newbcast:12 row_mask:0xf bank_mask:0xf
    v_and_b32_dpp v37, v32, v9 row_newbcast:12 row_mask:0xf bank_mask:0xf
    v_and_b32_dpp v38, v32, v10 row_newbcast:12 row_mask:0xf bank_mask:0xf
    v_and_b32_dpp v39, v32, v11 row_newbcast:12 row_mask:0xf bank_mask:0xf
    s_nop 1
    v_mfma_f32_16x16x32_bf16 v[16:19], v[36:39], v[140:143], v[16:19]
    s_waitcnt vmcnt(8)
    buffer_load_dwordx4 v[140:143], v2, s[8:11], s32 offen offset:3072 nt
    v_and_b32_dpp v40, v49, v8 row_newbcast:3 row_mask:0xf bank_mask:0xf
    v_and_b32_dpp v41, v49, v9 row_newbcast:3 row_mask:0xf bank_mask:0xf
    v_and_b32_dpp v42, v49, v10 row_newbcast:3 row_mask:0xf bank_mask:0xf
    v_and_b32_dpp v43, v49, v11 row_newbcast:3 row_mask:0xf bank_mask:0xf
    s_nop 1
    v_mfma_f32_16x16x32_bf16 v[52:55], v[40:43], a[140:143], v[52:55]
    buffer_load_dwordx4 a[84:87], v6, s[28:31], s34 offen offset:256
    v_and_b32_dpp v36, v33, v8 row_newbcast:0 row_mask:0xf bank_mask:0xf
    v_and_b32_dpp v37, v33, v9 row_newbcast:0 row_mask:0xf bank_mask:0xf
    v_and_b32_dpp v38, v33, v10 row_newbcast:0 row_mask:0xf bank_mask:0xf
    v_and_b32_dpp v39, v33, v11 row_newbcast:0 row_mask:0xf bank_mask:0xf
    s_nop 1
    v_mfma_f32_16x16x32_bf16 v[16:19], v[36:39], v[144:147], v[16:19]
    s_waitcnt vmcnt(8)
    buffer_load_dwordx4 v[144:147], v3, s[8:11], s32 offen offset:0 nt
    v_and_b32_dpp v40, v49, v8 row_newbcast:4 row_mask:0xf bank_mask:0xf
    v_and_b32_dpp v41, v49, v9 row_newbcast:4 row_mask:0xf bank_mask:0xf
    v_and_b32_dpp v42, v49, v10 row_newbcast:4 row_mask:0xf bank_mask:0xf
    v_and_b32_dpp v43, v49, v11 row_newbcast:4 row_mask:0xf bank_mask:0xf
    s_nop 1
    v_mfma_f32_16x16x32_bf16 v[52:55], v[40:43], a[144:147], v[52:55]
    buffer_load_dwordx4 a[88:91], v6, s[28:31], s34 offen offset:512
    v_and_b32_dpp v36, v33, v8 row_newbcast:4 row_mask:0xf bank_mask:0xf
    v_and_b32_dpp v37, v33, v9 row_newbcast:4 row_mask:0xf bank_mask:0xf
    v_and_b32_dpp v38, v33, v10 row_newbcast:4 row_mask:0xf bank_mask:0xf
    v_and_b32_dpp v39, v33, v11 row_newbcast:4 row_mask:0xf bank_mask:0xf
    s_nop 1
    v_mfma_f32_16x16x32_bf16 v[16:19], v[36:39], v[148:151], v[16:19]
    s_waitcnt vmcnt(9)
    buffer_load_dwordx4 v[148:151], v3, s[8:11], s32 offen offset:1024 nt
    v_and_b32_dpp v40, v49, v8 row_newbcast:5 row_mask:0xf bank_mask:0xf
    v_and_b32_dpp v41, v49, v9 row_newbcast:5 row_mask:0xf bank_mask:0xf
    v_and_b32_dpp v42, v49, v10 row_newbcast:5 row_mask:0xf bank_mask:0xf
    v_and_b32_dpp v43, v49, v11 row_newbcast:5 row_mask:0xf bank_mask:0xf
    s_nop 1
    v_mfma_f32_16x16x32_bf16 v[52:55], v[40:43], a[148:151], v[52:55]
    buffer_load_dwordx4 a[92:95], v6, s[28:31], s34 offen offset:768
    v_and_b32_dpp v36, v33, v8 row_newbcast:8 row_mask:0xf bank_mask:0xf
    v_and_b32_dpp v37, v33, v9 row_newbcast:8 row_mask:0xf bank_mask:0xf
    v_and_b32_dpp v38, v33, v10 row_newbcast:8 row_mask:0xf bank_mask:0xf
    v_and_b32_dpp v39, v33, v11 row_newbcast:8 row_mask:0xf bank_mask:0xf
    s_nop 1
    v_mfma_f32_16x16x32_bf16 v[16:19], v[36:39], v[152:155], v[16:19]
    s_waitcnt vmcnt(9)
    buffer_load_dwordx4 v[152:155], v3, s[8:11], s32 offen offset:2048 nt
    v_and_b32_dpp v40, v49, v8 row_newbcast:6 row_mask:0xf bank_mask:0xf
    v_and_b32_dpp v41, v49, v9 row_newbcast:6 row_mask:0xf bank_mask:0xf
    v_and_b32_dpp v42, v49, v10 row_newbcast:6 row_mask:0xf bank_mask:0xf
    v_and_b32_dpp v43, v49, v11 row_newbcast:6 row_mask:0xf bank_mask:0xf
    s_nop 1
    v_mfma_f32_16x16x32_bf16 v[52:55], v[40:43], a[152:155], v[52:55]
    v_and_b32_dpp v36, v33, v8 row_newbcast:12 row_mask:0xf bank_mask:0xf
    v_and_b32_dpp v37, v33, v9 row_newbcast:12 row_mask:0xf bank_mask:0xf
    v_and_b32_dpp v38, v33, v10 row_newbcast:12 row_mask:0xf bank_mask:0xf
    v_and_b32_dpp v39, v33, v11 row_newbcast:12 row_mask:0xf bank_mask:0xf
    s_nop 1
    v_mfma_f32_16x16x32_bf16 v[16:19], v[36:39], v[156:159], v[16:19]
    s_waitcnt vmcnt(9)
    buffer_load_dwordx4 v[156:159], v3, s[8:11], s32 offen offset:3072 nt
    v_and_b32_dpp v40, v49, v8 row_newbcast:7 row_mask:0xf bank_mask:0xf
    v_and_b32_dpp v41, v49, v9 row_newbcast:7 row_mask:0xf bank_mask:0xf
    v_and_b32_dpp v42, v49, v10 row_newbcast:7 row_mask:0xf bank_mask:0xf
    v_and_b32_dpp v43, v49, v11 row_newbcast:7 row_mask:0xf bank_mask:0xf
    s_nop 1
    v_mfma_f32_16x16x32_bf16 v[52:55], v[40:43], a[156:159], v[52:55]
    buffer_load_dwordx4 a[96:99], v6, s[28:31], s34 offen offset:1024
    s_add_u32 s34, s34, 5120
    s_add_u32 s32, s32, 32768
    s_waitcnt lgkmcnt(0)
    v_sub_f32 v30, v34, v28
    v_sub_f32 v31, v35, v28
    ds_read_b64 v[34:35], v117
    v_add_u32 v117, 512, v117
    v_mul_f32 v30, s46, v30
    v_mul_f32 v31, s46, v31
    v_exp_f32 v30, v30
    v_exp_f32 v31, v31
    v_cvt_pk_bf16_f32 v32, v30, v30
    v_cvt_pk_bf16_f32 v33, v31, v31
    v_add_f32 v29, v29, v30
    v_add_f32 v29, v29, v31
    v_and_b32_dpp v36, v32, v8 row_newbcast:0 row_mask:0xf bank_mask:0xf
    v_and_b32_dpp v37, v32, v9 row_newbcast:0 row_mask:0xf bank_mask:0xf
    v_and_b32_dpp v38, v32, v10 row_newbcast:0 row_mask:0xf bank_mask:0xf
    v_and_b32_dpp v39, v32, v11 row_newbcast:0 row_mask:0xf bank_mask:0xf
    s_nop 1
    v_mfma_f32_16x16x32_bf16 v[16:19], v[36:39], v[160:163], v[16:19]
    s_waitcnt vmcnt(9)
    buffer_load_dwordx4 v[160:163], v2, s[8:11], s32 offen offset:0 nt
    s_mov_b32 exec_hi, 0
    ds_write_b128 v51, v[52:55] offset:2048
    s_mov_b64 exec, -1
    v_and_b32_dpp v40, v32, v8 row_newbcast:4 row_mask:0xf bank_mask:0xf
    v_and_b32_dpp v41, v32, v9 row_newbcast:4 row_mask:0xf bank_mask:0xf
    v_and_b32_dpp v42, v32, v10 row_newbcast:4 row_mask:0xf bank_mask:0xf
    v_and_b32_dpp v43, v32, v11 row_newbcast:4 row_mask:0xf bank_mask:0xf
    s_nop 1
    v_mfma_f32_16x16x32_bf16 v[16:19], v[40:43], v[164:167], v[16:19]
    s_waitcnt vmcnt(9)
    buffer_load_dwordx4 v[164:167], v2, s[8:11], s32 offen offset:1024 nt
    buffer_load_dwordx4 a[100:103], v6, s[28:31], s34 offen offset:0
    v_and_b32_dpp v36, v32, v8 row_newbcast:8 row_mask:0xf bank_mask:0xf
    v_and_b32_dpp v37, v32, v9 row_newbcast:8 row_mask:0xf bank_mask:0xf
    v_and_b32_dpp v38, v32, v10 row_newbcast:8 row_mask:0xf bank_mask:0xf
    v_and_b32_dpp v39, v32, v11 row_newbcast:8 row_mask:0xf bank_mask:0xf
    s_nop 1
    v_mfma_f32_16x16x32_bf16 v[16:19], v[36:39], v[168:171], v[16:19]
    s_waitcnt vmcnt(9)
    buffer_load_dwordx4 v[168:171], v2, s[8:11], s32 offen offset:2048 nt
    v_and_b32_dpp v40, v32, v8 row_newbcast:12 row_mask:0xf bank_mask:0xf
    v_and_b32_dpp v41, v32, v9 row_newbcast:12 row_mask:0xf bank_mask:0xf
    v_and_b32_dpp v42, v32, v10 row_newbcast:12 row_mask:0xf bank_mask:0xf
    v_and_b32_dpp v43, v32, v11 row_newbcast:12 row_mask:0xf bank_mask:0xf
    s_nop 1
    v_mfma_f32_16x16x32_bf16 v[16:19], v[40:43], v[172:175], v[16:19]
    s_waitcnt vmcnt(8)
    buffer_load_dwordx4 v[172:175], v2, s[8:11], s32 offen offset:3072 nt
    buffer_load_dwordx4 a[104:107], v6, s[28:31], s34 offen offset:256
    v_and_b32_dpp v36, v33, v8 row_newbcast:0 row_mask:0xf bank_mask:0xf
    v_and_b32_dpp v37, v33, v9 row_newbcast:0 row_mask:0xf bank_mask:0xf
    v_and_b32_dpp v38, v33, v10 row_newbcast:0 row_mask:0xf bank_mask:0xf
    v_and_b32_dpp v39, v33, v11 row_newbcast:0 row_mask:0xf bank_mask:0xf
    s_nop 1
    v_mfma_f32_16x16x32_bf16 v[16:19], v[36:39], v[176:179], v[16:19]
    s_waitcnt vmcnt(8)
    buffer_load_dwordx4 v[176:179], v3, s[8:11], s32 offen offset:0 nt
    buffer_load_dwordx4 a[108:111], v6, s[28:31], s34 offen offset:512
    v_and_b32_dpp v40, v33, v8 row_newbcast:4 row_mask:0xf bank_mask:0xf
    v_and_b32_dpp v41, v33, v9 row_newbcast:4 row_mask:0xf bank_mask:0xf
    v_and_b32_dpp v42, v33, v10 row_newbcast:4 row_mask:0xf bank_mask:0xf
    v_and_b32_dpp v43, v33, v11 row_newbcast:4 row_mask:0xf bank_mask:0xf
    s_nop 1
    v_mfma_f32_16x16x32_bf16 v[16:19], v[40:43], v[180:183], v[16:19]
    s_waitcnt vmcnt(9)
    buffer_load_dwordx4 v[180:183], v3, s[8:11], s32 offen offset:1024 nt
    buffer_load_dwordx4 a[112:115], v6, s[28:31], s34 offen offset:768
    v_and_b32_dpp v36, v33, v8 row_newbcast:8 row_mask:0xf bank_mask:0xf
    v_and_b32_dpp v37, v33, v9 row_newbcast:8 row_mask:0xf bank_mask:0xf
    v_and_b32_dpp v38, v33, v10 row_newbcast:8 row_mask:0xf bank_mask:0xf
    v_and_b32_dpp v39, v33, v11 row_newbcast:8 row_mask:0xf bank_mask:0xf
    s_nop 1
    v_mfma_f32_16x16x32_bf16 v[16:19], v[36:39], v[184:187], v[16:19]
    s_waitcnt vmcnt(9)
    buffer_load_dwordx4 v[184:187], v3, s[8:11], s32 offen offset:2048 nt
    v_and_b32_dpp v40, v33, v8 row_newbcast:12 row_mask:0xf bank_mask:0xf
    v_and_b32_dpp v41, v33, v9 row_newbcast:12 row_mask:0xf bank_mask:0xf
    v_and_b32_dpp v42, v33, v10 row_newbcast:12 row_mask:0xf bank_mask:0xf
    v_and_b32_dpp v43, v33, v11 row_newbcast:12 row_mask:0xf bank_mask:0xf
    s_nop 1
    v_mfma_f32_16x16x32_bf16 v[16:19], v[40:43], v[188:191], v[16:19]
    s_waitcnt vmcnt(9)
    buffer_load_dwordx4 v[188:191], v3, s[8:11], s32 offen offset:3072 nt
    buffer_load_dwordx4 a[116:119], v6, s[28:31], s34 offen offset:1024
    s_add_u32 s34, s34, 5120
    s_add_u32 s32, s32, 32768
    s_waitcnt lgkmcnt(0)
    v_sub_f32 v30, v34, v28
    v_sub_f32 v31, v35, v28
    ds_read_b64 v[34:35], v117
    v_add_u32 v117, 512, v117
    v_mul_f32 v30, s46, v30
    v_mul_f32 v31, s46, v31
    v_exp_f32 v30, v30
    v_exp_f32 v31, v31
    v_cvt_pk_bf16_f32 v32, v30, v30
    v_cvt_pk_bf16_f32 v33, v31, v31
    v_add_f32 v29, v29, v30
    v_add_f32 v29, v29, v31
    v_and_b32_dpp v36, v32, v8 row_newbcast:0 row_mask:0xf bank_mask:0xf
    v_and_b32_dpp v37, v32, v9 row_newbcast:0 row_mask:0xf bank_mask:0xf
    v_and_b32_dpp v38, v32, v10 row_newbcast:0 row_mask:0xf bank_mask:0xf
    v_and_b32_dpp v39, v32, v11 row_newbcast:0 row_mask:0xf bank_mask:0xf
    s_nop 1
    v_mfma_f32_16x16x32_bf16 v[16:19], v[36:39], v[192:195], v[16:19]
    s_waitcnt vmcnt(9)
    buffer_load_dwordx4 v[192:195], v2, s[8:11], s32 offen offset:0 nt
    s_waitcnt lgkmcnt(0)
    s_barrier
    ds_read_b128 v[72:75], v106 offset:2048
    ds_read_b128 v[76:79], v106 offset:2064
    ds_read_b128 v[80:83], v106 offset:2560
    ds_read_b128 v[84:87], v106 offset:2576
    ds_read_b128 v[88:91], v106 offset:3072
    ds_read_b128 v[92:95], v106 offset:3088
    ds_read_b128 v[96:99], v106 offset:3584
    ds_read_b128 v[100:103], v106 offset:3600
    v_and_b32_dpp v40, v32, v8 row_newbcast:4 row_mask:0xf bank_mask:0xf
    v_and_b32_dpp v41, v32, v9 row_newbcast:4 row_mask:0xf bank_mask:0xf
    v_and_b32_dpp v42, v32, v10 row_newbcast:4 row_mask:0xf bank_mask:0xf
    v_and_b32_dpp v43, v32, v11 row_newbcast:4 row_mask:0xf bank_mask:0xf
    s_nop 1
    v_mfma_f32_16x16x32_bf16 v[16:19], v[40:43], v[196:199], v[16:19]
    s_waitcnt vmcnt(9)
    buffer_load_dwordx4 v[196:199], v2, s[8:11], s32 offen offset:1024 nt
    buffer_load_dwordx4 a[120:123], v6, s[28:31], s34 offen offset:0
    v_and_b32_dpp v36, v32, v8 row_newbcast:8 row_mask:0xf bank_mask:0xf
    v_and_b32_dpp v37, v32, v9 row_newbcast:8 row_mask:0xf bank_mask:0xf
    v_and_b32_dpp v38, v32, v10 row_newbcast:8 row_mask:0xf bank_mask:0xf
    v_and_b32_dpp v39, v32, v11 row_newbcast:8 row_mask:0xf bank_mask:0xf
    s_nop 1
    v_mfma_f32_16x16x32_bf16 v[16:19], v[36:39], v[200:203], v[16:19]
    s_waitcnt vmcnt(9)
    buffer_load_dwordx4 v[200:203], v2, s[8:11], s32 offen offset:2048 nt
    s_waitcnt lgkmcnt(0)
    v_add_f32 v72, v72, v80
    v_add_f32 v73, v73, v81
    v_add_f32 v74, v74, v82
    v_add_f32 v75, v75, v83
    v_add_f32 v76, v76, v84
    v_add_f32 v77, v77, v85
    v_add_f32 v78, v78, v86
    v_add_f32 v79, v79, v87
    v_add_f32 v72, v72, v88
    v_add_f32 v73, v73, v89
    v_add_f32 v74, v74, v90
    v_add_f32 v75, v75, v91
    v_add_f32 v76, v76, v92
    v_add_f32 v77, v77, v93
    v_add_f32 v78, v78, v94
    v_add_f32 v79, v79, v95
    v_add_f32 v72, v72, v96
    v_add_f32 v73, v73, v97
    v_add_f32 v74, v74, v98
    v_add_f32 v75, v75, v99
    v_add_f32 v76, v76, v100
    v_add_f32 v77, v77, v101
    v_add_f32 v78, v78, v102
    v_add_f32 v79, v79, v103
    v_cvt_pk_bf16_f32 v112, v72, v73
    v_cvt_pk_bf16_f32 v113, v74, v75
    v_cvt_pk_bf16_f32 v114, v76, v77
    v_cvt_pk_bf16_f32 v115, v78, v79
    v_and_b32_dpp v40, v32, v8 row_newbcast:12 row_mask:0xf bank_mask:0xf
    v_and_b32_dpp v41, v32, v9 row_newbcast:12 row_mask:0xf bank_mask:0xf
    v_and_b32_dpp v42, v32, v10 row_newbcast:12 row_mask:0xf bank_mask:0xf
    v_and_b32_dpp v43, v32, v11 row_newbcast:12 row_mask:0xf bank_mask:0xf
    s_nop 1
    v_mfma_f32_16x16x32_bf16 v[16:19], v[40:43], v[204:207], v[16:19]
    s_waitcnt vmcnt(8)
    buffer_load_dwordx4 v[204:207], v2, s[8:11], s32 offen offset:3072 nt
    buffer_load_dwordx4 a[124:127], v6, s[28:31], s34 offen offset:256
    v_and_b32_dpp v36, v33, v8 row_newbcast:0 row_mask:0xf bank_mask:0xf
    v_and_b32_dpp v37, v33, v9 row_newbcast:0 row_mask:0xf bank_mask:0xf
    v_and_b32_dpp v38, v33, v10 row_newbcast:0 row_mask:0xf bank_mask:0xf
    v_and_b32_dpp v39, v33, v11 row_newbcast:0 row_mask:0xf bank_mask:0xf
    s_nop 1
    v_mfma_f32_16x16x32_bf16 v[16:19], v[36:39], v[208:211], v[16:19]
    s_waitcnt vmcnt(8)
    buffer_load_dwordx4 v[208:211], v3, s[8:11], s32 offen offset:0 nt
    buffer_load_dwordx4 a[128:131], v6, s[28:31], s34 offen offset:512
    v_and_b32_dpp v40, v33, v8 row_newbcast:4 row_mask:0xf bank_mask:0xf
    v_and_b32_dpp v41, v33, v9 row_newbcast:4 row_mask:0xf bank_mask:0xf
    v_and_b32_dpp v42, v33, v10 row_newbcast:4 row_mask:0xf bank_mask:0xf
    v_and_b32_dpp v43, v33, v11 row_newbcast:4 row_mask:0xf bank_mask:0xf
    s_nop 1
    v_mfma_f32_16x16x32_bf16 v[16:19], v[40:43], v[212:215], v[16:19]
    s_waitcnt vmcnt(9)
    buffer_load_dwordx4 v[212:215], v3, s[8:11], s32 offen offset:1024 nt
    buffer_load_dwordx4 a[132:135], v6, s[28:31], s34 offen offset:768
    v_and_b32_dpp v36, v33, v8 row_newbcast:8 row_mask:0xf bank_mask:0xf
    v_and_b32_dpp v37, v33, v9 row_newbcast:8 row_mask:0xf bank_mask:0xf
    v_and_b32_dpp v38, v33, v10 row_newbcast:8 row_mask:0xf bank_mask:0xf
    v_and_b32_dpp v39, v33, v11 row_newbcast:8 row_mask:0xf bank_mask:0xf
    s_nop 1
    v_mfma_f32_16x16x32_bf16 v[16:19], v[36:39], v[216:219], v[16:19]
    s_waitcnt vmcnt(9)
    buffer_load_dwordx4 v[216:219], v3, s[8:11], s32 offen offset:2048 nt
    v_and_b32_dpp v40, v33, v8 row_newbcast:12 row_mask:0xf bank_mask:0xf
    v_and_b32_dpp v41, v33, v9 row_newbcast:12 row_mask:0xf bank_mask:0xf
    v_and_b32_dpp v42, v33, v10 row_newbcast:12 row_mask:0xf bank_mask:0xf
    v_and_b32_dpp v43, v33, v11 row_newbcast:12 row_mask:0xf bank_mask:0xf
    s_nop 1
    v_mfma_f32_16x16x32_bf16 v[16:19], v[40:43], v[220:223], v[16:19]
    s_waitcnt vmcnt(9)
    buffer_load_dwordx4 v[220:223], v3, s[8:11], s32 offen offset:3072 nt
    buffer_load_dwordx4 a[136:139], v6, s[28:31], s34 offen offset:1024
    s_add_u32 s34, s34, 5120
    s_add_u32 s32, s32, 32768
    s_waitcnt lgkmcnt(0)
    v_sub_f32 v30, v34, v28
    v_sub_f32 v31, v35, v28
    v_mul_f32 v30, s46, v30
    v_mul_f32 v31, s46, v31
    v_exp_f32 v30, v30
    v_exp_f32 v31, v31
    v_cvt_pk_bf16_f32 v32, v30, v30
    v_cvt_pk_bf16_f32 v33, v31, v31
    v_add_f32 v29, v29, v30
    v_add_f32 v29, v29, v31
    s_nop 1
    v_add_f32_dpp v29, v29, v29 row_half_mirror row_mask:0xf bank_mask:0xf
    s_nop 1
    v_add_f32_dpp v29, v29, v29 row_mirror row_mask:0xf bank_mask:0xf
    s_nop 1
    v_add_f32_dpp v29, v29, v29 row_bcast:15 row_mask:0xa bank_mask:0xf
    s_nop 1
    v_add_f32_dpp v29, v29, v29 row_bcast:31 row_mask:0xc bank_mask:0xf
    s_mov_b32 exec_lo, 0
    s_mov_b32 exec_hi, 0x80000000
    ds_write_b64 v4, v[28:29] offset:6144
    s_mov_b64 exec, -1
    v_and_b32_dpp v36, v32, v8 row_newbcast:0 row_mask:0xf bank_mask:0xf
    v_and_b32_dpp v37, v32, v9 row_newbcast:0 row_mask:0xf bank_mask:0xf
    v_and_b32_dpp v38, v32, v10 row_newbcast:0 row_mask:0xf bank_mask:0xf
    v_and_b32_dpp v39, v32, v11 row_newbcast:0 row_mask:0xf bank_mask:0xf
    s_nop 1
    v_mfma_f32_16x16x32_bf16 v[16:19], v[36:39], v[224:227], v[16:19]
    s_waitcnt vmcnt(9)
    buffer_load_dwordx4 v[224:227], v2, s[8:11], s32 offen offset:0 nt
    v_and_b32_dpp v40, v32, v8 row_newbcast:4 row_mask:0xf bank_mask:0xf
    v_and_b32_dpp v41, v32, v9 row_newbcast:4 row_mask:0xf bank_mask:0xf
    v_and_b32_dpp v42, v32, v10 row_newbcast:4 row_mask:0xf bank_mask:0xf
    v_and_b32_dpp v43, v32, v11 row_newbcast:4 row_mask:0xf bank_mask:0xf
    s_nop 1
    v_mfma_f32_16x16x32_bf16 v[16:19], v[40:43], v[228:231], v[16:19]
    s_waitcnt vmcnt(9)
    buffer_load_dwordx4 v[228:231], v2, s[8:11], s32 offen offset:1024 nt
    buffer_load_dwordx4 a[140:143], v6, s[28:31], s34 offen offset:0
    v_and_b32_dpp v36, v32, v8 row_newbcast:8 row_mask:0xf bank_mask:0xf
    v_and_b32_dpp v37, v32, v9 row_newbcast:8 row_mask:0xf bank_mask:0xf
    v_and_b32_dpp v38, v32, v10 row_newbcast:8 row_mask:0xf bank_mask:0xf
    v_and_b32_dpp v39, v32, v11 row_newbcast:8 row_mask:0xf bank_mask:0xf
    s_nop 1
    v_mfma_f32_16x16x32_bf16 v[16:19], v[36:39], v[232:235], v[16:19]
    s_waitcnt vmcnt(9)
    buffer_load_dwordx4 v[232:235], v2, s[8:11], s32 offen offset:2048 nt
    v_and_b32_dpp v40, v32, v8 row_newbcast:12 row_mask:0xf bank_mask:0xf
    v_and_b32_dpp v41, v32, v9 row_newbcast:12 row_mask:0xf bank_mask:0xf
    v_and_b32_dpp v42, v32, v10 row_newbcast:12 row_mask:0xf bank_mask:0xf
    v_and_b32_dpp v43, v32, v11 row_newbcast:12 row_mask:0xf bank_mask:0xf
    s_nop 1
    v_mfma_f32_16x16x32_bf16 v[16:19], v[40:43], v[236:239], v[16:19]
    s_waitcnt vmcnt(8)
    buffer_load_dwordx4 v[236:239], v2, s[8:11], s32 offen offset:3072 nt
    buffer_load_dwordx4 a[144:147], v6, s[28:31], s34 offen offset:256
    v_and_b32_dpp v36, v33, v8 row_newbcast:0 row_mask:0xf bank_mask:0xf
    v_and_b32_dpp v37, v33, v9 row_newbcast:0 row_mask:0xf bank_mask:0xf
    v_and_b32_dpp v38, v33, v10 row_newbcast:0 row_mask:0xf bank_mask:0xf
    v_and_b32_dpp v39, v33, v11 row_newbcast:0 row_mask:0xf bank_mask:0xf
    s_nop 1
    v_mfma_f32_16x16x32_bf16 v[16:19], v[36:39], v[240:243], v[16:19]
    s_waitcnt vmcnt(8)
    buffer_load_dwordx4 v[240:243], v3, s[8:11], s32 offen offset:0 nt
    buffer_load_dwordx4 a[148:151], v6, s[28:31], s34 offen offset:512
    v_and_b32_dpp v40, v33, v8 row_newbcast:4 row_mask:0xf bank_mask:0xf
    v_and_b32_dpp v41, v33, v9 row_newbcast:4 row_mask:0xf bank_mask:0xf
    v_and_b32_dpp v42, v33, v10 row_newbcast:4 row_mask:0xf bank_mask:0xf
    v_and_b32_dpp v43, v33, v11 row_newbcast:4 row_mask:0xf bank_mask:0xf
    s_nop 1
    v_mfma_f32_16x16x32_bf16 v[16:19], v[40:43], v[244:247], v[16:19]
    s_waitcnt vmcnt(9)
    buffer_load_dwordx4 v[244:247], v3, s[8:11], s32 offen offset:1024 nt
    buffer_load_dwordx4 a[152:155], v6, s[28:31], s34 offen offset:768
    v_and_b32_dpp v36, v33, v8 row_newbcast:8 row_mask:0xf bank_mask:0xf
    v_and_b32_dpp v37, v33, v9 row_newbcast:8 row_mask:0xf bank_mask:0xf
    v_and_b32_dpp v38, v33, v10 row_newbcast:8 row_mask:0xf bank_mask:0xf
    v_and_b32_dpp v39, v33, v11 row_newbcast:8 row_mask:0xf bank_mask:0xf
    s_nop 1
    v_mfma_f32_16x16x32_bf16 v[16:19], v[36:39], v[248:251], v[16:19]
    s_waitcnt vmcnt(9)
    buffer_load_dwordx4 v[248:251], v3, s[8:11], s32 offen offset:2048 nt
    v_and_b32_dpp v40, v33, v8 row_newbcast:12 row_mask:0xf bank_mask:0xf
    v_and_b32_dpp v41, v33, v9 row_newbcast:12 row_mask:0xf bank_mask:0xf
    v_and_b32_dpp v42, v33, v10 row_newbcast:12 row_mask:0xf bank_mask:0xf
    v_and_b32_dpp v43, v33, v11 row_newbcast:12 row_mask:0xf bank_mask:0xf
    s_nop 1
    v_mfma_f32_16x16x32_bf16 v[16:19], v[40:43], v[252:255], v[16:19]
    s_waitcnt vmcnt(9)
    buffer_load_dwordx4 v[252:255], v3, s[8:11], s32 offen offset:3072 nt
    buffer_load_dwordx4 a[156:159], v6, s[28:31], s34 offen offset:1024
    s_add_u32 s34, s34, 5120
    s_mov_b32 exec_hi, 0
    s_nop 2
    ds_write_b128 v51, v[16:19] offset:4096
    s_mov_b64 exec, -1
    s_nop 0
    v_mov_b32 v16, 0
    v_mov_b32 v17, 0
    v_mov_b32 v18, 0
    v_mov_b32 v19, 0
    v_mov_b32 v28, 0xff7fffff
    v_mov_b32 v29, 0
    s_lshl_b32 s4, s38, 14
    s_add_u32 s4, s4, 32768
    v_lshl_add_u32 v116, v7, 3, s4
    v_mov_b32 v117, v116
    v_mov_b32 v12, v112
    v_mov_b32 v13, v113
    v_mov_b32 v14, v114
    v_mov_b32 v15, v115
    s_add_u32 s32, s32, 32768
    v_dot2_f32_bf16 v20, v128, v12, 0
    v_dot2_f32_bf16 v20, v129, v13, v20
    v_dot2_f32_bf16 v20, v130, v14, v20
    v_dot2_f32_bf16 v20, v131, v15, v20
    s_waitcnt vmcnt(9)
    buffer_load_dwordx4 v[128:131], v2, s[8:11], s32 offen offset:0 nt
    v_dot2_f32_bf16 v21, v132, v12, 0
    v_dot2_f32_bf16 v21, v133, v13, v21
    v_dot2_f32_bf16 v21, v134, v14, v21
    v_dot2_f32_bf16 v21, v135, v15, v21
    s_waitcnt vmcnt(9)
    buffer_load_dwordx4 v[132:135], v2, s[8:11], s32 offen offset:1024 nt
    v_dot2_f32_bf16 v22, v136, v12, 0
    v_dot2_f32_bf16 v22, v137, v13, v22
    v_dot2_f32_bf16 v22, v138, v14, v22
    v_dot2_f32_bf16 v22, v139, v15, v22
    s_waitcnt vmcnt(8)
    buffer_load_dwordx4 v[136:139], v2, s[8:11], s32 offen offset:2048 nt
    v_dot2_f32_bf16 v23, v140, v12, 0
    v_dot2_f32_bf16 v23, v141, v13, v23
    v_dot2_f32_bf16 v23, v142, v14, v23
    v_dot2_f32_bf16 v23, v143, v15, v23
    s_waitcnt vmcnt(7)
    buffer_load_dwordx4 v[140:143], v2, s[8:11], s32 offen offset:3072 nt
    v_dot2_f32_bf16 v24, v144, v12, 0
    v_dot2_f32_bf16 v24, v145, v13, v24
    v_dot2_f32_bf16 v24, v146, v14, v24
    v_dot2_f32_bf16 v24, v147, v15, v24
    s_waitcnt vmcnt(6)
    buffer_load_dwordx4 v[144:147], v3, s[8:11], s32 offen offset:0 nt
    v_add_f32_dpp v20, v20, v20 row_mirror row_mask:0xf bank_mask:0xf
    v_add_f32_dpp v21, v21, v21 row_mirror row_mask:0xf bank_mask:0xf
    s_nop 0
    v_add_f32_dpp v20, v22, v22 row_mirror row_mask:0xf bank_mask:0xc
    v_add_f32_dpp v21, v23, v23 row_mirror row_mask:0xf bank_mask:0xc
    s_nop 0
    v_add_f32_dpp v20, v20, v20 row_half_mirror row_mask:0xf bank_mask:0xf
    s_nop 1
    v_add_f32_dpp v20, v21, v21 row_half_mirror row_mask:0xf bank_mask:0xa
    s_nop 1
    v_add_f32_dpp v20, v20, v20 quad_perm:[1,0,3,2] row_mask:0xf bank_mask:0xf
    s_nop 1
    v_add_f32_dpp v20, v20, v20 quad_perm:[2,3,0,1] row_mask:0xf bank_mask:0xf
    v_cvt_pk_bf16_f32 v20, v20, v20
    v_and_b32 v20, s47, v20
    v_mul_f32 v20, s45, v20
    v_cvt_pk_bf16_f32 v20, v20, v20
    v_and_b32 v110, s47, v20
    v_dot2_f32_bf16 v25, v148, v12, 0
    v_dot2_f32_bf16 v25, v149, v13, v25
    v_dot2_f32_bf16 v25, v150, v14, v25
    v_dot2_f32_bf16 v25, v151, v15, v25
    s_waitcnt vmcnt(6)
    buffer_load_dwordx4 v[148:151], v3, s[8:11], s32 offen offset:1024 nt
    v_dot2_f32_bf16 v26, v152, v12, 0
    v_dot2_f32_bf16 v26, v153, v13, v26
    v_dot2_f32_bf16 v26, v154, v14, v26
    v_dot2_f32_bf16 v26, v155, v15, v26
    s_waitcnt vmcnt(5)
    buffer_load_dwordx4 v[152:155], v3, s[8:11], s32 offen offset:2048 nt
    v_dot2_f32_bf16 v27, v156, v12, 0
    v_dot2_f32_bf16 v27, v157, v13, v27
    v_dot2_f32_bf16 v27, v158, v14, v27
    v_dot2_f32_bf16 v27, v159, v15, v27
    s_waitcnt vmcnt(5)
    buffer_load_dwordx4 v[156:159], v3, s[8:11], s32 offen offset:3072 nt
    v_add_f32_dpp v24, v24, v24 row_mirror row_mask:0xf bank_mask:0xf
    v_add_f32_dpp v25, v25, v25 row_mirror row_mask:0xf bank_mask:0xf
    s_nop 0
    v_add_f32_dpp v24, v26, v26 row_mirror row_mask:0xf bank_mask:0xc
    v_add_f32_dpp v25, v27, v27 row_mirror row_mask:0xf bank_mask:0xc
    s_nop 0
    v_add_f32_dpp v24, v24, v24 row_half_mirror row_mask:0xf bank_mask:0xf
    s_nop 1
    v_add_f32_dpp v24, v25, v25 row_half_mirror row_mask:0xf bank_mask:0xa
    s_nop 1
    v_add_f32_dpp v24, v24, v24 quad_perm:[1,0,3,2] row_mask:0xf bank_mask:0xf
    s_nop 1
    v_add_f32_dpp v24, v24, v24 quad_perm:[2,3,0,1] row_mask:0xf bank_mask:0xf
    v_cvt_pk_bf16_f32 v24, v24, v24
    v_and_b32 v24, s47, v24
    v_mul_f32 v24, s45, v24
    v_cvt_pk_bf16_f32 v24, v24, v24
    v_and_b32 v111, s47, v24
    ds_write_b64 v116, v[110:111]
    v_max3_f32 v28, v28, v110, v111
    v_add_u32 v116, 512, v116
    s_waitcnt lgkmcnt(0)
    s_barrier
    v_mov_b32 v84, 0
    ds_read_b128 v[72:75], v84 offset:6144
    ds_read_b128 v[76:79], v84 offset:6160
    ds_read_b32 v80, v107 offset:4096
    ds_read_b32 v81, v107 offset:4608
    ds_read_b32 v82, v107 offset:5120
    ds_read_b32 v83, v107 offset:5632
    v_mov_b32 v52, 0
    v_mov_b32 v53, 0
    v_mov_b32 v54, 0
    v_mov_b32 v55, 0
    v_mov_b32 v56, 0
    v_mov_b32 v57, 0
    v_mov_b32 v58, 0
    v_mov_b32 v59, 0
    v_mov_b32 v60, 0
    v_mov_b32 v61, 0
    v_mov_b32 v62, 0
    v_mov_b32 v63, 0
    v_mov_b32 v64, 0
    v_mov_b32 v65, 0
    v_mov_b32 v66, 0
    v_mov_b32 v67, 0
    v_mov_b32 v68, 0
    v_mov_b32 v69, 0
    v_mov_b32 v70, 0
    v_mov_b32 v71, 0
    s_add_u32 s24, s82, s63
    s_addc_u32 s25, s83, 0
    s_mov_b32 s26, 163840
    s_mov_b32 s27, 0x20000
    s_mul_i32 s34, s38, 40960
    s_add_u32 s32, s32, 32768
    v_dot2_f32_bf16 v20, v160, v12, 0
    v_dot2_f32_bf16 v20, v161, v13, v20
    v_dot2_f32_bf16 v20, v162, v14, v20
    v_dot2_f32_bf16 v20, v163, v15, v20
    s_waitcnt vmcnt(5)
    buffer_load_dwordx4 v[160:163], v2, s[8:11], s32 offen offset:0 nt
    s_waitcnt lgkmcnt(0)
    v_max3_f32 v84, v72, v74, v76
    v_max_f32 v84, v84, v78
    v_sub_f32 v72, v72, v84
    v_sub_f32 v74, v74, v84
    v_sub_f32 v76, v76, v84
    v_sub_f32 v78, v78, v84
    v_mul_f32 v72, s46, v72
    v_mul_f32 v74, s46, v74
    v_mul_f32 v76, s46, v76
    v_mul_f32 v78, s46, v78
    v_exp_f32 v72, v72
    v_exp_f32 v74, v74
    v_exp_f32 v76, v76
    v_exp_f32 v78, v78
    v_mul_f32 v84, v72, v73
    v_mul_f32 v85, v72, v80
    v_fmac_f32 v84, v74, v75
    v_fmac_f32 v85, v74, v81
    v_fmac_f32 v84, v76, v77
    v_fmac_f32 v85, v76, v82
    v_fmac_f32 v84, v78, v79
    v_fmac_f32 v85, v78, v83
    v_rcp_f32 v84, v84
    s_nop 0
    v_mul_f32 v85, v85, v84
    v_cvt_pk_bf16_f32 v50, v85, v85
    v_dot2_f32_bf16 v21, v164, v12, 0
    v_dot2_f32_bf16 v21, v165, v13, v21
    v_dot2_f32_bf16 v21, v166, v14, v21
    v_dot2_f32_bf16 v21, v167, v15, v21
    s_waitcnt vmcnt(5)
    buffer_load_dwordx4 v[164:167], v2, s[8:11], s32 offen offset:1024 nt
    v_dot2_f32_bf16 v22, v168, v12, 0
    v_dot2_f32_bf16 v22, v169, v13, v22
    v_dot2_f32_bf16 v22, v170, v14, v22
    v_dot2_f32_bf16 v22, v171, v15, v22
    s_waitcnt vmcnt(5)
    buffer_load_dwordx4 v[168:171], v2, s[8:11], s32 offen offset:2048 nt
    v_and_b32_dpp v36, v50, v8 row_newbcast:0 row_mask:0xf bank_mask:0xf
    v_and_b32_dpp v37, v50, v9 row_newbcast:0 row_mask:0xf bank_mask:0xf
    v_and_b32_dpp v38, v50, v10 row_newbcast:0 row_mask:0xf bank_mask:0xf
    v_and_b32_dpp v39, v50, v11 row_newbcast:0 row_mask:0xf bank_mask:0xf
    s_nop 1
    v_mfma_f32_16x16x32_bf16 v[52:55], v[36:39], a[0:3], v[52:55]
    v_mfma_f32_16x16x32_bf16 v[56:59], v[36:39], a[4:7], v[56:59]
    v_mfma_f32_16x16x32_bf16 v[60:63], v[36:39], a[8:11], v[60:63]
    v_mfma_f32_16x16x32_bf16 v[64:67], v[36:39], a[12:15], v[64:67]
    v_mfma_f32_16x16x32_bf16 v[68:71], v[36:39], a[16:19], v[68:71]
    v_dot2_f32_bf16 v23, v172, v12, 0
    v_dot2_f32_bf16 v23, v173, v13, v23
    v_dot2_f32_bf16 v23, v174, v14, v23
    v_dot2_f32_bf16 v23, v175, v15, v23
    s_waitcnt vmcnt(5)
    buffer_load_dwordx4 v[172:175], v2, s[8:11], s32 offen offset:3072 nt
    buffer_load_dwordx4 a[0:3], v6, s[24:27], s34 offen offset:0
    v_dot2_f32_bf16 v24, v176, v12, 0
    v_dot2_f32_bf16 v24, v177, v13, v24
    v_dot2_f32_bf16 v24, v178, v14, v24
    v_dot2_f32_bf16 v24, v179, v15, v24
    s_waitcnt vmcnt(6)
    buffer_load_dwordx4 v[176:179], v3, s[8:11], s32 offen offset:0 nt
    v_add_f32_dpp v20, v20, v20 row_mirror row_mask:0xf bank_mask:0xf
    v_add_f32_dpp v21, v21, v21 row_mirror row_mask:0xf bank_mask:0xf
    s_nop 0
    v_add_f32_dpp v20, v22, v22 row_mirror row_mask:0xf bank_mask:0xc
    v_add_f32_dpp v21, v23, v23 row_mirror row_mask:0xf bank_mask:0xc
    s_nop 0
    v_add_f32_dpp v20, v20, v20 row_half_mirror row_mask:0xf bank_mask:0xf
    s_nop 1
    v_add_f32_dpp v20, v21, v21 row_half_mirror row_mask:0xf bank_mask:0xa
    s_nop 1
    v_add_f32_dpp v20, v20, v20 quad_perm:[1,0,3,2] row_mask:0xf bank_mask:0xf
    s_nop 1
    v_add_f32_dpp v20, v20, v20 quad_perm:[2,3,0,1] row_mask:0xf bank_mask:0xf
    v_cvt_pk_bf16_f32 v20, v20, v20
    v_and_b32 v20, s47, v20
    v_mul_f32 v20, s45, v20
    v_cvt_pk_bf16_f32 v20, v20, v20
    v_and_b32 v110, s47, v20
    buffer_load_dwordx4 a[4:7], v6, s[24:27], s34 offen offset:256
    v_dot2_f32_bf16 v25, v180, v12, 0
    v_dot2_f32_bf16 v25, v181, v13, v25
    v_dot2_f32_bf16 v25, v182, v14, v25
    v_dot2_f32_bf16 v25, v183, v15, v25
    s_waitcnt vmcnt(7)
    buffer_load_dwordx4 v[180:183], v3, s[8:11], s32 offen offset:1024 nt
    buffer_load_dwordx4 a[8:11], v6, s[24:27], s34 offen offset:512
    v_dot2_f32_bf16 v26, v184, v12, 0
    v_dot2_f32_bf16 v26, v185, v13, v26
    v_dot2_f32_bf16 v26, v186, v14, v26
    v_dot2_f32_bf16 v26, v187, v15, v26
    s_waitcnt vmcnt(8)
    buffer_load_dwordx4 v[184:187], v3, s[8:11], s32 offen offset:2048 nt
    buffer_load_dwordx4 a[12:15], v6, s[24:27], s34 offen offset:768
    v_dot2_f32_bf16 v27, v188, v12, 0
    v_dot2_f32_bf16 v27, v189, v13, v27
    v_dot2_f32_bf16 v27, v190, v14, v27
    v_dot2_f32_bf16 v27, v191, v15, v27
    s_waitcnt vmcnt(9)
    buffer_load_dwordx4 v[188:191], v3, s[8:11], s32 offen offset:3072 nt
    v_add_f32_dpp v24, v24, v24 row_mirror row_mask:0xf bank_mask:0xf
    v_add_f32_dpp v25, v25, v25 row_mirror row_mask:0xf bank_mask:0xf
    s_nop 0
    v_add_f32_dpp v24, v26, v26 row_mirror row_mask:0xf bank_mask:0xc
    v_add_f32_dpp v25, v27, v27 row_mirror row_mask:0xf bank_mask:0xc
    s_nop 0
    v_add_f32_dpp v24, v24, v24 row_half_mirror row_mask:0xf bank_mask:0xf
    s_nop 1
    v_add_f32_dpp v24, v25, v25 row_half_mirror row_mask:0xf bank_mask:0xa
    s_nop 1
    v_add_f32_dpp v24, v24, v24 quad_perm:[1,0,3,2] row_mask:0xf bank_mask:0xf
    s_nop 1
    v_add_f32_dpp v24, v24, v24 quad_perm:[2,3,0,1] row_mask:0xf bank_mask:0xf
    v_cvt_pk_bf16_f32 v24, v24, v24
    v_and_b32 v24, s47, v24
    v_mul_f32 v24, s45, v24
    v_cvt_pk_bf16_f32 v24, v24, v24
    v_and_b32 v111, s47, v24
    ds_write_b64 v116, v[110:111]
    v_max3_f32 v28, v28, v110, v111
    v_add_u32 v116, 512, v116
    buffer_load_dwordx4 a[16:19], v6, s[24:27], s34 offen offset:1024
    s_add_u32 s34, s34, 5120
    s_add_u32 s32, s32, 32768
    v_dot2_f32_bf16 v20, v192, v12, 0
    v_dot2_f32_bf16 v20, v193, v13, v20
    v_dot2_f32_bf16 v20, v194, v14, v20
    v_dot2_f32_bf16 v20, v195, v15, v20
    s_waitcnt vmcnt(10)
    buffer_load_dwordx4 v[192:195], v2, s[8:11], s32 offen offset:0 nt
    v_dot2_f32_bf16 v21, v196, v12, 0
    v_dot2_f32_bf16 v21, v197, v13, v21
    v_dot2_f32_bf16 v21, v198, v14, v21
    v_dot2_f32_bf16 v21, v199, v15, v21
    s_waitcnt vmcnt(10)
    buffer_load_dwordx4 v[196:199], v2, s[8:11], s32 offen offset:1024 nt
    v_dot2_f32_bf16 v22, v200, v12, 0
    v_dot2_f32_bf16 v22, v201, v13, v22
    v_dot2_f32_bf16 v22, v202, v14, v22
    v_dot2_f32_bf16 v22, v203, v15, v22
    s_waitcnt vmcnt(9)
    buffer_load_dwordx4 v[200:203], v2, s[8:11], s32 offen offset:2048 nt
    v_and_b32_dpp v40, v50, v8 row_newbcast:1 row_mask:0xf bank_mask:0xf
    v_and_b32_dpp v41, v50, v9 row_newbcast:1 row_mask:0xf bank_mask:0xf
    v_and_b32_dpp v42, v50, v10 row_newbcast:1 row_mask:0xf bank_mask:0xf
    v_and_b32_dpp v43, v50, v11 row_newbcast:1 row_mask:0xf bank_mask:0xf
    s_nop 1
    v_mfma_f32_16x16x32_bf16 v[52:55], v[40:43], a[20:23], v[52:55]
    v_mfma_f32_16x16x32_bf16 v[56:59], v[40:43], a[24:27], v[56:59]
    v_mfma_f32_16x16x32_bf16 v[60:63], v[40:43], a[28:31], v[60:63]
    v_mfma_f32_16x16x32_bf16 v[64:67], v[40:43], a[32:35], v[64:67]
    v_mfma_f32_16x16x32_bf16 v[68:71], v[40:43], a[36:39], v[68:71]
    v_dot2_f32_bf16 v23, v204, v12, 0
    v_dot2_f32_bf16 v23, v205, v13, v23
    v_dot2_f32_bf16 v23, v206, v14, v23
    v_dot2_f32_bf16 v23, v207, v15, v23
    s_waitcnt vmcnt(8)
    buffer_load_dwordx4 v[204:207], v2, s[8:11], s32 offen offset:3072 nt
    buffer_load_dwordx4 a[20:23], v6, s[24:27], s34 offen offset:0
    v_dot2_f32_bf16 v24, v208, v12, 0
    v_dot2_f32_bf16 v24, v209, v13, v24
    v_dot2_f32_bf16 v24, v210, v14, v24
    v_dot2_f32_bf16 v24, v211, v15, v24
    s_waitcnt vmcnt(8)
    buffer_load_dwordx4 v[208:211], v3, s[8:11], s32 offen offset:0 nt
    v_add_f32_dpp v20, v20, v20 row_mirror row_mask:0xf bank_mask:0xf
    v_add_f32_dpp v21, v21, v21 row_mirror row_mask:0xf bank_mask:0xf
    s_nop 0
    v_add_f32_dpp v20, v22, v22 row_mirror row_mask:0xf bank_mask:0xc
    v_add_f32_dpp v21, v23, v23 row_mirror row_mask:0xf bank_mask:0xc
    s_nop 0
    v_add_f32_dpp v20, v20, v20 row_half_mirror row_mask:0xf bank_mask:0xf
    s_nop 1
    v_add_f32_dpp v20, v21, v21 row_half_mirror row_mask:0xf bank_mask:0xa
    s_nop 1
    v_add_f32_dpp v20, v20, v20 quad_perm:[1,0,3,2] row_mask:0xf bank_mask:0xf
    s_nop 1
    v_add_f32_dpp v20, v20, v20 quad_perm:[2,3,0,1] row_mask:0xf bank_mask:0xf
    v_cvt_pk_bf16_f32 v20, v20, v20
    v_and_b32 v20, s47, v20
    v_mul_f32 v20, s45, v20
    v_cvt_pk_bf16_f32 v20, v20, v20
    v_and_b32 v110, s47, v20
    buffer_load_dwordx4 a[24:27], v6, s[24:27], s34 offen offset:256
    v_dot2_f32_bf16 v25, v212, v12, 0
    v_dot2_f32_bf16 v25, v213, v13, v25
    v_dot2_f32_bf16 v25, v214, v14, v25
    v_dot2_f32_bf16 v25, v215, v15, v25
    s_waitcnt vmcnt(8)
    buffer_load_dwordx4 v[212:215], v3, s[8:11], s32 offen offset:1024 nt
    buffer_load_dwordx4 a[28:31], v6, s[24:27], s34 offen offset:512
    v_dot2_f32_bf16 v26, v216, v12, 0
    v_dot2_f32_bf16 v26, v217, v13, v26
    v_dot2_f32_bf16 v26, v218, v14, v26
    v_dot2_f32_bf16 v26, v219, v15, v26
    s_waitcnt vmcnt(8)
    buffer_load_dwordx4 v[216:219], v3, s[8:11], s32 offen offset:2048 nt
    buffer_load_dwordx4 a[32:35], v6, s[24:27], s34 offen offset:768
    v_dot2_f32_bf16 v27, v220, v12, 0
    v_dot2_f32_bf16 v27, v221, v13, v27
    v_dot2_f32_bf16 v27, v222, v14, v27
    v_dot2_f32_bf16 v27, v223, v15, v27
    s_waitcnt vmcnt(9)
    buffer_load_dwordx4 v[220:223], v3, s[8:11], s32 offen offset:3072 nt
    v_add_f32_dpp v24, v24, v24 row_mirror row_mask:0xf bank_mask:0xf
    v_add_f32_dpp v25, v25, v25 row_mirror row_mask:0xf bank_mask:0xf
    s_nop 0
    v_add_f32_dpp v24, v26, v26 row_mirror row_mask:0xf bank_mask:0xc
    v_add_f32_dpp v25, v27, v27 row_mirror row_mask:0xf bank_mask:0xc
    s_nop 0
    v_add_f32_dpp v24, v24, v24 row_half_mirror row_mask:0xf bank_mask:0xf
    s_nop 1
    v_add_f32_dpp v24, v25, v25 row_half_mirror row_mask:0xf bank_mask:0xa
    s_nop 1
    v_add_f32_dpp v24, v24, v24 quad_perm:[1,0,3,2] row_mask:0xf bank_mask:0xf
    s_nop 1
    v_add_f32_dpp v24, v24, v24 quad_perm:[2,3,0,1] row_mask:0xf bank_mask:0xf
    v_cvt_pk_bf16_f32 v24, v24, v24
    v_and_b32 v24, s47, v24
    v_mul_f32 v24, s45, v24
    v_cvt_pk_bf16_f32 v24, v24, v24
    v_and_b32 v111, s47, v24
    ds_write_b64 v116, v[110:111]
    v_max3_f32 v28, v28, v110, v111
    v_add_u32 v116, 512, v116
    buffer_load_dwordx4 a[36:39], v6, s[24:27], s34 offen offset:1024
    s_add_u32 s34, s34, 5120
    s_add_u32 s32, s32, 32768
    v_dot2_f32_bf16 v20, v224, v12, 0
    v_dot2_f32_bf16 v20, v225, v13, v20
    v_dot2_f32_bf16 v20, v226, v14, v20
    v_dot2_f32_bf16 v20, v227, v15, v20
    s_waitcnt vmcnt(10)
    buffer_load_dwordx4 v[224:227], v2, s[8:11], s32 offen offset:0 nt
    v_dot2_f32_bf16 v21, v228, v12, 0
    v_dot2_f32_bf16 v21, v229, v13, v21
    v_dot2_f32_bf16 v21, v230, v14, v21
    v_dot2_f32_bf16 v21, v231, v15, v21
    s_waitcnt vmcnt(10)
    buffer_load_dwordx4 v[228:231], v2, s[8:11], s32 offen offset:1024 nt
    v_dot2_f32_bf16 v22, v232, v12, 0
    v_dot2_f32_bf16 v22, v233, v13, v22
    v_dot2_f32_bf16 v22, v234, v14, v22
    v_dot2_f32_bf16 v22, v235, v15, v22
    s_waitcnt vmcnt(9)
    buffer_load_dwordx4 v[232:235], v2, s[8:11], s32 offen offset:2048 nt
    v_and_b32_dpp v36, v50, v8 row_newbcast:2 row_mask:0xf bank_mask:0xf
    v_and_b32_dpp v37, v50, v9 row_newbcast:2 row_mask:0xf bank_mask:0xf
    v_and_b32_dpp v38, v50, v10 row_newbcast:2 row_mask:0xf bank_mask:0xf
    v_and_b32_dpp v39, v50, v11 row_newbcast:2 row_mask:0xf bank_mask:0xf
    s_nop 1
    v_mfma_f32_16x16x32_bf16 v[52:55], v[36:39], a[40:43], v[52:55]
    v_mfma_f32_16x16x32_bf16 v[56:59], v[36:39], a[44:47], v[56:59]
    v_mfma_f32_16x16x32_bf16 v[60:63], v[36:39], a[48:51], v[60:63]
    v_mfma_f32_16x16x32_bf16 v[64:67], v[36:39], a[52:55], v[64:67]
    v_mfma_f32_16x16x32_bf16 v[68:71], v[36:39], a[56:59], v[68:71]
    v_dot2_f32_bf16 v23, v236, v12, 0
    v_dot2_f32_bf16 v23, v237, v13, v23
    v_dot2_f32_bf16 v23, v238, v14, v23
    v_dot2_f32_bf16 v23, v239, v15, v23
    s_waitcnt vmcnt(8)
    buffer_load_dwordx4 v[236:239], v2, s[8:11], s32 offen offset:3072 nt
    buffer_load_dwordx4 a[40:43], v6, s[24:27], s34 offen offset:0
    v_dot2_f32_bf16 v24, v240, v12, 0
    v_dot2_f32_bf16 v24, v241, v13, v24
    v_dot2_f32_bf16 v24, v242, v14, v24
    v_dot2_f32_bf16 v24, v243, v15, v24
    s_waitcnt vmcnt(8)
    buffer_load_dwordx4 v[240:243], v3, s[8:11], s32 offen offset:0 nt
    v_add_f32_dpp v20, v20, v20 row_mirror row_mask:0xf bank_mask:0xf
    v_add_f32_dpp v21, v21, v21 row_mirror row_mask:0xf bank_mask:0xf
    s_nop 0
    v_add_f32_dpp v20, v22, v22 row_mirror row_mask:0xf bank_mask:0xc
    v_add_f32_dpp v21, v23, v23 row_mirror row_mask:0xf bank_mask:0xc
    s_nop 0
    v_add_f32_dpp v20, v20, v20 row_half_mirror row_mask:0xf bank_mask:0xf
    s_nop 1
    v_add_f32_dpp v20, v21, v21 row_half_mirror row_mask:0xf bank_mask:0xa
    s_nop 1
    v_add_f32_dpp v20, v20, v20 quad_perm:[1,0,3,2] row_mask:0xf bank_mask:0xf
    s_nop 1
    v_add_f32_dpp v20, v20, v20 quad_perm:[2,3,0,1] row_mask:0xf bank_mask:0xf
    v_cvt_pk_bf16_f32 v20, v20, v20
    v_and_b32 v20, s47, v20
    v_mul_f32 v20, s45, v20
    v_cvt_pk_bf16_f32 v20, v20, v20
    v_and_b32 v110, s47, v20
    buffer_load_dwordx4 a[44:47], v6, s[24:27], s34 offen offset:256
    v_dot2_f32_bf16 v25, v244, v12, 0
    v_dot2_f32_bf16 v25, v245, v13, v25
    v_dot2_f32_bf16 v25, v246, v14, v25
    v_dot2_f32_bf16 v25, v247, v15, v25
    s_waitcnt vmcnt(8)
    buffer_load_dwordx4 v[244:247], v3, s[8:11], s32 offen offset:1024 nt
    buffer_load_dwordx4 a[48:51], v6, s[24:27], s34 offen offset:512
    v_dot2_f32_bf16 v26, v248, v12, 0
    v_dot2_f32_bf16 v26, v249, v13, v26
    v_dot2_f32_bf16 v26, v250, v14, v26
    v_dot2_f32_bf16 v26, v251, v15, v26
    s_waitcnt vmcnt(8)
    buffer_load_dwordx4 v[248:251], v3, s[8:11], s32 offen offset:2048 nt
    buffer_load_dwordx4 a[52:55], v6, s[24:27], s34 offen offset:768
    v_dot2_f32_bf16 v27, v252, v12, 0
    v_dot2_f32_bf16 v27, v253, v13, v27
    v_dot2_f32_bf16 v27, v254, v14, v27
    v_dot2_f32_bf16 v27, v255, v15, v27
    s_waitcnt vmcnt(9)
    buffer_load_dwordx4 v[252:255], v3, s[8:11], s32 offen offset:3072 nt
    v_add_f32_dpp v24, v24, v24 row_mirror row_mask:0xf bank_mask:0xf
    v_add_f32_dpp v25, v25, v25 row_mirror row_mask:0xf bank_mask:0xf
    s_nop 0
    v_add_f32_dpp v24, v26, v26 row_mirror row_mask:0xf bank_mask:0xc
    v_add_f32_dpp v25, v27, v27 row_mirror row_mask:0xf bank_mask:0xc
    s_nop 0
    v_add_f32_dpp v24, v24, v24 row_half_mirror row_mask:0xf bank_mask:0xf
    s_nop 1
    v_add_f32_dpp v24, v25, v25 row_half_mirror row_mask:0xf bank_mask:0xa
    s_nop 1
    v_add_f32_dpp v24, v24, v24 quad_perm:[1,0,3,2] row_mask:0xf bank_mask:0xf
    s_nop 1
    v_add_f32_dpp v24, v24, v24 quad_perm:[2,3,0,1] row_mask:0xf bank_mask:0xf
    v_cvt_pk_bf16_f32 v24, v24, v24
    v_and_b32 v24, s47, v24
    v_mul_f32 v24, s45, v24
    v_cvt_pk_bf16_f32 v24, v24, v24
    v_and_b32 v111, s47, v24
    ds_write_b64 v116, v[110:111]
    v_max3_f32 v28, v28, v110, v111
    v_add_u32 v116, 512, v116
    buffer_load_dwordx4 a[56:59], v6, s[24:27], s34 offen offset:1024
    s_add_u32 s34, s34, 5120
    s_add_u32 s32, s32, 32768
    v_dot2_f32_bf16 v20, v128, v12, 0
    v_dot2_f32_bf16 v20, v129, v13, v20
    v_dot2_f32_bf16 v20, v130, v14, v20
    v_dot2_f32_bf16 v20, v131, v15, v20
    s_waitcnt vmcnt(10)
    buffer_load_dwordx4 v[128:131], v2, s[8:11], s32 offen offset:0 nt
    v_dot2_f32_bf16 v21, v132, v12, 0
    v_dot2_f32_bf16 v21, v133, v13, v21
    v_dot2_f32_bf16 v21, v134, v14, v21
    v_dot2_f32_bf16 v21, v135, v15, v21
    s_waitcnt vmcnt(10)
    buffer_load_dwordx4 v[132:135], v2, s[8:11], s32 offen offset:1024 nt
    v_dot2_f32_bf16 v22, v136, v12, 0
    v_dot2_f32_bf16 v22, v137, v13, v22
    v_dot2_f32_bf16 v22, v138, v14, v22
    v_dot2_f32_bf16 v22, v139, v15, v22
    s_waitcnt vmcnt(9)
    buffer_load_dwordx4 v[136:139], v2, s[8:11], s32 offen offset:2048 nt
    v_and_b32_dpp v40, v50, v8 row_newbcast:3 row_mask:0xf bank_mask:0xf
    v_and_b32_dpp v41, v50, v9 row_newbcast:3 row_mask:0xf bank_mask:0xf
    v_and_b32_dpp v42, v50, v10 row_newbcast:3 row_mask:0xf bank_mask:0xf
    v_and_b32_dpp v43, v50, v11 row_newbcast:3 row_mask:0xf bank_mask:0xf
    s_nop 1
    v_mfma_f32_16x16x32_bf16 v[52:55], v[40:43], a[60:63], v[52:55]
    v_mfma_f32_16x16x32_bf16 v[56:59], v[40:43], a[64:67], v[56:59]
    v_mfma_f32_16x16x32_bf16 v[60:63], v[40:43], a[68:71], v[60:63]
    v_mfma_f32_16x16x32_bf16 v[64:67], v[40:43], a[72:75], v[64:67]
    v_mfma_f32_16x16x32_bf16 v[68:71], v[40:43], a[76:79], v[68:71]
    v_dot2_f32_bf16 v23, v140, v12, 0
    v_dot2_f32_bf16 v23, v141, v13, v23
    v_dot2_f32_bf16 v23, v142, v14, v23
    v_dot2_f32_bf16 v23, v143, v15, v23
    s_waitcnt vmcnt(8)
    buffer_load_dwordx4 v[140:143], v2, s[8:11], s32 offen offset:3072 nt
    buffer_load_dwordx4 a[60:63], v6, s[24:27], s34 offen offset:0
    v_dot2_f32_bf16 v24, v144, v12, 0
    v_dot2_f32_bf16 v24, v145, v13, v24
    v_dot2_f32_bf16 v24, v146, v14, v24
    v_dot2_f32_bf16 v24, v147, v15, v24
    s_waitcnt vmcnt(8)
    buffer_load_dwordx4 v[144:147], v3, s[8:11], s32 offen offset:0 nt
    v_add_f32_dpp v20, v20, v20 row_mirror row_mask:0xf bank_mask:0xf
    v_add_f32_dpp v21, v21, v21 row_mirror row_mask:0xf bank_mask:0xf
    s_nop 0
    v_add_f32_dpp v20, v22, v22 row_mirror row_mask:0xf bank_mask:0xc
    v_add_f32_dpp v21, v23, v23 row_mirror row_mask:0xf bank_mask:0xc
    s_nop 0
    v_add_f32_dpp v20, v20, v20 row_half_mirror row_mask:0xf bank_mask:0xf
    s_nop 1
    v_add_f32_dpp v20, v21, v21 row_half_mirror row_mask:0xf bank_mask:0xa
    s_nop 1
    v_add_f32_dpp v20, v20, v20 quad_perm:[1,0,3,2] row_mask:0xf bank_mask:0xf
    s_nop 1
    v_add_f32_dpp v20, v20, v20 quad_perm:[2,3,0,1] row_mask:0xf bank_mask:0xf
    v_cvt_pk_bf16_f32 v20, v20, v20
    v_and_b32 v20, s47, v20
    v_mul_f32 v20, s45, v20
    v_cvt_pk_bf16_f32 v20, v20, v20
    v_and_b32 v110, s47, v20
    buffer_load_dwordx4 a[64:67], v6, s[24:27], s34 offen offset:256
    v_dot2_f32_bf16 v25, v148, v12, 0
    v_dot2_f32_bf16 v25, v149, v13, v25
    v_dot2_f32_bf16 v25, v150, v14, v25
    v_dot2_f32_bf16 v25, v151, v15, v25
    s_waitcnt vmcnt(8)
    buffer_load_dwordx4 v[148:151], v3, s[8:11], s32 offen offset:1024 nt
    buffer_load_dwordx4 a[68:71], v6, s[24:27], s34 offen offset:512
    v_dot2_f32_bf16 v26, v152, v12, 0
    v_dot2_f32_bf16 v26, v153, v13, v26
    v_dot2_f32_bf16 v26, v154, v14, v26
    v_dot2_f32_bf16 v26, v155, v15, v26
    s_waitcnt vmcnt(8)
    buffer_load_dwordx4 v[152:155], v3, s[8:11], s32 offen offset:2048 nt
    buffer_load_dwordx4 a[72:75], v6, s[24:27], s34 offen offset:768
    v_dot2_f32_bf16 v27, v156, v12, 0
    v_dot2_f32_bf16 v27, v157, v13, v27
    v_dot2_f32_bf16 v27, v158, v14, v27
    v_dot2_f32_bf16 v27, v159, v15, v27
    s_waitcnt vmcnt(9)
    buffer_load_dwordx4 v[156:159], v3, s[8:11], s32 offen offset:3072 nt
    v_add_f32_dpp v24, v24, v24 row_mirror row_mask:0xf bank_mask:0xf
    v_add_f32_dpp v25, v25, v25 row_mirror row_mask:0xf bank_mask:0xf
    s_nop 0
    v_add_f32_dpp v24, v26, v26 row_mirror row_mask:0xf bank_mask:0xc
    v_add_f32_dpp v25, v27, v27 row_mirror row_mask:0xf bank_mask:0xc
    s_nop 0
    v_add_f32_dpp v24, v24, v24 row_half_mirror row_mask:0xf bank_mask:0xf
    s_nop 1
    v_add_f32_dpp v24, v25, v25 row_half_mirror row_mask:0xf bank_mask:0xa
    s_nop 1
    v_add_f32_dpp v24, v24, v24 quad_perm:[1,0,3,2] row_mask:0xf bank_mask:0xf
    s_nop 1
    v_add_f32_dpp v24, v24, v24 quad_perm:[2,3,0,1] row_mask:0xf bank_mask:0xf
    v_cvt_pk_bf16_f32 v24, v24, v24
    v_and_b32 v24, s47, v24
    v_mul_f32 v24, s45, v24
    v_cvt_pk_bf16_f32 v24, v24, v24
    v_and_b32 v111, s47, v24
    ds_write_b64 v116, v[110:111]
    v_max3_f32 v28, v28, v110, v111
    v_add_u32 v116, 512, v116
    buffer_load_dwordx4 a[76:79], v6, s[24:27], s34 offen offset:1024
    s_add_u32 s34, s34, 5120
    s_add_u32 s32, s32, 32768
    v_dot2_f32_bf16 v20, v160, v12, 0
    v_dot2_f32_bf16 v20, v161, v13, v20
    v_dot2_f32_bf16 v20, v162, v14, v20
    v_dot2_f32_bf16 v20, v163, v15, v20
    s_waitcnt vmcnt(10)
    buffer_load_dwordx4 v[160:163], v2, s[8:11], s32 offen offset:0 nt
    v_dot2_f32_bf16 v21, v164, v12, 0
    v_dot2_f32_bf16 v21, v165, v13, v21
    v_dot2_f32_bf16 v21, v166, v14, v21
    v_dot2_f32_bf16 v21, v167, v15, v21
    s_waitcnt vmcnt(10)
    buffer_load_dwordx4 v[164:167], v2, s[8:11], s32 offen offset:1024 nt
    v_dot2_f32_bf16 v22, v168, v12, 0
    v_dot2_f32_bf16 v22, v169, v13, v22
    v_dot2_f32_bf16 v22, v170, v14, v22
    v_dot2_f32_bf16 v22, v171, v15, v22
    s_waitcnt vmcnt(9)
    buffer_load_dwordx4 v[168:171], v2, s[8:11], s32 offen offset:2048 nt
    v_and_b32_dpp v36, v50, v8 row_newbcast:4 row_mask:0xf bank_mask:0xf
    v_and_b32_dpp v37, v50, v9 row_newbcast:4 row_mask:0xf bank_mask:0xf
    v_and_b32_dpp v38, v50, v10 row_newbcast:4 row_mask:0xf bank_mask:0xf
    v_and_b32_dpp v39, v50, v11 row_newbcast:4 row_mask:0xf bank_mask:0xf
    s_nop 1
    v_mfma_f32_16x16x32_bf16 v[52:55], v[36:39], a[80:83], v[52:55]
    v_mfma_f32_16x16x32_bf16 v[56:59], v[36:39], a[84:87], v[56:59]
    v_mfma_f32_16x16x32_bf16 v[60:63], v[36:39], a[88:91], v[60:63]
    v_mfma_f32_16x16x32_bf16 v[64:67], v[36:39], a[92:95], v[64:67]
    v_mfma_f32_16x16x32_bf16 v[68:71], v[36:39], a[96:99], v[68:71]
    v_dot2_f32_bf16 v23, v172, v12, 0
    v_dot2_f32_bf16 v23, v173, v13, v23
    v_dot2_f32_bf16 v23, v174, v14, v23
    v_dot2_f32_bf16 v23, v175, v15, v23
    s_waitcnt vmcnt(8)
    buffer_load_dwordx4 v[172:175], v2, s[8:11], s32 offen offset:3072 nt
    buffer_load_dwordx4 a[80:83], v6, s[24:27], s34 offen offset:0
    v_dot2_f32_bf16 v24, v176, v12, 0
    v_dot2_f32_bf16 v24, v177, v13, v24
    v_dot2_f32_bf16 v24, v178, v14, v24
    v_dot2_f32_bf16 v24, v179, v15, v24
    s_waitcnt vmcnt(8)
    buffer_load_dwordx4 v[176:179], v3, s[8:11], s32 offen offset:0 nt
    v_add_f32_dpp v20, v20, v20 row_mirror row_mask:0xf bank_mask:0xf
    v_add_f32_dpp v21, v21, v21 row_mirror row_mask:0xf bank_mask:0xf
    s_nop 0
    v_add_f32_dpp v20, v22, v22 row_mirror row_mask:0xf bank_mask:0xc
    v_add_f32_dpp v21, v23, v23 row_mirror row_mask:0xf bank_mask:0xc
    s_nop 0
    v_add_f32_dpp v20, v20, v20 row_half_mirror row_mask:0xf bank_mask:0xf
    s_nop 1
    v_add_f32_dpp v20, v21, v21 row_half_mirror row_mask:0xf bank_mask:0xa
    s_nop 1
    v_add_f32_dpp v20, v20, v20 quad_perm:[1,0,3,2] row_mask:0xf bank_mask:0xf
    s_nop 1
    v_add_f32_dpp v20, v20, v20 quad_perm:[2,3,0,1] row_mask:0xf bank_mask:0xf
    v_cvt_pk_bf16_f32 v20, v20, v20
    v_and_b32 v20, s47, v20
    v_mul_f32 v20, s45, v20
    v_cvt_pk_bf16_f32 v20, v20, v20
    v_and_b32 v110, s47, v20
    buffer_load_dwordx4 a[84:87], v6, s[24:27], s34 offen offset:256
    v_dot2_f32_bf16 v25, v180, v12, 0
    v_dot2_f32_bf16 v25, v181, v13, v25
    v_dot2_f32_bf16 v25, v182, v14, v25
    v_dot2_f32_bf16 v25, v183, v15, v25
    s_waitcnt vmcnt(8)
    buffer_load_dwordx4 v[180:183], v3, s[8:11], s32 offen offset:1024 nt
    buffer_load_dwordx4 a[88:91], v6, s[24:27], s34 offen offset:512
    v_dot2_f32_bf16 v26, v184, v12, 0
    v_dot2_f32_bf16 v26, v185, v13, v26
    v_dot2_f32_bf16 v26, v186, v14, v26
    v_dot2_f32_bf16 v26, v187, v15, v26
    s_waitcnt vmcnt(8)
    buffer_load_dwordx4 v[184:187], v3, s[8:11], s32 offen offset:2048 nt
    buffer_load_dwordx4 a[92:95], v6, s[24:27], s34 offen offset:768
    v_dot2_f32_bf16 v27, v188, v12, 0
    v_dot2_f32_bf16 v27, v189, v13, v27
    v_dot2_f32_bf16 v27, v190, v14, v27
    v_dot2_f32_bf16 v27, v191, v15, v27
    s_waitcnt vmcnt(9)
    buffer_load_dwordx4 v[188:191], v3, s[8:11], s32 offen offset:3072 nt
    v_add_f32_dpp v24, v24, v24 row_mirror row_mask:0xf bank_mask:0xf
    v_add_f32_dpp v25, v25, v25 row_mirror row_mask:0xf bank_mask:0xf
    s_nop 0
    v_add_f32_dpp v24, v26, v26 row_mirror row_mask:0xf bank_mask:0xc
    v_add_f32_dpp v25, v27, v27 row_mirror row_mask:0xf bank_mask:0xc
    s_nop 0
    v_add_f32_dpp v24, v24, v24 row_half_mirror row_mask:0xf bank_mask:0xf
    s_nop 1
    v_add_f32_dpp v24, v25, v25 row_half_mirror row_mask:0xf bank_mask:0xa
    s_nop 1
    v_add_f32_dpp v24, v24, v24 quad_perm:[1,0,3,2] row_mask:0xf bank_mask:0xf
    s_nop 1
    v_add_f32_dpp v24, v24, v24 quad_perm:[2,3,0,1] row_mask:0xf bank_mask:0xf
    v_cvt_pk_bf16_f32 v24, v24, v24
    v_and_b32 v24, s47, v24
    v_mul_f32 v24, s45, v24
    v_cvt_pk_bf16_f32 v24, v24, v24
    v_and_b32 v111, s47, v24
    ds_write_b64 v116, v[110:111]
    v_max3_f32 v28, v28, v110, v111
    v_add_u32 v116, 512, v116
    buffer_load_dwordx4 a[96:99], v6, s[24:27], s34 offen offset:1024
    s_add_u32 s34, s34, 5120
    s_add_u32 s32, s32, 32768
    v_dot2_f32_bf16 v20, v192, v12, 0
    v_dot2_f32_bf16 v20, v193, v13, v20
    v_dot2_f32_bf16 v20, v194, v14, v20
    v_dot2_f32_bf16 v20, v195, v15, v20
    s_waitcnt vmcnt(10)
    buffer_load_dwordx4 v[192:195], v2, s[8:11], s32 offen offset:0 nt
    v_dot2_f32_bf16 v21, v196, v12, 0
    v_dot2_f32_bf16 v21, v197, v13, v21
    v_dot2_f32_bf16 v21, v198, v14, v21
    v_dot2_f32_bf16 v21, v199, v15, v21
    s_waitcnt vmcnt(10)
    buffer_load_dwordx4 v[196:199], v2, s[8:11], s32 offen offset:1024 nt
    v_dot2_f32_bf16 v22, v200, v12, 0
    v_dot2_f32_bf16 v22, v201, v13, v22
    v_dot2_f32_bf16 v22, v202, v14, v22
    v_dot2_f32_bf16 v22, v203, v15, v22
    s_waitcnt vmcnt(9)
    buffer_load_dwordx4 v[200:203], v2, s[8:11], s32 offen offset:2048 nt
    v_and_b32_dpp v40, v50, v8 row_newbcast:5 row_mask:0xf bank_mask:0xf
    v_and_b32_dpp v41, v50, v9 row_newbcast:5 row_mask:0xf bank_mask:0xf
    v_and_b32_dpp v42, v50, v10 row_newbcast:5 row_mask:0xf bank_mask:0xf
    v_and_b32_dpp v43, v50, v11 row_newbcast:5 row_mask:0xf bank_mask:0xf
    s_nop 1
    v_mfma_f32_16x16x32_bf16 v[52:55], v[40:43], a[100:103], v[52:55]
    v_mfma_f32_16x16x32_bf16 v[56:59], v[40:43], a[104:107], v[56:59]
    v_mfma_f32_16x16x32_bf16 v[60:63], v[40:43], a[108:111], v[60:63]
    v_mfma_f32_16x16x32_bf16 v[64:67], v[40:43], a[112:115], v[64:67]
    v_mfma_f32_16x16x32_bf16 v[68:71], v[40:43], a[116:119], v[68:71]
    v_dot2_f32_bf16 v23, v204, v12, 0
    v_dot2_f32_bf16 v23, v205, v13, v23
    v_dot2_f32_bf16 v23, v206, v14, v23
    v_dot2_f32_bf16 v23, v207, v15, v23
    s_waitcnt vmcnt(8)
    buffer_load_dwordx4 v[204:207], v2, s[8:11], s32 offen offset:3072 nt
    buffer_load_dwordx4 a[100:103], v6, s[24:27], s34 offen offset:0
    v_dot2_f32_bf16 v24, v208, v12, 0
    v_dot2_f32_bf16 v24, v209, v13, v24
    v_dot2_f32_bf16 v24, v210, v14, v24
    v_dot2_f32_bf16 v24, v211, v15, v24
    s_waitcnt vmcnt(8)
    buffer_load_dwordx4 v[208:211], v3, s[8:11], s32 offen offset:0 nt
    v_add_f32_dpp v20, v20, v20 row_mirror row_mask:0xf bank_mask:0xf
    v_add_f32_dpp v21, v21, v21 row_mirror row_mask:0xf bank_mask:0xf
    s_nop 0
    v_add_f32_dpp v20, v22, v22 row_mirror row_mask:0xf bank_mask:0xc
    v_add_f32_dpp v21, v23, v23 row_mirror row_mask:0xf bank_mask:0xc
    s_nop 0
    v_add_f32_dpp v20, v20, v20 row_half_mirror row_mask:0xf bank_mask:0xf
    s_nop 1
    v_add_f32_dpp v20, v21, v21 row_half_mirror row_mask:0xf bank_mask:0xa
    s_nop 1
    v_add_f32_dpp v20, v20, v20 quad_perm:[1,0,3,2] row_mask:0xf bank_mask:0xf
    s_nop 1
    v_add_f32_dpp v20, v20, v20 quad_perm:[2,3,0,1] row_mask:0xf bank_mask:0xf
    v_cvt_pk_bf16_f32 v20, v20, v20
    v_and_b32 v20, s47, v20
    v_mul_f32 v20, s45, v20
    v_cvt_pk_bf16_f32 v20, v20, v20
    v_and_b32 v110, s47, v20
    buffer_load_dwordx4 a[104:107], v6, s[24:27], s34 offen offset:256
    v_dot2_f32_bf16 v25, v212, v12, 0
    v_dot2_f32_bf16 v25, v213, v13, v25
    v_dot2_f32_bf16 v25, v214, v14, v25
    v_dot2_f32_bf16 v25, v215, v15, v25
    s_waitcnt vmcnt(8)
    buffer_load_dwordx4 v[212:215], v3, s[8:11], s32 offen offset:1024 nt
    buffer_load_dwordx4 a[108:111], v6, s[24:27], s34 offen offset:512
    v_dot2_f32_bf16 v26, v216, v12, 0
    v_dot2_f32_bf16 v26, v217, v13, v26
    v_dot2_f32_bf16 v26, v218, v14, v26
    v_dot2_f32_bf16 v26, v219, v15, v26
    s_waitcnt vmcnt(8)
    buffer_load_dwordx4 v[216:219], v3, s[8:11], s32 offen offset:2048 nt
    buffer_load_dwordx4 a[112:115], v6, s[24:27], s34 offen offset:768
    v_dot2_f32_bf16 v27, v220, v12, 0
    v_dot2_f32_bf16 v27, v221, v13, v27
    v_dot2_f32_bf16 v27, v222, v14, v27
    v_dot2_f32_bf16 v27, v223, v15, v27
    s_waitcnt vmcnt(9)
    buffer_load_dwordx4 v[220:223], v3, s[8:11], s32 offen offset:3072 nt
    v_add_f32_dpp v24, v24, v24 row_mirror row_mask:0xf bank_mask:0xf
    v_add_f32_dpp v25, v25, v25 row_mirror row_mask:0xf bank_mask:0xf
    s_nop 0
    v_add_f32_dpp v24, v26, v26 row_mirror row_mask:0xf bank_mask:0xc
    v_add_f32_dpp v25, v27, v27 row_mirror row_mask:0xf bank_mask:0xc
    s_nop 0
    v_add_f32_dpp v24, v24, v24 row_half_mirror row_mask:0xf bank_mask:0xf
    s_nop 1
    v_add_f32_dpp v24, v25, v25 row_half_mirror row_mask:0xf bank_mask:0xa
    s_nop 1
    v_add_f32_dpp v24, v24, v24 quad_perm:[1,0,3,2] row_mask:0xf bank_mask:0xf
    s_nop 1
    v_add_f32_dpp v24, v24, v24 quad_perm:[2,3,0,1] row_mask:0xf bank_mask:0xf
    v_cvt_pk_bf16_f32 v24, v24, v24
    v_and_b32 v24, s47, v24
    v_mul_f32 v24, s45, v24
    v_cvt_pk_bf16_f32 v24, v24, v24
    v_and_b32 v111, s47, v24
    ds_write_b64 v116, v[110:111]
    v_max3_f32 v28, v28, v110, v111
    v_add_u32 v116, 512, v116
    buffer_load_dwordx4 a[116:119], v6, s[24:27], s34 offen offset:1024
    s_add_u32 s34, s34, 5120
    s_add_u32 s32, s32, 32768
    v_dot2_f32_bf16 v20, v224, v12, 0
    v_dot2_f32_bf16 v20, v225, v13, v20
    v_dot2_f32_bf16 v20, v226, v14, v20
    v_dot2_f32_bf16 v20, v227, v15, v20
    s_waitcnt vmcnt(10)
    buffer_load_dwordx4 v[224:227], v2, s[8:11], s32 offen offset:0 nt
    v_dot2_f32_bf16 v21, v228, v12, 0
    v_dot2_f32_bf16 v21, v229, v13, v21
    v_dot2_f32_bf16 v21, v230, v14, v21
    v_dot2_f32_bf16 v21, v231, v15, v21
    s_waitcnt vmcnt(10)
    buffer_load_dwordx4 v[228:231], v2, s[8:11], s32 offen offset:1024 nt
    v_dot2_f32_bf16 v22, v232, v12, 0
    v_dot2_f32_bf16 v22, v233, v13, v22
    v_dot2_f32_bf16 v22, v234, v14, v22
    v_dot2_f32_bf16 v22, v235, v15, v22
    s_waitcnt vmcnt(9)
    buffer_load_dwordx4 v[232:235], v2, s[8:11], s32 offen offset:2048 nt
    v_and_b32_dpp v36, v50, v8 row_newbcast:6 row_mask:0xf bank_mask:0xf
    v_and_b32_dpp v37, v50, v9 row_newbcast:6 row_mask:0xf bank_mask:0xf
    v_and_b32_dpp v38, v50, v10 row_newbcast:6 row_mask:0xf bank_mask:0xf
    v_and_b32_dpp v39, v50, v11 row_newbcast:6 row_mask:0xf bank_mask:0xf
    s_nop 1
    v_mfma_f32_16x16x32_bf16 v[52:55], v[36:39], a[120:123], v[52:55]
    v_mfma_f32_16x16x32_bf16 v[56:59], v[36:39], a[124:127], v[56:59]
    v_mfma_f32_16x16x32_bf16 v[60:63], v[36:39], a[128:131], v[60:63]
    v_mfma_f32_16x16x32_bf16 v[64:67], v[36:39], a[132:135], v[64:67]
    v_mfma_f32_16x16x32_bf16 v[68:71], v[36:39], a[136:139], v[68:71]
    v_dot2_f32_bf16 v23, v236, v12, 0
    v_dot2_f32_bf16 v23, v237, v13, v23
    v_dot2_f32_bf16 v23, v238, v14, v23
    v_dot2_f32_bf16 v23, v239, v15, v23
    s_waitcnt vmcnt(8)
    buffer_load_dwordx4 v[236:239], v2, s[8:11], s32 offen offset:3072 nt
    buffer_load_dwordx4 a[120:123], v6, s[24:27], s34 offen offset:0
    v_dot2_f32_bf16 v24, v240, v12, 0
    v_dot2_f32_bf16 v24, v241, v13, v24
    v_dot2_f32_bf16 v24, v242, v14, v24
    v_dot2_f32_bf16 v24, v243, v15, v24
    s_waitcnt vmcnt(8)
    buffer_load_dwordx4 v[240:243], v3, s[8:11], s32 offen offset:0 nt
    v_add_f32_dpp v20, v20, v20 row_mirror row_mask:0xf bank_mask:0xf
    v_add_f32_dpp v21, v21, v21 row_mirror row_mask:0xf bank_mask:0xf
    s_nop 0
    v_add_f32_dpp v20, v22, v22 row_mirror row_mask:0xf bank_mask:0xc
    v_add_f32_dpp v21, v23, v23 row_mirror row_mask:0xf bank_mask:0xc
    s_nop 0
    v_add_f32_dpp v20, v20, v20 row_half_mirror row_mask:0xf bank_mask:0xf
    s_nop 1
    v_add_f32_dpp v20, v21, v21 row_half_mirror row_mask:0xf bank_mask:0xa
    s_nop 1
    v_add_f32_dpp v20, v20, v20 quad_perm:[1,0,3,2] row_mask:0xf bank_mask:0xf
    s_nop 1
    v_add_f32_dpp v20, v20, v20 quad_perm:[2,3,0,1] row_mask:0xf bank_mask:0xf
    v_cvt_pk_bf16_f32 v20, v20, v20
    v_and_b32 v20, s47, v20
    v_mul_f32 v20, s45, v20
    v_cvt_pk_bf16_f32 v20, v20, v20
    v_and_b32 v110, s47, v20
    buffer_load_dwordx4 a[124:127], v6, s[24:27], s34 offen offset:256
    v_dot2_f32_bf16 v25, v244, v12, 0
    v_dot2_f32_bf16 v25, v245, v13, v25
    v_dot2_f32_bf16 v25, v246, v14, v25
    v_dot2_f32_bf16 v25, v247, v15, v25
    s_waitcnt vmcnt(8)
    buffer_load_dwordx4 v[244:247], v3, s[8:11], s32 offen offset:1024 nt
    buffer_load_dwordx4 a[128:131], v6, s[24:27], s34 offen offset:512
    v_dot2_f32_bf16 v26, v248, v12, 0
    v_dot2_f32_bf16 v26, v249, v13, v26
    v_dot2_f32_bf16 v26, v250, v14, v26
    v_dot2_f32_bf16 v26, v251, v15, v26
    s_waitcnt vmcnt(8)
    buffer_load_dwordx4 v[248:251], v3, s[8:11], s32 offen offset:2048 nt
    buffer_load_dwordx4 a[132:135], v6, s[24:27], s34 offen offset:768
    v_dot2_f32_bf16 v27, v252, v12, 0
    v_dot2_f32_bf16 v27, v253, v13, v27
    v_dot2_f32_bf16 v27, v254, v14, v27
    v_dot2_f32_bf16 v27, v255, v15, v27
    s_waitcnt vmcnt(9)
    buffer_load_dwordx4 v[252:255], v3, s[8:11], s32 offen offset:3072 nt
    v_add_f32_dpp v24, v24, v24 row_mirror row_mask:0xf bank_mask:0xf
    v_add_f32_dpp v25, v25, v25 row_mirror row_mask:0xf bank_mask:0xf
    s_nop 0
    v_add_f32_dpp v24, v26, v26 row_mirror row_mask:0xf bank_mask:0xc
    v_add_f32_dpp v25, v27, v27 row_mirror row_mask:0xf bank_mask:0xc
    s_nop 0
    v_add_f32_dpp v24, v24, v24 row_half_mirror row_mask:0xf bank_mask:0xf
    s_nop 1
    v_add_f32_dpp v24, v25, v25 row_half_mirror row_mask:0xf bank_mask:0xa
    s_nop 1
    v_add_f32_dpp v24, v24, v24 quad_perm:[1,0,3,2] row_mask:0xf bank_mask:0xf
    s_nop 1
    v_add_f32_dpp v24, v24, v24 quad_perm:[2,3,0,1] row_mask:0xf bank_mask:0xf
    v_cvt_pk_bf16_f32 v24, v24, v24
    v_and_b32 v24, s47, v24
    v_mul_f32 v24, s45, v24
    v_cvt_pk_bf16_f32 v24, v24, v24
    v_and_b32 v111, s47, v24
    ds_write_b64 v116, v[110:111]
    v_max3_f32 v28, v28, v110, v111
    v_add_u32 v116, 512, v116
    buffer_load_dwordx4 a[136:139], v6, s[24:27], s34 offen offset:1024
    s_add_u32 s34, s34, 5120
    s_add_u32 s32, s32, 32768
    v_dot2_f32_bf16 v20, v128, v12, 0
    v_dot2_f32_bf16 v20, v129, v13, v20
    v_dot2_f32_bf16 v20, v130, v14, v20
    v_dot2_f32_bf16 v20, v131, v15, v20
    s_waitcnt vmcnt(10)
    buffer_load_dwordx4 v[128:131], v2, s[8:11], s32 offen offset:0 nt
    v_dot2_f32_bf16 v21, v132, v12, 0
    v_dot2_f32_bf16 v21, v133, v13, v21
    v_dot2_f32_bf16 v21, v134, v14, v21
    v_dot2_f32_bf16 v21, v135, v15, v21
    s_waitcnt vmcnt(10)
    buffer_load_dwordx4 v[132:135], v2, s[8:11], s32 offen offset:1024 nt
    v_dot2_f32_bf16 v22, v136, v12, 0
    v_dot2_f32_bf16 v22, v137, v13, v22
    v_dot2_f32_bf16 v22, v138, v14, v22
    v_dot2_f32_bf16 v22, v139, v15, v22
    s_waitcnt vmcnt(9)
    buffer_load_dwordx4 v[136:139], v2, s[8:11], s32 offen offset:2048 nt
    v_and_b32_dpp v40, v50, v8 row_newbcast:7 row_mask:0xf bank_mask:0xf
    v_and_b32_dpp v41, v50, v9 row_newbcast:7 row_mask:0xf bank_mask:0xf
    v_and_b32_dpp v42, v50, v10 row_newbcast:7 row_mask:0xf bank_mask:0xf
    v_and_b32_dpp v43, v50, v11 row_newbcast:7 row_mask:0xf bank_mask:0xf
    s_nop 1
    v_mfma_f32_16x16x32_bf16 v[52:55], v[40:43], a[140:143], v[52:55]
    v_mfma_f32_16x16x32_bf16 v[56:59], v[40:43], a[144:147], v[56:59]
    v_mfma_f32_16x16x32_bf16 v[60:63], v[40:43], a[148:151], v[60:63]
    v_mfma_f32_16x16x32_bf16 v[64:67], v[40:43], a[152:155], v[64:67]
    v_mfma_f32_16x16x32_bf16 v[68:71], v[40:43], a[156:159], v[68:71]
    v_dot2_f32_bf16 v23, v140, v12, 0
    v_dot2_f32_bf16 v23, v141, v13, v23
    v_dot2_f32_bf16 v23, v142, v14, v23
    v_dot2_f32_bf16 v23, v143, v15, v23
    s_waitcnt vmcnt(8)
    buffer_load_dwordx4 v[140:143], v2, s[8:11], s32 offen offset:3072 nt
    buffer_load_dwordx4 a[140:143], v6, s[24:27], s34 offen offset:0
    v_dot2_f32_bf16 v24, v144, v12, 0
    v_dot2_f32_bf16 v24, v145, v13, v24
    v_dot2_f32_bf16 v24, v146, v14, v24
    v_dot2_f32_bf16 v24, v147, v15, v24
    s_waitcnt vmcnt(8)
    buffer_load_dwordx4 v[144:147], v3, s[8:11], s32 offen offset:0 nt
    v_add_f32_dpp v20, v20, v20 row_mirror row_mask:0xf bank_mask:0xf
    v_add_f32_dpp v21, v21, v21 row_mirror row_mask:0xf bank_mask:0xf
    s_nop 0
    v_add_f32_dpp v20, v22, v22 row_mirror row_mask:0xf bank_mask:0xc
    v_add_f32_dpp v21, v23, v23 row_mirror row_mask:0xf bank_mask:0xc
    s_nop 0
    v_add_f32_dpp v20, v20, v20 row_half_mirror row_mask:0xf bank_mask:0xf
    s_nop 1
    v_add_f32_dpp v20, v21, v21 row_half_mirror row_mask:0xf bank_mask:0xa
    s_nop 1
    v_add_f32_dpp v20, v20, v20 quad_perm:[1,0,3,2] row_mask:0xf bank_mask:0xf
    s_nop 1
    v_add_f32_dpp v20, v20, v20 quad_perm:[2,3,0,1] row_mask:0xf bank_mask:0xf
    v_cvt_pk_bf16_f32 v20, v20, v20
    v_and_b32 v20, s47, v20
    v_mul_f32 v20, s45, v20
    v_cvt_pk_bf16_f32 v20, v20, v20
    v_and_b32 v110, s47, v20
    buffer_load_dwordx4 a[144:147], v6, s[24:27], s34 offen offset:256
    v_dot2_f32_bf16 v25, v148, v12, 0
    v_dot2_f32_bf16 v25, v149, v13, v25
    v_dot2_f32_bf16 v25, v150, v14, v25
    v_dot2_f32_bf16 v25, v151, v15, v25
    s_waitcnt vmcnt(8)
    buffer_load_dwordx4 v[148:151], v3, s[8:11], s32 offen offset:1024 nt
    buffer_load_dwordx4 a[148:151], v6, s[24:27], s34 offen offset:512
    v_dot2_f32_bf16 v26, v152, v12, 0
    v_dot2_f32_bf16 v26, v153, v13, v26
    v_dot2_f32_bf16 v26, v154, v14, v26
    v_dot2_f32_bf16 v26, v155, v15, v26
    s_waitcnt vmcnt(8)
    buffer_load_dwordx4 v[152:155], v3, s[8:11], s32 offen offset:2048 nt
    buffer_load_dwordx4 a[152:155], v6, s[24:27], s34 offen offset:768
    v_dot2_f32_bf16 v27, v156, v12, 0
    v_dot2_f32_bf16 v27, v157, v13, v27
    v_dot2_f32_bf16 v27, v158, v14, v27
    v_dot2_f32_bf16 v27, v159, v15, v27
    s_waitcnt vmcnt(9)
    buffer_load_dwordx4 v[156:159], v3, s[8:11], s32 offen offset:3072 nt
    v_add_f32_dpp v24, v24, v24 row_mirror row_mask:0xf bank_mask:0xf
    v_add_f32_dpp v25, v25, v25 row_mirror row_mask:0xf bank_mask:0xf
    s_nop 0
    v_add_f32_dpp v24, v26, v26 row_mirror row_mask:0xf bank_mask:0xc
    v_add_f32_dpp v25, v27, v27 row_mirror row_mask:0xf bank_mask:0xc
    s_nop 0
    v_add_f32_dpp v24, v24, v24 row_half_mirror row_mask:0xf bank_mask:0xf
    s_nop 1
    v_add_f32_dpp v24, v25, v25 row_half_mirror row_mask:0xf bank_mask:0xa
    s_nop 1
    v_add_f32_dpp v24, v24, v24 quad_perm:[1,0,3,2] row_mask:0xf bank_mask:0xf
    s_nop 1
    v_add_f32_dpp v24, v24, v24 quad_perm:[2,3,0,1] row_mask:0xf bank_mask:0xf
    v_cvt_pk_bf16_f32 v24, v24, v24
    v_and_b32 v24, s47, v24
    v_mul_f32 v24, s45, v24
    v_cvt_pk_bf16_f32 v24, v24, v24
    v_and_b32 v111, s47, v24
    ds_write_b64 v116, v[110:111]
    v_max3_f32 v28, v28, v110, v111
    v_add_u32 v116, 512, v116
    buffer_load_dwordx4 a[156:159], v6, s[24:27], s34 offen offset:1024
    s_add_u32 s34, s34, 5120
    s_add_u32 s32, s32, 32768
    v_dot2_f32_bf16 v20, v160, v12, 0
    v_dot2_f32_bf16 v20, v161, v13, v20
    v_dot2_f32_bf16 v20, v162, v14, v20
    v_dot2_f32_bf16 v20, v163, v15, v20
    s_waitcnt vmcnt(9)
    buffer_load_dwordx4 v[160:163], v2, s[8:11], s32 offen offset:0 nt
    s_mov_b32 exec_hi, 0
    ds_write_b128 v108, v[52:55] offset:12288
    ds_write_b128 v108, v[56:59] offset:12800
    ds_write_b128 v108, v[60:63] offset:13312
    ds_write_b128 v108, v[64:67] offset:13824
    ds_write_b128 v108, v[68:71] offset:14336
    s_mov_b64 exec, -1
    v_dot2_f32_bf16 v21, v164, v12, 0
    v_dot2_f32_bf16 v21, v165, v13, v21
    v_dot2_f32_bf16 v21, v166, v14, v21
    v_dot2_f32_bf16 v21, v167, v15, v21
    s_waitcnt vmcnt(8)
    buffer_load_dwordx4 v[164:167], v2, s[8:11], s32 offen offset:1024 nt
    v_dot2_f32_bf16 v22, v168, v12, 0
    v_dot2_f32_bf16 v22, v169, v13, v22
    v_dot2_f32_bf16 v22, v170, v14, v22
    v_dot2_f32_bf16 v22, v171, v15, v22
    s_waitcnt vmcnt(7)
    buffer_load_dwordx4 v[168:171], v2, s[8:11], s32 offen offset:2048 nt
    v_dot2_f32_bf16 v23, v172, v12, 0
    v_dot2_f32_bf16 v23, v173, v13, v23
    v_dot2_f32_bf16 v23, v174, v14, v23
    v_dot2_f32_bf16 v23, v175, v15, v23
    s_waitcnt vmcnt(6)
    buffer_load_dwordx4 v[172:175], v2, s[8:11], s32 offen offset:3072 nt
    v_dot2_f32_bf16 v24, v176, v12, 0
    v_dot2_f32_bf16 v24, v177, v13, v24
    v_dot2_f32_bf16 v24, v178, v14, v24
    v_dot2_f32_bf16 v24, v179, v15, v24
    s_waitcnt vmcnt(5)
    buffer_load_dwordx4 v[176:179], v3, s[8:11], s32 offen offset:0 nt
    v_add_f32_dpp v20, v20, v20 row_mirror row_mask:0xf bank_mask:0xf
    v_add_f32_dpp v21, v21, v21 row_mirror row_mask:0xf bank_mask:0xf
    s_nop 0
    v_add_f32_dpp v20, v22, v22 row_mirror row_mask:0xf bank_mask:0xc
    v_add_f32_dpp v21, v23, v23 row_mirror row_mask:0xf bank_mask:0xc
    s_nop 0
    v_add_f32_dpp v20, v20, v20 row_half_mirror row_mask:0xf bank_mask:0xf
    s_nop 1
    v_add_f32_dpp v20, v21, v21 row_half_mirror row_mask:0xf bank_mask:0xa
    s_nop 1
    v_add_f32_dpp v20, v20, v20 quad_perm:[1,0,3,2] row_mask:0xf bank_mask:0xf
    s_nop 1
    v_add_f32_dpp v20, v20, v20 quad_perm:[2,3,0,1] row_mask:0xf bank_mask:0xf
    v_cvt_pk_bf16_f32 v20, v20, v20
    v_and_b32 v20, s47, v20
    v_mul_f32 v20, s45, v20
    v_cvt_pk_bf16_f32 v20, v20, v20
    v_and_b32 v110, s47, v20
    v_dot2_f32_bf16 v25, v180, v12, 0
    v_dot2_f32_bf16 v25, v181, v13, v25
    v_dot2_f32_bf16 v25, v182, v14, v25
    v_dot2_f32_bf16 v25, v183, v15, v25
    s_waitcnt vmcnt(4)
    buffer_load_dwordx4 v[180:183], v3, s[8:11], s32 offen offset:1024 nt
    v_dot2_f32_bf16 v26, v184, v12, 0
    v_dot2_f32_bf16 v26, v185, v13, v26
    v_dot2_f32_bf16 v26, v186, v14, v26
    v_dot2_f32_bf16 v26, v187, v15, v26
    s_waitcnt vmcnt(4)
    buffer_load_dwordx4 v[184:187], v3, s[8:11], s32 offen offset:2048 nt
    v_dot2_f32_bf16 v27, v188, v12, 0
    v_dot2_f32_bf16 v27, v189, v13, v27
    v_dot2_f32_bf16 v27, v190, v14, v27
    v_dot2_f32_bf16 v27, v191, v15, v27
    s_waitcnt vmcnt(4)
    buffer_load_dwordx4 v[188:191], v3, s[8:11], s32 offen offset:3072 nt
    v_add_f32_dpp v24, v24, v24 row_mirror row_mask:0xf bank_mask:0xf
    v_add_f32_dpp v25, v25, v25 row_mirror row_mask:0xf bank_mask:0xf
    s_nop 0
    v_add_f32_dpp v24, v26, v26 row_mirror row_mask:0xf bank_mask:0xc
    v_add_f32_dpp v25, v27, v27 row_mirror row_mask:0xf bank_mask:0xc
    s_nop 0
    v_add_f32_dpp v24, v24, v24 row_half_mirror row_mask:0xf bank_mask:0xf
    s_nop 1
    v_add_f32_dpp v24, v25, v25 row_half_mirror row_mask:0xf bank_mask:0xa
    s_nop 1
    v_add_f32_dpp v24, v24, v24 quad_perm:[1,0,3,2] row_mask:0xf bank_mask:0xf
    s_nop 1
    v_add_f32_dpp v24, v24, v24 quad_perm:[2,3,0,1] row_mask:0xf bank_mask:0xf
    v_cvt_pk_bf16_f32 v24, v24, v24
    v_and_b32 v24, s47, v24
    v_mul_f32 v24, s45, v24
    v_cvt_pk_bf16_f32 v24, v24, v24
    v_and_b32 v111, s47, v24
    ds_write_b64 v116, v[110:111]
    v_max3_f32 v28, v28, v110, v111
    v_add_u32 v116, 512, v116
    s_add_u32 s32, s32, 32768
    v_dot2_f32_bf16 v20, v192, v12, 0
    v_dot2_f32_bf16 v20, v193, v13, v20
    v_dot2_f32_bf16 v20, v194, v14, v20
    v_dot2_f32_bf16 v20, v195, v15, v20
    s_waitcnt vmcnt(4)
    buffer_load_dwordx4 v[192:195], v2, s[8:11], s32 offen offset:0 nt
    s_waitcnt lgkmcnt(0)
    s_barrier
    v_cmp_gt_u32 vcc, 160, v0
    s_nop 0
    s_and_saveexec_b64 s[4:5], vcc
    s_cbranch_execz L_sk2
    v_lshlrev_b32 v88, 4, v0
    ds_read_b128 v[72:75], v88 offset:12288
    ds_read_b128 v[76:79], v88 offset:14848
    ds_read_b128 v[80:83], v88 offset:17408
    ds_read_b128 v[84:87], v88 offset:19968
    s_mul_i32 s3, s2, 5120
    s_waitcnt lgkmcnt(0)
    v_add_f32 v72, v72, v76
    v_add_f32 v73, v73, v77
    v_add_f32 v74, v74, v78
    v_add_f32 v75, v75, v79
    v_add_f32 v72, v72, v80
    v_add_f32 v73, v73, v81
    v_add_f32 v74, v74, v82
    v_add_f32 v75, v75, v83
    v_add_f32 v72, v72, v84
    v_add_f32 v73, v73, v85
    v_add_f32 v74, v74, v86
    v_add_f32 v75, v75, v87
    buffer_store_dwordx4 v[72:75], v88, s[48:51], s3 offen offset:0
L_sk2:
    s_mov_b64 exec, -1
    v_mov_b32 v52, 0
    v_mov_b32 v53, 0
    v_mov_b32 v54, 0
    v_mov_b32 v55, 0
    v_mov_b32 v56, 0
    v_mov_b32 v57, 0
    v_mov_b32 v58, 0
    v_mov_b32 v59, 0
    v_mov_b32 v60, 0
    v_mov_b32 v61, 0
    v_mov_b32 v62, 0
    v_mov_b32 v63, 0
    v_mov_b32 v64, 0
    v_mov_b32 v65, 0
    v_mov_b32 v66, 0
    v_mov_b32 v67, 0
    v_mov_b32 v68, 0
    v_mov_b32 v69, 0
    v_mov_b32 v70, 0
    v_mov_b32 v71, 0
    v_dot2_f32_bf16 v21, v196, v12, 0
    v_dot2_f32_bf16 v21, v197, v13, v21
    v_dot2_f32_bf16 v21, v198, v14, v21
    v_dot2_f32_bf16 v21, v199, v15, v21
    s_waitcnt vmcnt(4)
    buffer_load_dwordx4 v[196:199], v2, s[8:11], s32 offen offset:1024 nt
    v_dot2_f32_bf16 v22, v200, v12, 0
    v_dot2_f32_bf16 v22, v201, v13, v22
    v_dot2_f32_bf16 v22, v202, v14, v22
    v_dot2_f32_bf16 v22, v203, v15, v22
    s_waitcnt vmcnt(4)
    buffer_load_dwordx4 v[200:203], v2, s[8:11], s32 offen offset:2048 nt
    v_dot2_f32_bf16 v23, v204, v12, 0
    v_dot2_f32_bf16 v23, v205, v13, v23
    v_dot2_f32_bf16 v23, v206, v14, v23
    v_dot2_f32_bf16 v23, v207, v15, v23
    s_waitcnt vmcnt(4)
    buffer_load_dwordx4 v[204:207], v2, s[8:11], s32 offen offset:3072 nt
    v_dot2_f32_bf16 v24, v208, v12, 0
    v_dot2_f32_bf16 v24, v209, v13, v24
    v_dot2_f32_bf16 v24, v210, v14, v24
    v_dot2_f32_bf16 v24, v211, v15, v24
    s_waitcnt vmcnt(4)
    buffer_load_dwordx4 v[208:211], v3, s[8:11], s32 offen offset:0 nt
    v_add_f32_dpp v20, v20, v20 row_mirror row_mask:0xf bank_mask:0xf
    v_add_f32_dpp v21, v21, v21 row_mirror row_mask:0xf bank_mask:0xf
    s_nop 0
    v_add_f32_dpp v20, v22, v22 row_mirror row_mask:0xf bank_mask:0xc
    v_add_f32_dpp v21, v23, v23 row_mirror row_mask:0xf bank_mask:0xc
    s_nop 0
    v_add_f32_dpp v20, v20, v20 row_half_mirror row_mask:0xf bank_mask:0xf
    s_nop 1
    v_add_f32_dpp v20, v21, v21 row_half_mirror row_mask:0xf bank_mask:0xa
    s_nop 1
    v_add_f32_dpp v20, v20, v20 quad_perm:[1,0,3,2] row_mask:0xf bank_mask:0xf
    s_nop 1
    v_add_f32_dpp v20, v20, v20 quad_perm:[2,3,0,1] row_mask:0xf bank_mask:0xf
    v_cvt_pk_bf16_f32 v20, v20, v20
    v_and_b32 v20, s47, v20
    v_mul_f32 v20, s45, v20
    v_cvt_pk_bf16_f32 v20, v20, v20
    v_and_b32 v110, s47, v20
    v_dot2_f32_bf16 v25, v212, v12, 0
    v_dot2_f32_bf16 v25, v213, v13, v25
    v_dot2_f32_bf16 v25, v214, v14, v25
    v_dot2_f32_bf16 v25, v215, v15, v25
    s_waitcnt vmcnt(4)
    buffer_load_dwordx4 v[212:215], v3, s[8:11], s32 offen offset:1024 nt
    v_dot2_f32_bf16 v26, v216, v12, 0
    v_dot2_f32_bf16 v26, v217, v13, v26
    v_dot2_f32_bf16 v26, v218, v14, v26
    v_dot2_f32_bf16 v26, v219, v15, v26
    s_waitcnt vmcnt(4)
    buffer_load_dwordx4 v[216:219], v3, s[8:11], s32 offen offset:2048 nt
    v_dot2_f32_bf16 v27, v220, v12, 0
    v_dot2_f32_bf16 v27, v221, v13, v27
    v_dot2_f32_bf16 v27, v222, v14, v27
    v_dot2_f32_bf16 v27, v223, v15, v27
    s_waitcnt vmcnt(4)
    buffer_load_dwordx4 v[220:223], v3, s[8:11], s32 offen offset:3072 nt
    v_add_f32_dpp v24, v24, v24 row_mirror row_mask:0xf bank_mask:0xf
    v_add_f32_dpp v25, v25, v25 row_mirror row_mask:0xf bank_mask:0xf
    s_nop 0
    v_add_f32_dpp v24, v26, v26 row_mirror row_mask:0xf bank_mask:0xc
    v_add_f32_dpp v25, v27, v27 row_mirror row_mask:0xf bank_mask:0xc
    s_nop 0
    v_add_f32_dpp v24, v24, v24 row_half_mirror row_mask:0xf bank_mask:0xf
    s_nop 1
    v_add_f32_dpp v24, v25, v25 row_half_mirror row_mask:0xf bank_mask:0xa
    s_nop 1
    v_add_f32_dpp v24, v24, v24 quad_perm:[1,0,3,2] row_mask:0xf bank_mask:0xf
    s_nop 1
    v_add_f32_dpp v24, v24, v24 quad_perm:[2,3,0,1] row_mask:0xf bank_mask:0xf
    v_cvt_pk_bf16_f32 v24, v24, v24
    v_and_b32 v24, s47, v24
    v_mul_f32 v24, s45, v24
    v_cvt_pk_bf16_f32 v24, v24, v24
    v_and_b32 v111, s47, v24
    ds_write_b64 v116, v[110:111]
    v_max3_f32 v28, v28, v110, v111
    v_add_u32 v116, 512, v116
    s_add_u32 s32, s32, 32768
    v_dot2_f32_bf16 v20, v224, v12, 0
    v_dot2_f32_bf16 v20, v225, v13, v20
    v_dot2_f32_bf16 v20, v226, v14, v20
    v_dot2_f32_bf16 v20, v227, v15, v20
    s_waitcnt vmcnt(4)
    buffer_load_dwordx4 v[224:227], v2, s[8:11], s32 offen offset:0 nt
    v_dot2_f32_bf16 v21, v228, v12, 0
    v_dot2_f32_bf16 v21, v229, v13, v21
    v_dot2_f32_bf16 v21, v230, v14, v21
    v_dot2_f32_bf16 v21, v231, v15, v21
    s_waitcnt vmcnt(4)
    buffer_load_dwordx4 v[228:231], v2, s[8:11], s32 offen offset:1024 nt
    v_dot2_f32_bf16 v22, v232, v12, 0
    v_dot2_f32_bf16 v22, v233, v13, v22
    v_dot2_f32_bf16 v22, v234, v14, v22
    v_dot2_f32_bf16 v22, v235, v15, v22
    s_waitcnt vmcnt(4)
    buffer_load_dwordx4 v[232:235], v2, s[8:11], s32 offen offset:2048 nt
    v_dot2_f32_bf16 v23, v236, v12, 0
    v_dot2_f32_bf16 v23, v237, v13, v23
    v_dot2_f32_bf16 v23, v238, v14, v23
    v_dot2_f32_bf16 v23, v239, v15, v23
    s_waitcnt vmcnt(4)
    buffer_load_dwordx4 v[236:239], v2, s[8:11], s32 offen offset:3072 nt
    v_dot2_f32_bf16 v24, v240, v12, 0
    v_dot2_f32_bf16 v24, v241, v13, v24
    v_dot2_f32_bf16 v24, v242, v14, v24
    v_dot2_f32_bf16 v24, v243, v15, v24
    s_waitcnt vmcnt(4)
    buffer_load_dwordx4 v[240:243], v3, s[8:11], s32 offen offset:0 nt
    v_add_f32_dpp v20, v20, v20 row_mirror row_mask:0xf bank_mask:0xf
    v_add_f32_dpp v21, v21, v21 row_mirror row_mask:0xf bank_mask:0xf
    s_nop 0
    v_add_f32_dpp v20, v22, v22 row_mirror row_mask:0xf bank_mask:0xc
    v_add_f32_dpp v21, v23, v23 row_mirror row_mask:0xf bank_mask:0xc
    s_nop 0
    v_add_f32_dpp v20, v20, v20 row_half_mirror row_mask:0xf bank_mask:0xf
    s_nop 1
    v_add_f32_dpp v20, v21, v21 row_half_mirror row_mask:0xf bank_mask:0xa
    s_nop 1
    v_add_f32_dpp v20, v20, v20 quad_perm:[1,0,3,2] row_mask:0xf bank_mask:0xf
    s_nop 1
    v_add_f32_dpp v20, v20, v20 quad_perm:[2,3,0,1] row_mask:0xf bank_mask:0xf
    v_cvt_pk_bf16_f32 v20, v20, v20
    v_and_b32 v20, s47, v20
    v_mul_f32 v20, s45, v20
    v_cvt_pk_bf16_f32 v20, v20, v20
    v_and_b32 v110, s47, v20
    v_dot2_f32_bf16 v25, v244, v12, 0
    v_dot2_f32_bf16 v25, v245, v13, v25
    v_dot2_f32_bf16 v25, v246, v14, v25
    v_dot2_f32_bf16 v25, v247, v15, v25
    s_waitcnt vmcnt(4)
    buffer_load_dwordx4 v[244:247], v3, s[8:11], s32 offen offset:1024 nt
    v_dot2_f32_bf16 v26, v248, v12, 0
    v_dot2_f32_bf16 v26, v249, v13, v26
    v_dot2_f32_bf16 v26, v250, v14, v26
    v_dot2_f32_bf16 v26, v251, v15, v26
    s_waitcnt vmcnt(4)
    buffer_load_dwordx4 v[248:251], v3, s[8:11], s32 offen offset:2048 nt
    v_dot2_f32_bf16 v27, v252, v12, 0
    v_dot2_f32_bf16 v27, v253, v13, v27
    v_dot2_f32_bf16 v27, v254, v14, v27
    v_dot2_f32_bf16 v27, v255, v15, v27
    s_waitcnt vmcnt(4)
    buffer_load_dwordx4 v[252:255], v3, s[8:11], s32 offen offset:3072 nt
    v_add_f32_dpp v24, v24, v24 row_mirror row_mask:0xf bank_mask:0xf
    v_add_f32_dpp v25, v25, v25 row_mirror row_mask:0xf bank_mask:0xf
    s_nop 0
    v_add_f32_dpp v24, v26, v26 row_mirror row_mask:0xf bank_mask:0xc
    v_add_f32_dpp v25, v27, v27 row_mirror row_mask:0xf bank_mask:0xc
    s_nop 0
    v_add_f32_dpp v24, v24, v24 row_half_mirror row_mask:0xf bank_mask:0xf
    s_nop 1
    v_add_f32_dpp v24, v25, v25 row_half_mirror row_mask:0xf bank_mask:0xa
    s_nop 1
    v_add_f32_dpp v24, v24, v24 quad_perm:[1,0,3,2] row_mask:0xf bank_mask:0xf
    s_nop 1
    v_add_f32_dpp v24, v24, v24 quad_perm:[2,3,0,1] row_mask:0xf bank_mask:0xf
    v_cvt_pk_bf16_f32 v24, v24, v24
    v_and_b32 v24, s47, v24
    v_mul_f32 v24, s45, v24
    v_cvt_pk_bf16_f32 v24, v24, v24
    v_and_b32 v111, s47, v24
    ds_write_b64 v116, v[110:111]
    v_max3_f32 v28, v28, v110, v111
    v_add_u32 v116, 512, v116
    s_add_u32 s32, s32, 32768
    s_mov_b32 s37, 5
.p2align 6
L_k0:
    s_cmp_lg_u32 s37, 1
    s_cbranch_scc1 L_sw3
    s_mov_b32 s8, s20
    s_mov_b32 s9, s21
    s_mov_b32 s10, s22
    s_mov_b32 s32, s41
L_sw3:
    s_waitcnt vmcnt(31)
    v_dot2_f32_bf16 v20, v128, v12, 0
    v_dot2_f32_bf16 v20, v129, v13, v20
    v_dot2_f32_bf16 v20, v130, v14, v20
    v_dot2_f32_bf16 v20, v131, v15, v20
    s_cmp_lg_u32 s52, 5
    s_cbranch_scc1 L_alt5
    s_waitcnt vmcnt(4)
L_go4:
    buffer_load_dwordx4 v[128:131], v2, s[8:11], s32 offen offset:0 nt
    s_add_u32 s33, s33, 1
    buffer_load_dword v121, v122, s[48:51], s35 offen nt
    s_cmp_lg_u32 s38, 0
    s_cbranch_scc1 L_cp6
    v_mov_b32 v123, s33
    s_mov_b64 exec, 1
    buffer_store_dword v123, v124, s[48:51], s35 offen
    s_mov_b64 exec, -1
L_cp6:
    s_waitcnt vmcnt(32)
    v_dot2_f32_bf16 v21, v132, v12, 0
    v_dot2_f32_bf16 v21, v133, v13, v21
    v_dot2_f32_bf16 v21, v134, v14, v21
    v_dot2_f32_bf16 v21, v135, v15, v21
    s_cmp_lg_u32 s53, 5
    s_cbranch_scc1 L_alt8
    s_waitcnt vmcnt(5)
L_go7:
    buffer_load_dwordx4 v[132:135], v2, s[8:11], s32 offen offset:1024 nt
    s_waitcnt vmcnt(32)
    v_dot2_f32_bf16 v22, v136, v12, 0
    v_dot2_f32_bf16 v22, v137, v13, v22
    v_dot2_f32_bf16 v22, v138, v14, v22
    v_dot2_f32_bf16 v22, v139, v15, v22
    s_cmp_lg_u32 s54, 5
    s_cbranch_scc1 L_alt10
    s_waitcnt vmcnt(5)
L_go9:
    buffer_load_dwordx4 v[136:139], v2, s[8:11], s32 offen offset:2048 nt
    s_waitcnt vmcnt(32)
    v_dot2_f32_bf16 v23, v140, v12, 0
    v_dot2_f32_bf16 v23, v141, v13, v23
    v_dot2_f32_bf16 v23, v142, v14, v23
    v_dot2_f32_bf16 v23, v143, v15, v23
    s_cmp_lg_u32 s55, 5
    s_cbranch_scc1 L_alt12
    s_waitcnt vmcnt(5)
L_go11:
    buffer_load_dwordx4 v[140:143], v2, s[8:11], s32 offen offset:3072 nt
    s_waitcnt vmcnt(32)
    v_dot2_f32_bf16 v24, v144, v12, 0
    v_dot2_f32_bf16 v24, v145, v13, v24
    v_dot2_f32_bf16 v24, v146, v14, v24
    v_dot2_f32_bf16 v24, v147, v15, v24
    s_cmp_lg_u32 s52, 5
    s_cbranch_scc1 L_alt14
    s_waitcnt vmcnt(5)
L_go13:
    buffer_load_dwordx4 v[144:147], v3, s[8:11], s32 offen offset:0 nt
    v_add_f32_dpp v20, v20, v20 row_mirror row_mask:0xf bank_mask:0xf
    v_add_f32_dpp v21, v21, v21 row_mirror row_mask:0xf bank_mask:0xf
    s_nop 0
    v_add_f32_dpp v20, v22, v22 row_mirror row_mask:0xf bank_mask:0xc
    v_add_f32_dpp v21, v23, v23 row_mirror row_mask:0xf bank_mask:0xc
    s_nop 0
    v_add_f32_dpp v20, v20, v20 row_half_mirror row_mask:0xf bank_mask:0xf
    s_nop 1
    v_add_f32_dpp v20, v21, v21 row_half_mirror row_mask:0xf bank_mask:0xa
    s_nop 1
    v_add_f32_dpp v20, v20, v20 quad_perm:[1,0,3,2] row_mask:0xf bank_mask:0xf
    s_nop 1
    v_add_f32_dpp v20, v20, v20 quad_perm:[2,3,0,1] row_mask:0xf bank_mask:0xf
    v_cvt_pk_bf16_f32 v20, v20, v20
    v_and_b32 v20, s47, v20
    v_mul_f32 v20, s45, v20
    v_cvt_pk_bf16_f32 v20, v20, v20
    v_and_b32 v110, s47, v20
    s_waitcnt vmcnt(32)
    v_dot2_f32_bf16 v25, v148, v12, 0
    v_dot2_f32_bf16 v25, v149, v13, v25
    v_dot2_f32_bf16 v25, v150, v14, v25
    v_dot2_f32_bf16 v25, v151, v15, v25
    s_cmp_lg_u32 s53, 5
    s_cbranch_scc1 L_alt16
    s_waitcnt vmcnt(5)
L_go15:
    buffer_load_dwordx4 v[148:151], v3, s[8:11], s32 offen offset:1024 nt
    s_waitcnt vmcnt(32)
    v_dot2_f32_bf16 v26, v152, v12, 0
    v_dot2_f32_bf16 v26, v153, v13, v26
    v_dot2_f32_bf16 v26, v154, v14, v26
    v_dot2_f32_bf16 v26, v155, v15, v26
    s_cmp_lg_u32 s54, 5
    s_cbranch_scc1 L_alt18
    s_waitcnt vmcnt(4)
L_go17:
    buffer_load_dwordx4 v[152:155], v3, s[8:11], s32 offen offset:2048 nt
    s_waitcnt vmcnt(32)
    v_dot2_f32_bf16 v27, v156, v12, 0
    v_dot2_f32_bf16 v27, v157, v13, v27
    v_dot2_f32_bf16 v27, v158, v14, v27
    v_dot2_f32_bf16 v27, v159, v15, v27
    s_cmp_lg_u32 s55, 5
    s_cbranch_scc1 L_alt20
    s_waitcnt vmcnt(4)
L_go19:
    buffer_load_dwordx4 v[156:159], v3, s[8:11], s32 offen offset:3072 nt
    v_add_f32_dpp v24, v24, v24 row_mirror row_mask:0xf bank_mask:0xf
    v_add_f32_dpp v25, v25, v25 row_mirror row_mask:0xf bank_mask:0xf
    s_nop 0
    v_add_f32_dpp v24, v26, v26 row_mirror row_mask:0xf bank_mask:0xc
    v_add_f32_dpp v25, v27, v27 row_mirror row_mask:0xf bank_mask:0xc
    s_nop 0
    v_add_f32_dpp v24, v24, v24 row_half_mirror row_mask:0xf bank_mask:0xf
    s_nop 1
    v_add_f32_dpp v24, v25, v25 row_half_mirror row_mask:0xf bank_mask:0xa
    s_nop 1
    v_add_f32_dpp v24, v24, v24 quad_perm:[1,0,3,2] row_mask:0xf bank_mask:0xf
    s_nop 1
    v_add_f32_dpp v24, v24, v24 quad_perm:[2,3,0,1] row_mask:0xf bank_mask:0xf
    v_cvt_pk_bf16_f32 v24, v24, v24
    v_and_b32 v24, s47, v24
    v_mul_f32 v24, s45, v24
    v_cvt_pk_bf16_f32 v24, v24, v24
    v_and_b32 v111, s47, v24
    ds_write_b64 v116, v[110:111]
    v_max3_f32 v28, v28, v110, v111
    v_add_u32 v116, 512, v116
    s_add_u32 s32, s32, 32768
    s_waitcnt vmcnt(32)
    v_dot2_f32_bf16 v20, v160, v12, 0
    v_dot2_f32_bf16 v20, v161, v13, v20
    v_dot2_f32_bf16 v20, v162, v14, v20
    v_dot2_f32_bf16 v20, v163, v15, v20
    s_cmp_lg_u32 s52, 5
    s_cbranch_scc1 L_alt22
    s_waitcnt vmcnt(4)
L_go21:
    buffer_load_dwordx4 v[160:163], v2, s[8:11], s32 offen offset:0 nt
    s_waitcnt vmcnt(32)
    v_dot2_f32_bf16 v21, v164, v12, 0
    v_dot2_f32_bf16 v21, v165, v13, v21
    v_dot2_f32_bf16 v21, v166, v14, v21
    v_dot2_f32_bf16 v21, v167, v15, v21
    s_cmp_lg_u32 s53, 5
    s_cbranch_scc1 L_alt24
    s_waitcnt vmcnt(4)
L_go23:
    buffer_load_dwordx4 v[164:167], v2, s[8:11], s32 offen offset:1024 nt
    s_waitcnt vmcnt(32)
    v_dot2_f32_bf16 v22, v168, v12, 0
    v_dot2_f32_bf16 v22, v169, v13, v22
    v_dot2_f32_bf16 v22, v170, v14, v22
    v_dot2_f32_bf16 v22, v171, v15, v22
    s_cmp_lg_u32 s54, 5
    s_cbranch_scc1 L_alt26
    s_waitcnt vmcnt(4)
L_go25:
    buffer_load_dwordx4 v[168:171], v2, s[8:11], s32 offen offset:2048 nt
    s_waitcnt vmcnt(10)
    v_cmp_le_u32 vcc, s33, v121
    s_add_u32 s4, s33, 1
    v_cmp_le_u32 s[6:7], s4, v121
    s_bcnt1_i32_b32 s3, vcc_lo
    s_sub_u32 s4, s33, 1
    v_cmp_gt_u32 vcc, s4, v121
    s_bcnt1_i32_b32 s6, s6
    s_add_i32 s3, s3, s6
    s_bcnt1_i32_b32 s6, vcc_lo
    s_sub_i32 s3, s3, s6
    s_mov_b32 s4, -1
    s_cmp_ge_i32 s3, 2
    s_cselect_b32 s4, 0, s4
    s_cmp_ge_i32 s3, 18
    s_cselect_b32 s4, 1, s4
    s_cmp_ge_i32 s3, 26
    s_cselect_b32 s4, 3, s4
    s_cmp_gt_u32 s6, 6
    s_cselect_b32 s4, 0, s4
    s_and_b32 s4, s4, s36
    s_add_i32 s4, s4, s42
    s_add_u32 s52, s4, 0
    s_lshr_b32 s52, s52, 2
    s_add_u32 s53, s4, 1
    s_lshr_b32 s53, s53, 2
    s_add_u32 s54, s4, 2
    s_lshr_b32 s54, s54, 2
    s_add_u32 s55, s4, 3
    s_lshr_b32 s55, s55, 2
    v_dot2_f32_bf16 v23, v172, v12, 0
    v_dot2_f32_bf16 v23, v173, v13, v23
    v_dot2_f32_bf16 v23, v174, v14, v23
    v_dot2_f32_bf16 v23, v175, v15, v23
    s_cmp_lg_u32 s55, 5
    s_cbranch_scc1 L_alt28
    s_waitcnt vmcnt(4)
L_go27:
    buffer_load_dwordx4 v[172:175], v2, s[8:11], s32 offen offset:3072 nt
    v_dot2_f32_bf16 v24, v176, v12, 0
    v_dot2_f32_bf16 v24, v177, v13, v24
    v_dot2_f32_bf16 v24, v178, v14, v24
    v_dot2_f32_bf16 v24, v179, v15, v24
    s_cmp_lg_u32 s52, 5
    s_cbranch_scc1 L_alt30
    s_waitcnt vmcnt(4)
L_go29:
    buffer_load_dwordx4 v[176:179], v3, s[8:11], s32 offen offset:0 nt
    v_add_f32_dpp v20, v20, v20 row_mirror row_mask:0xf bank_mask:0xf
    v_add_f32_dpp v21, v21, v21 row_mirror row_mask:0xf bank_mask:0xf
    s_nop 0
    v_add_f32_dpp v20, v22, v22 row_mirror row_mask:0xf bank_mask:0xc
    v_add_f32_dpp v21, v23, v23 row_mirror row_mask:0xf bank_mask:0xc
    s_nop 0
    v_add_f32_dpp v20, v20, v20 row_half_mirror row_mask:0xf bank_mask:0xf
    s_nop 1
    v_add_f32_dpp v20, v21, v21 row_half_mirror row_mask:0xf bank_mask:0xa
    s_nop 1
    v_add_f32_dpp v20, v20, v20 quad_perm:[1,0,3,2] row_mask:0xf bank_mask:0xf
    s_nop 1
    v_add_f32_dpp v20, v20, v20 quad_perm:[2,3,0,1] row_mask:0xf bank_mask:0xf
    v_cvt_pk_bf16_f32 v20, v20, v20
    v_and_b32 v20, s47, v20
    v_mul_f32 v20, s45, v20
    v_cvt_pk_bf16_f32 v20, v20, v20
    v_and_b32 v110, s47, v20
    v_dot2_f32_bf16 v25, v180, v12, 0
    v_dot2_f32_bf16 v25, v181, v13, v25
    v_dot2_f32_bf16 v25, v182, v14, v25
    v_dot2_f32_bf16 v25, v183, v15, v25
    s_cmp_lg_u32 s53, 5
    s_cbranch_scc1 L_alt32
    s_waitcnt vmcnt(4)
L_go31:
    buffer_load_dwordx4 v[180:183], v3, s[8:11], s32 offen offset:1024 nt
    v_dot2_f32_bf16 v26, v184, v12, 0
    v_dot2_f32_bf16 v26, v185, v13, v26
    v_dot2_f32_bf16 v26, v186, v14, v26
    v_dot2_f32_bf16 v26, v187, v15, v26
    s_cmp_lg_u32 s54, 5
    s_cbranch_scc1 L_alt34
    s_waitcnt vmcnt(4)
L_go33:
    buffer_load_dwordx4 v[184:187], v3, s[8:11], s32 offen offset:2048 nt
    v_dot2_f32_bf16 v27, v188, v12, 0
    v_dot2_f32_bf16 v27, v189, v13, v27
    v_dot2_f32_bf16 v27, v190, v14, v27
    v_dot2_f32_bf16 v27, v191, v15, v27
    s_cmp_lg_u32 s55, 5
    s_cbranch_scc1 L_alt36
    s_waitcnt vmcnt(4)
L_go35:
    buffer_load_dwordx4 v[188:191], v3, s[8:11], s32 offen offset:3072 nt
    v_add_f32_dpp v24, v24, v24 row_mirror row_mask:0xf bank_mask:0xf
    v_add_f32_dpp v25, v25, v25 row_mirror row_mask:0xf bank_mask:0xf
    s_nop 0
    v_add_f32_dpp v24, v26, v26 row_mirror row_mask:0xf bank_mask:0xc
    v_add_f32_dpp v25, v27, v27 row_mirror row_mask:0xf bank_mask:0xc
    s_nop 0
    v_add_f32_dpp v24, v24, v24 row_half_mirror row_mask:0xf bank_mask:0xf
    s_nop 1
    v_add_f32_dpp v24, v25, v25 row_half_mirror row_mask:0xf bank_mask:0xa
    s_nop 1
    v_add_f32_dpp v24, v24, v24 quad_perm:[1,0,3,2] row_mask:0xf bank_mask:0xf
    s_nop 1
    v_add_f32_dpp v24, v24, v24 quad_perm:[2,3,0,1] row_mask:0xf bank_mask:0xf
    v_cvt_pk_bf16_f32 v24, v24, v24
    v_and_b32 v24, s47, v24
    v_mul_f32 v24, s45, v24
    v_cvt_pk_bf16_f32 v24, v24, v24
    v_and_b32 v111, s47, v24
    ds_write_b64 v116, v[110:111]
    v_max3_f32 v28, v28, v110, v111
    v_add_u32 v116, 512, v116
    s_add_u32 s32, s32, 32768
    v_dot2_f32_bf16 v20, v192, v12, 0
    v_dot2_f32_bf16 v20, v193, v13, v20
    v_dot2_f32_bf16 v20, v194, v14, v20
    v_dot2_f32_bf16 v20, v195, v15, v20
    s_cmp_lg_u32 s52, 5
    s_cbranch_scc1 L_alt38
    s_waitcnt vmcnt(4)
L_go37:
    buffer_load_dwordx4 v[192:195], v2, s[8:11], s32 offen offset:0 nt
    v_dot2_f32_bf16 v21, v196, v12, 0
    v_dot2_f32_bf16 v21, v197, v13, v21
    v_dot2_f32_bf16 v21, v198, v14, v21
    v_dot2_f32_bf16 v21, v199, v15, v21
    s_cmp_lg_u32 s53, 5
    s_cbranch_scc1 L_alt40
    s_waitcnt vmcnt(4)
L_go39:
    buffer_load_dwordx4 v[196:199], v2, s[8:11], s32 offen offset:1024 nt
    v_dot2_f32_bf16 v22, v200, v12, 0
    v_dot2_f32_bf16 v22, v201, v13, v22
    v_dot2_f32_bf16 v22, v202, v14, v22
    v_dot2_f32_bf16 v22, v203, v15, v22
    s_cmp_lg_u32 s54, 5
    s_cbranch_scc1 L_alt42
    s_waitcnt vmcnt(4)
L_go41:
    buffer_load_dwordx4 v[200:203], v2, s[8:11], s32 offen offset:2048 nt
    v_dot2_f32_bf16 v23, v204, v12, 0
    v_dot2_f32_bf16 v23, v205, v13, v23
    v_dot2_f32_bf16 v23, v206, v14, v23
    v_dot2_f32_bf16 v23, v207, v15, v23
    s_cmp_lg_u32 s55, 5
    s_cbranch_scc1 L_alt44
    s_waitcnt vmcnt(4)
L_go43:
    buffer_load_dwordx4 v[204:207], v2, s[8:11], s32 offen offset:3072 nt
    v_dot2_f32_bf16 v24, v208, v12, 0
    v_dot2_f32_bf16 v24, v209, v13, v24
    v_dot2_f32_bf16 v24, v210, v14, v24
    v_dot2_f32_bf16 v24, v211, v15, v24
    s_cmp_lg_u32 s52, 5
    s_cbranch_scc1 L_alt46
    s_waitcnt vmcnt(4)
L_go45:
    buffer_load_dwordx4 v[208:211], v3, s[8:11], s32 offen offset:0 nt
    v_add_f32_dpp v20, v20, v20 row_mirror row_mask:0xf bank_mask:0xf
    v_add_f32_dpp v21, v21, v21 row_mirror row_mask:0xf bank_mask:0xf
    s_nop 0
    v_add_f32_dpp v20, v22, v22 row_mirror row_mask:0xf bank_mask:0xc
    v_add_f32_dpp v21, v23, v23 row_mirror row_mask:0xf bank_mask:0xc
    s_nop 0
    v_add_f32_dpp v20, v20, v20 row_half_mirror row_mask:0xf bank_mask:0xf
    s_nop 1
    v_add_f32_dpp v20, v21, v21 row_half_mirror row_mask:0xf bank_mask:0xa
    s_nop 1
    v_add_f32_dpp v20, v20, v20 quad_perm:[1,0,3,2] row_mask:0xf bank_mask:0xf
    s_nop 1
    v_add_f32_dpp v20, v20, v20 quad_perm:[2,3,0,1] row_mask:0xf bank_mask:0xf
    v_cvt_pk_bf16_f32 v20, v20, v20
    v_and_b32 v20, s47, v20
    v_mul_f32 v20, s45, v20
    v_cvt_pk_bf16_f32 v20, v20, v20
    v_and_b32 v110, s47, v20
    v_dot2_f32_bf16 v25, v212, v12, 0
    v_dot2_f32_bf16 v25, v213, v13, v25
    v_dot2_f32_bf16 v25, v214, v14, v25
    v_dot2_f32_bf16 v25, v215, v15, v25
    s_cmp_lg_u32 s53, 5
    s_cbranch_scc1 L_alt48
    s_waitcnt vmcnt(4)
L_go47:
    buffer_load_dwordx4 v[212:215], v3, s[8:11], s32 offen offset:1024 nt
    v_dot2_f32_bf16 v26, v216, v12, 0
    v_dot2_f32_bf16 v26, v217, v13, v26
    v_dot2_f32_bf16 v26, v218, v14, v26
    v_dot2_f32_bf16 v26, v219, v15, v26
    s_cmp_lg_u32 s54, 5
    s_cbranch_scc1 L_alt50
    s_waitcnt vmcnt(4)
L_go49:
    buffer_load_dwordx4 v[216:219], v3, s[8:11], s32 offen offset:2048 nt
    v_dot2_f32_bf16 v27, v220, v12, 0
    v_dot2_f32_bf16 v27, v221, v13, v27
    v_dot2_f32_bf16 v27, v222, v14, v27
    v_dot2_f32_bf16 v27, v223, v15, v27
    s_cmp_lg_u32 s55, 5
    s_cbranch_scc1 L_alt52
    s_waitcnt vmcnt(4)
L_go51:
    buffer_load_dwordx4 v[220:223], v3, s[8:11], s32 offen offset:3072 nt
    v_add_f32_dpp v24, v24, v24 row_mirror row_mask:0xf bank_mask:0xf
    v_add_f32_dpp v25, v25, v25 row_mirror row_mask:0xf bank_mask:0xf
    s_nop 0
    v_add_f32_dpp v24, v26, v26 row_mirror row_mask:0xf bank_mask:0xc
    v_add_f32_dpp v25, v27, v27 row_mirror row_mask:0xf bank_mask:0xc
    s_nop 0
    v_add_f32_dpp v24, v24, v24 row_half_mirror row_mask:0xf bank_mask:0xf
    s_nop 1
    v_add_f32_dpp v24, v25, v25 row_half_mirror row_mask:0xf bank_mask:0xa
    s_nop 1
    v_add_f32_dpp v24, v24, v24 quad_perm:[1,0,3,2] row_mask:0xf bank_mask:0xf
    s_nop 1
    v_add_f32_dpp v24, v24, v24 quad_perm:[2,3,0,1] row_mask:0xf bank_mask:0xf
    v_cvt_pk_bf16_f32 v24, v24, v24
    v_and_b32 v24, s47, v24
    v_mul_f32 v24, s45, v24
    v_cvt_pk_bf16_f32 v24, v24, v24
    v_and_b32 v111, s47, v24
    ds_write_b64 v116, v[110:111]
    v_max3_f32 v28, v28, v110, v111
    v_add_u32 v116, 512, v116
    s_add_u32 s32, s32, 32768
    v_dot2_f32_bf16 v20, v224, v12, 0
    v_dot2_f32_bf16 v20, v225, v13, v20
    v_dot2_f32_bf16 v20, v226, v14, v20
    v_dot2_f32_bf16 v20, v227, v15, v20
    s_cmp_lg_u32 s52, 5
    s_cbranch_scc1 L_alt54
    s_waitcnt vmcnt(4)
L_go53:
    buffer_load_dwordx4 v[224:227], v2, s[8:11], s32 offen offset:0 nt
    v_dot2_f32_bf16 v21, v228, v12, 0
    v_dot2_f32_bf16 v21, v229, v13, v21
    v_dot2_f32_bf16 v21, v230, v14, v21
    v_dot2_f32_bf16 v21, v231, v15, v21
    s_cmp_lg_u32 s53, 5
    s_cbranch_scc1 L_alt56
    s_waitcnt vmcnt(4)
L_go55:
    buffer_load_dwordx4 v[228:231], v2, s[8:11], s32 offen offset:1024 nt
    v_dot2_f32_bf16 v22, v232, v12, 0
    v_dot2_f32_bf16 v22, v233, v13, v22
    v_dot2_f32_bf16 v22, v234, v14, v22
    v_dot2_f32_bf16 v22, v235, v15, v22
    s_cmp_lg_u32 s54, 5
    s_cbranch_scc1 L_alt58
    s_waitcnt vmcnt(4)
L_go57:
    buffer_load_dwordx4 v[232:235], v2, s[8:11], s32 offen offset:2048 nt
    v_dot2_f32_bf16 v23, v236, v12, 0
    v_dot2_f32_bf16 v23, v237, v13, v23
    v_dot2_f32_bf16 v23, v238, v14, v23
    v_dot2_f32_bf16 v23, v239, v15, v23
    s_cmp_lg_u32 s55, 5
    s_cbranch_scc1 L_alt60
    s_waitcnt vmcnt(4)
L_go59:
    buffer_load_dwordx4 v[236:239], v2, s[8:11], s32 offen offset:3072 nt
    v_dot2_f32_bf16 v24, v240, v12, 0
    v_dot2_f32_bf16 v24, v241, v13, v24
    v_dot2_f32_bf16 v24, v242, v14, v24
    v_dot2_f32_bf16 v24, v243, v15, v24
    s_cmp_lg_u32 s52, 5
    s_cbranch_scc1 L_alt62
    s_waitcnt vmcnt(4)
L_go61:
    buffer_load_dwordx4 v[240:243], v3, s[8:11], s32 offen offset:0 nt
    v_add_f32_dpp v20, v20, v20 row_mirror row_mask:0xf bank_mask:0xf
    v_add_f32_dpp v21, v21, v21 row_mirror row_mask:0xf bank_mask:0xf
    s_nop 0
    v_add_f32_dpp v20, v22, v22 row_mirror row_mask:0xf bank_mask:0xc
    v_add_f32_dpp v21, v23, v23 row_mirror row_mask:0xf bank_mask:0xc
    s_nop 0
    v_add_f32_dpp v20, v20, v20 row_half_mirror row_mask:0xf bank_mask:0xf
    s_nop 1
    v_add_f32_dpp v20, v21, v21 row_half_mirror row_mask:0xf bank_mask:0xa
    s_nop 1
    v_add_f32_dpp v20, v20, v20 quad_perm:[1,0,3,2] row_mask:0xf bank_mask:0xf
    s_nop 1
    v_add_f32_dpp v20, v20, v20 quad_perm:[2,3,0,1] row_mask:0xf bank_mask:0xf
    v_cvt_pk_bf16_f32 v20, v20, v20
    v_and_b32 v20, s47, v20
    v_mul_f32 v20, s45, v20
    v_cvt_pk_bf16_f32 v20, v20, v20
    v_and_b32 v110, s47, v20
    v_dot2_f32_bf16 v25, v244, v12, 0
    v_dot2_f32_bf16 v25, v245, v13, v25
    v_dot2_f32_bf16 v25, v246, v14, v25
    v_dot2_f32_bf16 v25, v247, v15, v25
    s_cmp_lg_u32 s53, 5
    s_cbranch_scc1 L_alt64
    s_waitcnt vmcnt(4)
L_go63:
    buffer_load_dwordx4 v[244:247], v3, s[8:11], s32 offen offset:1024 nt
    v_dot2_f32_bf16 v26, v248, v12, 0
    v_dot2_f32_bf16 v26, v249, v13, v26
    v_dot2_f32_bf16 v26, v250, v14, v26
    v_dot2_f32_bf16 v26, v251, v15, v26
    s_cmp_lg_u32 s54, 5
    s_cbranch_scc1 L_alt66
    s_waitcnt vmcnt(4)
L_go65:
    buffer_load_dwordx4 v[248:251], v3, s[8:11], s32 offen offset:2048 nt
    v_dot2_f32_bf16 v27, v252, v12, 0
    v_dot2_f32_bf16 v27, v253, v13, v27
    v_dot2_f32_bf16 v27, v254, v14, v27
    v_dot2_f32_bf16 v27, v255, v15, v27
    s_cmp_lg_u32 s55, 5
    s_cbranch_scc1 L_alt68
    s_waitcnt vmcnt(4)
L_go67:
    buffer_load_dwordx4 v[252:255], v3, s[8:11], s32 offen offset:3072 nt
    v_add_f32_dpp v24, v24, v24 row_mirror row_mask:0xf bank_mask:0xf
    v_add_f32_dpp v25, v25, v25 row_mirror row_mask:0xf bank_mask:0xf
    s_nop 0
    v_add_f32_dpp v24, v26, v26 row_mirror row_mask:0xf bank_mask:0xc
    v_add_f32_dpp v25, v27, v27 row_mirror row_mask:0xf bank_mask:0xc
    s_nop 0
    v_add_f32_dpp v24, v24, v24 row_half_mirror row_mask:0xf bank_mask:0xf
    s_nop 1
    v_add_f32_dpp v24, v25, v25 row_half_mirror row_mask:0xf bank_mask:0xa
    s_nop 1
    v_add_f32_dpp v24, v24, v24 quad_perm:[1,0,3,2] row_mask:0xf bank_mask:0xf
    s_nop 1
    v_add_f32_dpp v24, v24, v24 quad_perm:[2,3,0,1] row_mask:0xf bank_mask:0xf
    v_cvt_pk_bf16_f32 v24, v24, v24
    v_and_b32 v24, s47, v24
    v_mul_f32 v24, s45, v24
    v_cvt_pk_bf16_f32 v24, v24, v24
    v_and_b32 v111, s47, v24
    ds_write_b64 v116, v[110:111]
    v_max3_f32 v28, v28, v110, v111
    v_add_u32 v116, 512, v116
    s_add_u32 s32, s32, 32768
    s_sub_u32 s37, s37, 1
    s_cmp_lg_u32 s37, 0
    s_cbranch_scc1 L_k0
    v_max_f32_dpp v28, v28, v28 row_half_mirror row_mask:0xf bank_mask:0xf
    s_nop 1
    v_max_f32_dpp v28, v28, v28 row_mirror row_mask:0xf bank_mask:0xf
    s_nop 1
    v_max_f32_dpp v28, v28, v28 row_bcast:15 row_mask:0xa bank_mask:0xf
    s_nop 1
    v_max_f32_dpp v28, v28, v28 row_bcast:31 row_mask:0xc bank_mask:0xf
    s_nop 0
    v_readlane_b32 s44, v28, 63
    s_waitcnt lgkmcnt(0)
    ds_read_b64 v[34:35], v117
    v_add_u32 v117, 512, v117
    v_mov_b32 v28, s44
    s_mov_b32 s37, 6
.p2align 6
L_v0:
    s_waitcnt lgkmcnt(0)
    v_sub_f32 v30, v34, v28
    v_sub_f32 v31, v35, v28
    ds_read_b64 v[34:35], v117
    v_add_u32 v117, 512, v117
    v_mul_f32 v30, s46, v30
    v_mul_f32 v31, s46, v31
    v_exp_f32 v30, v30
    v_exp_f32 v31, v31
    v_cvt_pk_bf16_f32 v32, v30, v30
    v_cvt_pk_bf16_f32 v33, v31, v31
    v_add_f32 v29, v29, v30
    v_add_f32 v29, v29, v31
    v_and_b32_dpp v36, v32, v8 row_newbcast:0 row_mask:0xf bank_mask:0xf
    v_and_b32_dpp v37, v32, v9 row_newbcast:0 row_mask:0xf bank_mask:0xf
    v_and_b32_dpp v38, v32, v10 row_newbcast:0 row_mask:0xf bank_mask:0xf
    v_and_b32_dpp v39, v32, v11 row_newbcast:0 row_mask:0xf bank_mask:0xf
    s_waitcnt vmcnt(31)
    s_nop 0
    v_mfma_f32_16x16x32_bf16 v[16:19], v[36:39], v[128:131], v[16:19]
    s_cmp_lg_u32 s52, 5
    s_cbranch_scc1 L_alt70
    s_waitcnt vmcnt(4)
L_go69:
    buffer_load_dwordx4 v[128:131], v2, s[8:11], s32 offen offset:0 nt
    s_add_u32 s33, s33, 1
    buffer_load_dword v121, v122, s[48:51], s35 offen nt
    s_cmp_lg_u32 s38, 0
    s_cbranch_scc1 L_cp71
    v_mov_b32 v123, s33
    s_mov_b64 exec, 1
    buffer_store_dword v123, v124, s[48:51], s35 offen
    s_mov_b64 exec, -1
L_cp71:
    v_and_b32_dpp v40, v32, v8 row_newbcast:4 row_mask:0xf bank_mask:0xf
    v_and_b32_dpp v41, v32, v9 row_newbcast:4 row_mask:0xf bank_mask:0xf
    v_and_b32_dpp v42, v32, v10 row_newbcast:4 row_mask:0xf bank_mask:0xf
    v_and_b32_dpp v43, v32, v11 row_newbcast:4 row_mask:0xf bank_mask:0xf
    s_waitcnt vmcnt(32)
    s_nop 0
    v_mfma_f32_16x16x32_bf16 v[16:19], v[40:43], v[132:135], v[16:19]
    s_cmp_lg_u32 s53, 5
    s_cbranch_scc1 L_alt73
    s_waitcnt vmcnt(5)
L_go72:
    buffer_load_dwordx4 v[132:135], v2, s[8:11], s32 offen offset:1024 nt
    v_and_b32_dpp v36, v32, v8 row_newbcast:8 row_mask:0xf bank_mask:0xf
    v_and_b32_dpp v37, v32, v9 row_newbcast:8 row_mask:0xf bank_mask:0xf
    v_and_b32_dpp v38, v32, v10 row_newbcast:8 row_mask:0xf bank_mask:0xf
    v_and_b32_dpp v39, v32, v11 row_newbcast:8 row_mask:0xf bank_mask:0xf
    s_waitcnt vmcnt(32)
    s_nop 0
    v_mfma_f32_16x16x32_bf16 v[16:19], v[36:39], v[136:139], v[16:19]
    s_cmp_lg_u32 s54, 5
    s_cbranch_scc1 L_alt75
    s_waitcnt vmcnt(5)
L_go74:
    buffer_load_dwordx4 v[136:139], v2, s[8:11], s32 offen offset:2048 nt
    v_and_b32_dpp v40, v32, v8 row_newbcast:12 row_mask:0xf bank_mask:0xf
    v_and_b32_dpp v41, v32, v9 row_newbcast:12 row_mask:0xf bank_mask:0xf
    v_and_b32_dpp v42, v32, v10 row_newbcast:12 row_mask:0xf bank_mask:0xf
    v_and_b32_dpp v43, v32, v11 row_newbcast:12 row_mask:0xf bank_mask:0xf
    s_waitcnt vmcnt(32)
    s_nop 0
    v_mfma_f32_16x16x32_bf16 v[16:19], v[40:43], v[140:143], v[16:19]
    s_cmp_lg_u32 s55, 5
    s_cbranch_scc1 L_alt77
    s_waitcnt vmcnt(5)
L_go76:
    buffer_load_dwordx4 v[140:143], v2, s[8:11], s32 offen offset:3072 nt
    v_and_b32_dpp v36, v33, v8 row_newbcast:0 row_mask:0xf bank_mask:0xf
    v_and_b32_dpp v37, v33, v9 row_newbcast:0 row_mask:0xf bank_mask:0xf
    v_and_b32_dpp v38, v33, v10 row_newbcast:0 row_mask:0xf bank_mask:0xf
    v_and_b32_dpp v39, v33, v11 row_newbcast:0 row_mask:0xf bank_mask:0xf
    s_waitcnt vmcnt(32)
    s_nop 0
    v_mfma_f32_16x16x32_bf16 v[16:19], v[36:39], v[144:147], v[16:19]
    s_cmp_lg_u32 s52, 5
    s_cbranch_scc1 L_alt79
    s_waitcnt vmcnt(5)
L_go78:
    buffer_load_dwordx4 v[144:147], v3, s[8:11], s32 offen offset:0 nt
    v_and_b32_dpp v40, v33, v8 row_newbcast:4 row_mask:0xf bank_mask:0xf
    v_and_b32_dpp v41, v33, v9 row_newbcast:4 row_mask:0xf bank_mask:0xf
    v_and_b32_dpp v42, v33, v10 row_newbcast:4 row_mask:0xf bank_mask:0xf
    v_and_b32_dpp v43, v33, v11 row_newbcast:4 row_mask:0xf bank_mask:0xf
    s_waitcnt vmcnt(32)
    s_nop 0
    v_mfma_f32_16x16x32_bf16 v[16:19], v[40:43], v[148:151], v[16:19]
    s_cmp_lg_u32 s53, 5
    s_cbranch_scc1 L_alt81
    s_waitcnt vmcnt(5)
L_go80:
    buffer_load_dwordx4 v[148:151], v3, s[8:11], s32 offen offset:1024 nt
    v_and_b32_dpp v36, v33, v8 row_newbcast:8 row_mask:0xf bank_mask:0xf
    v_and_b32_dpp v37, v33, v9 row_newbcast:8 row_mask:0xf bank_mask:0xf
    v_and_b32_dpp v38, v33, v10 row_newbcast:8 row_mask:0xf bank_mask:0xf
    v_and_b32_dpp v39, v33, v11 row_newbcast:8 row_mask:0xf bank_mask:0xf
    s_waitcnt vmcnt(32)
    s_nop 0
    v_mfma_f32_16x16x32_bf16 v[16:19], v[36:39], v[152:155], v[16:19]
    s_cmp_lg_u32 s54, 5
    s_cbranch_scc1 L_alt83
    s_waitcnt vmcnt(4)
L_go82:
    buffer_load_dwordx4 v[152:155], v3, s[8:11], s32 offen offset:2048 nt
    v_and_b32_dpp v40, v33, v8 row_newbcast:12 row_mask:0xf bank_mask:0xf
    v_and_b32_dpp v41, v33, v9 row_newbcast:12 row_mask:0xf bank_mask:0xf
    v_and_b32_dpp v42, v33, v10 row_newbcast:12 row_mask:0xf bank_mask:0xf
    v_and_b32_dpp v43, v33, v11 row_newbcast:12 row_mask:0xf bank_mask:0xf
    s_waitcnt vmcnt(32)
    s_nop 0
    v_mfma_f32_16x16x32_bf16 v[16:19], v[40:43], v[156:159], v[16:19]
    s_cmp_lg_u32 s55, 5
    s_cbranch_scc1 L_alt85
    s_waitcnt vmcnt(4)
L_go84:
    buffer_load_dwordx4 v[156:159], v3, s[8:11], s32 offen offset:3072 nt
    s_add_u32 s32, s32, 32768
    s_waitcnt lgkmcnt(0)
    v_sub_f32 v30, v34, v28
    v_sub_f32 v31, v35, v28
    ds_read_b64 v[34:35], v117
    v_add_u32 v117, 512, v117
    v_mul_f32 v30, s46, v30
    v_mul_f32 v31, s46, v31
    v_exp_f32 v30, v30
    v_exp_f32 v31, v31
    v_cvt_pk_bf16_f32 v32, v30, v30
    v_cvt_pk_bf16_f32 v33, v31, v31
    v_add_f32 v29, v29, v30
    v_add_f32 v29, v29, v31
    v_and_b32_dpp v36, v32, v8 row_newbcast:0 row_mask:0xf bank_mask:0xf
    v_and_b32_dpp v37, v32, v9 row_newbcast:0 row_mask:0xf bank_mask:0xf
    v_and_b32_dpp v38, v32, v10 row_newbcast:0 row_mask:0xf bank_mask:0xf
    v_and_b32_dpp v39, v32, v11 row_newbcast:0 row_mask:0xf bank_mask:0xf
    s_waitcnt vmcnt(32)
    s_nop 0
    v_mfma_f32_16x16x32_bf16 v[16:19], v[36:39], v[160:163], v[16:19]
    s_cmp_lg_u32 s52, 5
    s_cbranch_scc1 L_alt87
    s_waitcnt vmcnt(4)
L_go86:
    buffer_load_dwordx4 v[160:163], v2, s[8:11], s32 offen offset:0 nt
    v_and_b32_dpp v40, v32, v8 row_newbcast:4 row_mask:0xf bank_mask:0xf
    v_and_b32_dpp v41, v32, v9 row_newbcast:4 row_mask:0xf bank_mask:0xf
    v_and_b32_dpp v42, v32, v10 row_newbcast:4 row_mask:0xf bank_mask:0xf
    v_and_b32_dpp v43, v32, v11 row_newbcast:4 row_mask:0xf bank_mask:0xf
    s_waitcnt vmcnt(32)
    s_nop 0
    v_mfma_f32_16x16x32_bf16 v[16:19], v[40:43], v[164:167], v[16:19]
    s_cmp_lg_u32 s53, 5
    s_cbranch_scc1 L_alt89
    s_waitcnt vmcnt(4)
L_go88:
    buffer_load_dwordx4 v[164:167], v2, s[8:11], s32 offen offset:1024 nt
    v_and_b32_dpp v36, v32, v8 row_newbcast:8 row_mask:0xf bank_mask:0xf
    v_and_b32_dpp v37, v32, v9 row_newbcast:8 row_mask:0xf bank_mask:0xf
    v_and_b32_dpp v38, v32, v10 row_newbcast:8 row_mask:0xf bank_mask:0xf
    v_and_b32_dpp v39, v32, v11 row_newbcast:8 row_mask:0xf bank_mask:0xf
    s_waitcnt vmcnt(32)
    s_nop 0
    v_mfma_f32_16x16x32_bf16 v[16:19], v[36:39], v[168:171], v[16:19]
    s_cmp_lg_u32 s54, 5
    s_cbranch_scc1 L_alt91
    s_waitcnt vmcnt(4)
L_go90:
    buffer_load_dwordx4 v[168:171], v2, s[8:11], s32 offen offset:2048 nt
    s_waitcnt vmcnt(10)
    v_cmp_le_u32 vcc, s33, v121
    s_add_u32 s4, s33, 1
    v_cmp_le_u32 s[6:7], s4, v121
    s_bcnt1_i32_b32 s3, vcc_lo
    s_sub_u32 s4, s33, 1
    v_cmp_gt_u32 vcc, s4, v121
    s_bcnt1_i32_b32 s6, s6
    s_add_i32 s3, s3, s6
    s_bcnt1_i32_b32 s6, vcc_lo
    s_sub_i32 s3, s3, s6
    s_mov_b32 s4, -1
    s_cmp_ge_i32 s3, 2
    s_cselect_b32 s4, 0, s4
    s_cmp_ge_i32 s3, 18
    s_cselect_b32 s4, 1, s4
    s_cmp_ge_i32 s3, 26
    s_cselect_b32 s4, 3, s4
    s_cmp_gt_u32 s6, 6
    s_cselect_b32 s4, 0, s4
    s_and_b32 s4, s4, s36
    s_add_i32 s4, s4, s42
    s_add_u32 s52, s4, 0
    s_lshr_b32 s52, s52, 2
    s_add_u32 s53, s4, 1
    s_lshr_b32 s53, s53, 2
    s_add_u32 s54, s4, 2
    s_lshr_b32 s54, s54, 2
    s_add_u32 s55, s4, 3
    s_lshr_b32 s55, s55, 2
    v_and_b32_dpp v40, v32, v8 row_newbcast:12 row_mask:0xf bank_mask:0xf
    v_and_b32_dpp v41, v32, v9 row_newbcast:12 row_mask:0xf bank_mask:0xf
    v_and_b32_dpp v42, v32, v10 row_newbcast:12 row_mask:0xf bank_mask:0xf
    v_and_b32_dpp v43, v32, v11 row_newbcast:12 row_mask:0xf bank_mask:0xf
    s_nop 1
    v_mfma_f32_16x16x32_bf16 v[16:19], v[40:43], v[172:175], v[16:19]
    s_cmp_lg_u32 s55, 5
    s_cbranch_scc1 L_alt93
    s_waitcnt vmcnt(4)
L_go92:
    buffer_load_dwordx4 v[172:175], v2, s[8:11], s32 offen offset:3072 nt
    v_and_b32_dpp v36, v33, v8 row_newbcast:0 row_mask:0xf bank_mask:0xf
    v_and_b32_dpp v37, v33, v9 row_newbcast:0 row_mask:0xf bank_mask:0xf
    v_and_b32_dpp v38, v33, v10 row_newbcast:0 row_mask:0xf bank_mask:0xf
    v_and_b32_dpp v39, v33, v11 row_newbcast:0 row_mask:0xf bank_mask:0xf
    s_nop 1
    v_mfma_f32_16x16x32_bf16 v[16:19], v[36:39], v[176:179], v[16:19]
    s_cmp_lg_u32 s52, 5
    s_cbranch_scc1 L_alt95
    s_waitcnt vmcnt(4)
L_go94:
    buffer_load_dwordx4 v[176:179], v3, s[8:11], s32 offen offset:0 nt
    v_and_b32_dpp v40, v33, v8 row_newbcast:4 row_mask:0xf bank_mask:0xf
    v_and_b32_dpp v41, v33, v9 row_newbcast:4 row_mask:0xf bank_mask:0xf
    v_and_b32_dpp v42, v33, v10 row_newbcast:4 row_mask:0xf bank_mask:0xf
    v_and_b32_dpp v43, v33, v11 row_newbcast:4 row_mask:0xf bank_mask:0xf
    s_nop 1
    v_mfma_f32_16x16x32_bf16 v[16:19], v[40:43], v[180:183], v[16:19]
    s_cmp_lg_u32 s53, 5
    s_cbranch_scc1 L_alt97
    s_waitcnt vmcnt(4)
L_go96:
    buffer_load_dwordx4 v[180:183], v3, s[8:11], s32 offen offset:1024 nt
    v_and_b32_dpp v36, v33, v8 row_newbcast:8 row_mask:0xf bank_mask:0xf
    v_and_b32_dpp v37, v33, v9 row_newbcast:8 row_mask:0xf bank_mask:0xf
    v_and_b32_dpp v38, v33, v10 row_newbcast:8 row_mask:0xf bank_mask:0xf
    v_and_b32_dpp v39, v33, v11 row_newbcast:8 row_mask:0xf bank_mask:0xf
    s_nop 1
    v_mfma_f32_16x16x32_bf16 v[16:19], v[36:39], v[184:187], v[16:19]
    s_cmp_lg_u32 s54, 5
    s_cbranch_scc1 L_alt99
    s_waitcnt vmcnt(4)
L_go98:
    buffer_load_dwordx4 v[184:187], v3, s[8:11], s32 offen offset:2048 nt
    v_and_b32_dpp v40, v33, v8 row_newbcast:12 row_mask:0xf bank_mask:0xf
    v_and_b32_dpp v41, v33, v9 row_newbcast:12 row_mask:0xf bank_mask:0xf
    v_and_b32_dpp v42, v33, v10 row_newbcast:12 row_mask:0xf bank_mask:0xf
    v_and_b32_dpp v43, v33, v11 row_newbcast:12 row_mask:0xf bank_mask:0xf
    s_nop 1
    v_mfma_f32_16x16x32_bf16 v[16:19], v[40:43], v[188:191], v[16:19]
    s_cmp_lg_u32 s55, 5
    s_cbranch_scc1 L_alt101
    s_waitcnt vmcnt(4)
L_go100:
    buffer_load_dwordx4 v[188:191], v3, s[8:11], s32 offen offset:3072 nt
    s_add_u32 s32, s32, 32768
    s_waitcnt lgkmcnt(0)
    v_sub_f32 v30, v34, v28
    v_sub_f32 v31, v35, v28
    ds_read_b64 v[34:35], v117
    v_add_u32 v117, 512, v117
    v_mul_f32 v30, s46, v30
    v_mul_f32 v31, s46, v31
    v_exp_f32 v30, v30
    v_exp_f32 v31, v31
    v_cvt_pk_bf16_f32 v32, v30, v30
    v_cvt_pk_bf16_f32 v33, v31, v31
    v_add_f32 v29, v29, v30
    v_add_f32 v29, v29, v31
    v_and_b32_dpp v36, v32, v8 row_newbcast:0 row_mask:0xf bank_mask:0xf
    v_and_b32_dpp v37, v32, v9 row_newbcast:0 row_mask:0xf bank_mask:0xf
    v_and_b32_dpp v38, v32, v10 row_newbcast:0 row_mask:0xf bank_mask:0xf
    v_and_b32_dpp v39, v32, v11 row_newbcast:0 row_mask:0xf bank_mask:0xf
    s_nop 1
    v_mfma_f32_16x16x32_bf16 v[16:19], v[36:39], v[192:195], v[16:19]
    s_cmp_lg_u32 s52, 5
    s_cbranch_scc1 L_alt103
    s_waitcnt vmcnt(4)
L_go102:
    buffer_load_dwordx4 v[192:195], v2, s[8:11], s32 offen offset:0 nt
    v_and_b32_dpp v40, v32, v8 row_newbcast:4 row_mask:0xf bank_mask:0xf
    v_and_b32_dpp v41, v32, v9 row_newbcast:4 row_mask:0xf bank_mask:0xf
    v_and_b32_dpp v42, v32, v10 row_newbcast:4 row_mask:0xf bank_mask:0xf
    v_and_b32_dpp v43, v32, v11 row_newbcast:4 row_mask:0xf bank_mask:0xf
    s_nop 1
    v_mfma_f32_16x16x32_bf16 v[16:19], v[40:43], v[196:199], v[16:19]
    s_cmp_lg_u32 s53, 5
    s_cbranch_scc1 L_alt105
    s_waitcnt vmcnt(4)
L_go104:
    buffer_load_dwordx4 v[196:199], v2, s[8:11], s32 offen offset:1024 nt
    v_and_b32_dpp v36, v32, v8 row_newbcast:8 row_mask:0xf bank_mask:0xf
    v_and_b32_dpp v37, v32, v9 row_newbcast:8 row_mask:0xf bank_mask:0xf
    v_and_b32_dpp v38, v32, v10 row_newbcast:8 row_mask:0xf bank_mask:0xf
    v_and_b32_dpp v39, v32, v11 row_newbcast:8 row_mask:0xf bank_mask:0xf
    s_nop 1
    v_mfma_f32_16x16x32_bf16 v[16:19], v[36:39], v[200:203], v[16:19]
    s_cmp_lg_u32 s54, 5
    s_cbranch_scc1 L_alt107
    s_waitcnt vmcnt(4)
L_go106:
    buffer_load_dwordx4 v[200:203], v2, s[8:11], s32 offen offset:2048 nt
    v_and_b32_dpp v40, v32, v8 row_newbcast:12 row_mask:0xf bank_mask:0xf
    v_and_b32_dpp v41, v32, v9 row_newbcast:12 row_mask:0xf bank_mask:0xf
    v_and_b32_dpp v42, v32, v10 row_newbcast:12 row_mask:0xf bank_mask:0xf
    v_and_b32_dpp v43, v32, v11 row_newbcast:12 row_mask:0xf bank_mask:0xf
    s_nop 1
    v_mfma_f32_16x16x32_bf16 v[16:19], v[40:43], v[204:207], v[16:19]
    s_cmp_lg_u32 s55, 5
    s_cbranch_scc1 L_alt109
    s_waitcnt vmcnt(4)
L_go108:
    buffer_load_dwordx4 v[204:207], v2, s[8:11], s32 offen offset:3072 nt
    v_and_b32_dpp v36, v33, v8 row_newbcast:0 row_mask:0xf bank_mask:0xf
    v_and_b32_dpp v37, v33, v9 row_newbcast:0 row_mask:0xf bank_mask:0xf
    v_and_b32_dpp v38, v33, v10 row_newbcast:0 row_mask:0xf bank_mask:0xf
    v_and_b32_dpp v39, v33, v11 row_newbcast:0 row_mask:0xf bank_mask:0xf
    s_nop 1
    v_mfma_f32_16x16x32_bf16 v[16:19], v[36:39], v[208:211], v[16:19]
    s_cmp_lg_u32 s52, 5
    s_cbranch_scc1 L_alt111
    s_waitcnt vmcnt(4)
L_go110:
    buffer_load_dwordx4 v[208:211], v3, s[8:11], s32 offen offset:0 nt
    v_and_b32_dpp v40, v33, v8 row_newbcast:4 row_mask:0xf bank_mask:0xf
    v_and_b32_dpp v41, v33, v9 row_newbcast:4 row_mask:0xf bank_mask:0xf
    v_and_b32_dpp v42, v33, v10 row_newbcast:4 row_mask:0xf bank_mask:0xf
    v_and_b32_dpp v43, v33, v11 row_newbcast:4 row_mask:0xf bank_mask:0xf
    s_nop 1
    v_mfma_f32_16x16x32_bf16 v[16:19], v[40:43], v[212:215], v[16:19]
    s_cmp_lg_u32 s53, 5
    s_cbranch_scc1 L_alt113
    s_waitcnt vmcnt(4)
L_go112:
    buffer_load_dwordx4 v[212:215], v3, s[8:11], s32 offen offset:1024 nt
    v_and_b32_dpp v36, v33, v8 row_newbcast:8 row_mask:0xf bank_mask:0xf
    v_and_b32_dpp v37, v33, v9 row_newbcast:8 row_mask:0xf bank_mask:0xf
    v_and_b32_dpp v38, v33, v10 row_newbcast:8 row_mask:0xf bank_mask:0xf
    v_and_b32_dpp v39, v33, v11 row_newbcast:8 row_mask:0xf bank_mask:0xf
    s_nop 1
    v_mfma_f32_16x16x32_bf16 v[16:19], v[36:39], v[216:219], v[16:19]
    s_cmp_lg_u32 s54, 5
    s_cbranch_scc1 L_alt115
    s_waitcnt vmcnt(4)
L_go114:
    buffer_load_dwordx4 v[216:219], v3, s[8:11], s32 offen offset:2048 nt
    v_and_b32_dpp v40, v33, v8 row_newbcast:12 row_mask:0xf bank_mask:0xf
    v_and_b32_dpp v41, v33, v9 row_newbcast:12 row_mask:0xf bank_mask:0xf
    v_and_b32_dpp v42, v33, v10 row_newbcast:12 row_mask:0xf bank_mask:0xf
    v_and_b32_dpp v43, v33, v11 row_newbcast:12 row_mask:0xf bank_mask:0xf
    s_nop 1
    v_mfma_f32_16x16x32_bf16 v[16:19], v[40:43], v[220:223], v[16:19]
    s_cmp_lg_u32 s55, 5
    s_cbranch_scc1 L_alt117
    s_waitcnt vmcnt(4)
L_go116:
    buffer_load_dwordx4 v[220:223], v3, s[8:11], s32 offen offset:3072 nt
    s_add_u32 s32, s32, 32768
    s_waitcnt lgkmcnt(0)
    v_sub_f32 v30, v34, v28
    v_sub_f32 v31, v35, v28
    ds_read_b64 v[34:35], v117
    v_add_u32 v117, 512, v117
    v_mul_f32 v30, s46, v30
    v_mul_f32 v31, s46, v31
    v_exp_f32 v30, v30
    v_exp_f32 v31, v31
    v_cvt_pk_bf16_f32 v32, v30, v30
    v_cvt_pk_bf16_f32 v33, v31, v31
    v_add_f32 v29, v29, v30
    v_add_f32 v29, v29, v31
    v_and_b32_dpp v36, v32, v8 row_newbcast:0 row_mask:0xf bank_mask:0xf
    v_and_b32_dpp v37, v32, v9 row_newbcast:0 row_mask:0xf bank_mask:0xf
    v_and_b32_dpp v38, v32, v10 row_newbcast:0 row_mask:0xf bank_mask:0xf
    v_and_b32_dpp v39, v32, v11 row_newbcast:0 row_mask:0xf bank_mask:0xf
    s_nop 1
    v_mfma_f32_16x16x32_bf16 v[16:19], v[36:39], v[224:227], v[16:19]
    s_cmp_lg_u32 s52, 5
    s_cbranch_scc1 L_alt119
    s_waitcnt vmcnt(4)
L_go118:
    buffer_load_dwordx4 v[224:227], v2, s[8:11], s32 offen offset:0 nt
    v_and_b32_dpp v40, v32, v8 row_newbcast:4 row_mask:0xf bank_mask:0xf
    v_and_b32_dpp v41, v32, v9 row_newbcast:4 row_mask:0xf bank_mask:0xf
    v_and_b32_dpp v42, v32, v10 row_newbcast:4 row_mask:0xf bank_mask:0xf
    v_and_b32_dpp v43, v32, v11 row_newbcast:4 row_mask:0xf bank_mask:0xf
    s_nop 1
    v_mfma_f32_16x16x32_bf16 v[16:19], v[40:43], v[228:231], v[16:19]
    s_cmp_lg_u32 s53, 5
    s_cbranch_scc1 L_alt121
    s_waitcnt vmcnt(4)
L_go120:
    buffer_load_dwordx4 v[228:231], v2, s[8:11], s32 offen offset:1024 nt
    v_and_b32_dpp v36, v32, v8 row_newbcast:8 row_mask:0xf bank_mask:0xf
    v_and_b32_dpp v37, v32, v9 row_newbcast:8 row_mask:0xf bank_mask:0xf
    v_and_b32_dpp v38, v32, v10 row_newbcast:8 row_mask:0xf bank_mask:0xf
    v_and_b32_dpp v39, v32, v11 row_newbcast:8 row_mask:0xf bank_mask:0xf
    s_nop 1
    v_mfma_f32_16x16x32_bf16 v[16:19], v[36:39], v[232:235], v[16:19]
    s_cmp_lg_u32 s54, 5
    s_cbranch_scc1 L_alt123
    s_waitcnt vmcnt(4)
L_go122:
    buffer_load_dwordx4 v[232:235], v2, s[8:11], s32 offen offset:2048 nt
    v_and_b32_dpp v40, v32, v8 row_newbcast:12 row_mask:0xf bank_mask:0xf
    v_and_b32_dpp v41, v32, v9 row_newbcast:12 row_mask:0xf bank_mask:0xf
    v_and_b32_dpp v42, v32, v10 row_newbcast:12 row_mask:0xf bank_mask:0xf
    v_and_b32_dpp v43, v32, v11 row_newbcast:12 row_mask:0xf bank_mask:0xf
    s_nop 1
    v_mfma_f32_16x16x32_bf16 v[16:19], v[40:43], v[236:239], v[16:19]
    s_cmp_lg_u32 s55, 5
    s_cbranch_scc1 L_alt125
    s_waitcnt vmcnt(4)
L_go124:
    buffer_load_dwordx4 v[236:239], v2, s[8:11], s32 offen offset:3072 nt
    v_and_b32_dpp v36, v33, v8 row_newbcast:0 row_mask:0xf bank_mask:0xf
    v_and_b32_dpp v37, v33, v9 row_newbcast:0 row_mask:0xf bank_mask:0xf
    v_and_b32_dpp v38, v33, v10 row_newbcast:0 row_mask:0xf bank_mask:0xf
    v_and_b32_dpp v39, v33, v11 row_newbcast:0 row_mask:0xf bank_mask:0xf
    s_nop 1
    v_mfma_f32_16x16x32_bf16 v[16:19], v[36:39], v[240:243], v[16:19]
    s_cmp_lg_u32 s52, 5
    s_cbranch_scc1 L_alt127
    s_waitcnt vmcnt(4)
L_go126:
    buffer_load_dwordx4 v[240:243], v3, s[8:11], s32 offen offset:0 nt
    v_and_b32_dpp v40, v33, v8 row_newbcast:4 row_mask:0xf bank_mask:0xf
    v_and_b32_dpp v41, v33, v9 row_newbcast:4 row_mask:0xf bank_mask:0xf
    v_and_b32_dpp v42, v33, v10 row_newbcast:4 row_mask:0xf bank_mask:0xf
    v_and_b32_dpp v43, v33, v11 row_newbcast:4 row_mask:0xf bank_mask:0xf
    s_nop 1
    v_mfma_f32_16x16x32_bf16 v[16:19], v[40:43], v[244:247], v[16:19]
    s_cmp_lg_u32 s53, 5
    s_cbranch_scc1 L_alt129
    s_waitcnt vmcnt(4)
L_go128:
    buffer_load_dwordx4 v[244:247], v3, s[8:11], s32 offen offset:1024 nt
    v_and_b32_dpp v36, v33, v8 row_newbcast:8 row_mask:0xf bank_mask:0xf
    v_and_b32_dpp v37, v33, v9 row_newbcast:8 row_mask:0xf bank_mask:0xf
    v_and_b32_dpp v38, v33, v10 row_newbcast:8 row_mask:0xf bank_mask:0xf
    v_and_b32_dpp v39, v33, v11 row_newbcast:8 row_mask:0xf bank_mask:0xf
    s_nop 1
    v_mfma_f32_16x16x32_bf16 v[16:19], v[36:39], v[248:251], v[16:19]
    s_cmp_lg_u32 s54, 5
    s_cbranch_scc1 L_alt131
    s_waitcnt vmcnt(4)
L_go130:
    buffer_load_dwordx4 v[248:251], v3, s[8:11], s32 offen offset:2048 nt
    v_and_b32_dpp v40, v33, v8 row_newbcast:12 row_mask:0xf bank_mask:0xf
    v_and_b32_dpp v41, v33, v9 row_newbcast:12 row_mask:0xf bank_mask:0xf
    v_and_b32_dpp v42, v33, v10 row_newbcast:12 row_mask:0xf bank_mask:0xf
    v_and_b32_dpp v43, v33, v11 row_newbcast:12 row_mask:0xf bank_mask:0xf
    s_nop 1
    v_mfma_f32_16x16x32_bf16 v[16:19], v[40:43], v[252:255], v[16:19]
    s_cmp_lg_u32 s55, 5
    s_cbranch_scc1 L_alt133
    s_waitcnt vmcnt(4)
L_go132:
    buffer_load_dwordx4 v[252:255], v3, s[8:11], s32 offen offset:3072 nt
    s_add_u32 s32, s32, 32768
    s_sub_u32 s37, s37, 1
    s_cmp_lg_u32 s37, 0
    s_cbranch_scc1 L_v0
    s_mov_b32 s37, 1
.p2align 6
L_vend:
    s_waitcnt lgkmcnt(0)
    v_sub_f32 v30, v34, v28
    v_sub_f32 v31, v35, v28
    ds_read_b64 v[34:35], v117
    v_add_u32 v117, 512, v117
    v_mul_f32 v30, s46, v30
    v_mul_f32 v31, s46, v31
    v_exp_f32 v30, v30
    v_exp_f32 v31, v31
    v_cvt_pk_bf16_f32 v32, v30, v30
    v_cvt_pk_bf16_f32 v33, v31, v31
    v_add_f32 v29, v29, v30
    v_add_f32 v29, v29, v31
    v_and_b32_dpp v36, v32, v8 row_newbcast:0 row_mask:0xf bank_mask:0xf
    v_and_b32_dpp v37, v32, v9 row_newbcast:0 row_mask:0xf bank_mask:0xf
    v_and_b32_dpp v38, v32, v10 row_newbcast:0 row_mask:0xf bank_mask:0xf
    v_and_b32_dpp v39, v32, v11 row_newbcast:0 row_mask:0xf bank_mask:0xf
    s_waitcnt vmcnt(31)
    s_nop 0
    v_mfma_f32_16x16x32_bf16 v[16:19], v[36:39], v[128:131], v[16:19]
    s_waitcnt vmcnt(9)
    buffer_load_dwordx4 v[128:131], v2, s[8:11], s32 offen offset:0 nt
    v_and_b32_dpp v40, v32, v8 row_newbcast:4 row_mask:0xf bank_mask:0xf
    v_and_b32_dpp v41, v32, v9 row_newbcast:4 row_mask:0xf bank_mask:0xf
    v_and_b32_dpp v42, v32, v10 row_newbcast:4 row_mask:0xf bank_mask:0xf
    v_and_b32_dpp v43, v32, v11 row_newbcast:4 row_mask:0xf bank_mask:0xf
    s_waitcnt vmcnt(31)
    s_nop 0
    v_mfma_f32_16x16x32_bf16 v[16:19], v[40:43], v[132:135], v[16:19]
    s_waitcnt vmcnt(9)
    buffer_load_dwordx4 v[132:135], v2, s[8:11], s32 offen offset:1024 nt
    v_and_b32_dpp v36, v32, v8 row_newbcast:8 row_mask:0xf bank_mask:0xf
    v_and_b32_dpp v37, v32, v9 row_newbcast:8 row_mask:0xf bank_mask:0xf
    v_and_b32_dpp v38, v32, v10 row_newbcast:8 row_mask:0xf bank_mask:0xf
    v_and_b32_dpp v39, v32, v11 row_newbcast:8 row_mask:0xf bank_mask:0xf
    s_waitcnt vmcnt(31)
    s_nop 0
    v_mfma_f32_16x16x32_bf16 v[16:19], v[36:39], v[136:139], v[16:19]
    s_waitcnt vmcnt(9)
    buffer_load_dwordx4 v[136:139], v2, s[8:11], s32 offen offset:2048 nt
    v_and_b32_dpp v40, v32, v8 row_newbcast:12 row_mask:0xf bank_mask:0xf
    v_and_b32_dpp v41, v32, v9 row_newbcast:12 row_mask:0xf bank_mask:0xf
    v_and_b32_dpp v42, v32, v10 row_newbcast:12 row_mask:0xf bank_mask:0xf
    v_and_b32_dpp v43, v32, v11 row_newbcast:12 row_mask:0xf bank_mask:0xf
    s_waitcnt vmcnt(31)
    s_nop 0
    v_mfma_f32_16x16x32_bf16 v[16:19], v[40:43], v[140:143], v[16:19]
    s_waitcnt vmcnt(9)
    buffer_load_dwordx4 v[140:143], v2, s[8:11], s32 offen offset:3072 nt
    v_and_b32_dpp v36, v33, v8 row_newbcast:0 row_mask:0xf bank_mask:0xf
    v_and_b32_dpp v37, v33, v9 row_newbcast:0 row_mask:0xf bank_mask:0xf
    v_and_b32_dpp v38, v33, v10 row_newbcast:0 row_mask:0xf bank_mask:0xf
    v_and_b32_dpp v39, v33, v11 row_newbcast:0 row_mask:0xf bank_mask:0xf
    s_waitcnt vmcnt(31)
    s_nop 0
    v_mfma_f32_16x16x32_bf16 v[16:19], v[36:39], v[144:147], v[16:19]
    s_waitcnt vmcnt(9)
    buffer_load_dwordx4 v[144:147], v3, s[8:11], s32 offen offset:0 nt
    v_and_b32_dpp v40, v33, v8 row_newbcast:4 row_mask:0xf bank_mask:0xf
    v_and_b32_dpp v41, v33, v9 row_newbcast:4 row_mask:0xf bank_mask:0xf
    v_and_b32_dpp v42, v33, v10 row_newbcast:4 row_mask:0xf bank_mask:0xf
    v_and_b32_dpp v43, v33, v11 row_newbcast:4 row_mask:0xf bank_mask:0xf
    s_waitcnt vmcnt(31)
    s_nop 0
    v_mfma_f32_16x16x32_bf16 v[16:19], v[40:43], v[148:151], v[16:19]
    s_waitcnt vmcnt(9)
    buffer_load_dwordx4 v[148:151], v3, s[8:11], s32 offen offset:1024 nt
    v_and_b32_dpp v36, v33, v8 row_newbcast:8 row_mask:0xf bank_mask:0xf
    v_and_b32_dpp v37, v33, v9 row_newbcast:8 row_mask:0xf bank_mask:0xf
    v_and_b32_dpp v38, v33, v10 row_newbcast:8 row_mask:0xf bank_mask:0xf
    v_and_b32_dpp v39, v33, v11 row_newbcast:8 row_mask:0xf bank_mask:0xf
    s_waitcnt vmcnt(31)
    s_nop 0
    v_mfma_f32_16x16x32_bf16 v[16:19], v[36:39], v[152:155], v[16:19]
    s_waitcnt vmcnt(9)
    buffer_load_dwordx4 v[152:155], v3, s[8:11], s32 offen offset:2048 nt
    v_and_b32_dpp v40, v33, v8 row_newbcast:12 row_mask:0xf bank_mask:0xf
    v_and_b32_dpp v41, v33, v9 row_newbcast:12 row_mask:0xf bank_mask:0xf
    v_and_b32_dpp v42, v33, v10 row_newbcast:12 row_mask:0xf bank_mask:0xf
    v_and_b32_dpp v43, v33, v11 row_newbcast:12 row_mask:0xf bank_mask:0xf
    s_waitcnt vmcnt(31)
    s_nop 0
    v_mfma_f32_16x16x32_bf16 v[16:19], v[40:43], v[156:159], v[16:19]
    s_waitcnt vmcnt(9)
    buffer_load_dwordx4 v[156:159], v3, s[8:11], s32 offen offset:3072 nt
    s_add_u32 s32, s32, 32768
    s_waitcnt lgkmcnt(0)
    v_sub_f32 v30, v34, v28
    v_sub_f32 v31, v35, v28
    ds_read_b64 v[34:35], v117
    v_add_u32 v117, 512, v117
    v_mul_f32 v30, s46, v30
    v_mul_f32 v31, s46, v31
    v_exp_f32 v30, v30
    v_exp_f32 v31, v31
    v_cvt_pk_bf16_f32 v32, v30, v30
    v_cvt_pk_bf16_f32 v33, v31, v31
    v_add_f32 v29, v29, v30
    v_add_f32 v29, v29, v31
    v_and_b32_dpp v36, v32, v8 row_newbcast:0 row_mask:0xf bank_mask:0xf
    v_and_b32_dpp v37, v32, v9 row_newbcast:0 row_mask:0xf bank_mask:0xf
    v_and_b32_dpp v38, v32, v10 row_newbcast:0 row_mask:0xf bank_mask:0xf
    v_and_b32_dpp v39, v32, v11 row_newbcast:0 row_mask:0xf bank_mask:0xf
    s_waitcnt vmcnt(31)
    s_nop 0
    v_mfma_f32_16x16x32_bf16 v[16:19], v[36:39], v[160:163], v[16:19]
    s_waitcnt vmcnt(9)
    buffer_load_dwordx4 v[160:163], v2, s[8:11], s32 offen offset:0 nt
    v_and_b32_dpp v40, v32, v8 row_newbcast:4 row_mask:0xf bank_mask:0xf
    v_and_b32_dpp v41, v32, v9 row_newbcast:4 row_mask:0xf bank_mask:0xf
    v_and_b32_dpp v42, v32, v10 row_newbcast:4 row_mask:0xf bank_mask:0xf
    v_and_b32_dpp v43, v32, v11 row_newbcast:4 row_mask:0xf bank_mask:0xf
    s_waitcnt vmcnt(31)
    s_nop 0
    v_mfma_f32_16x16x32_bf16 v[16:19], v[40:43], v[164:167], v[16:19]
    s_waitcnt vmcnt(9)
    buffer_load_dwordx4 v[164:167], v2, s[8:11], s32 offen offset:1024 nt
    v_and_b32_dpp v36, v32, v8 row_newbcast:8 row_mask:0xf bank_mask:0xf
    v_and_b32_dpp v37, v32, v9 row_newbcast:8 row_mask:0xf bank_mask:0xf
    v_and_b32_dpp v38, v32, v10 row_newbcast:8 row_mask:0xf bank_mask:0xf
    v_and_b32_dpp v39, v32, v11 row_newbcast:8 row_mask:0xf bank_mask:0xf
    s_waitcnt vmcnt(31)
    s_nop 0
    v_mfma_f32_16x16x32_bf16 v[16:19], v[36:39], v[168:171], v[16:19]
    s_waitcnt vmcnt(9)
    buffer_load_dwordx4 v[168:171], v2, s[8:11], s32 offen offset:2048 nt
    v_and_b32_dpp v40, v32, v8 row_newbcast:12 row_mask:0xf bank_mask:0xf
    v_and_b32_dpp v41, v32, v9 row_newbcast:12 row_mask:0xf bank_mask:0xf
    v_and_b32_dpp v42, v32, v10 row_newbcast:12 row_mask:0xf bank_mask:0xf
    v_and_b32_dpp v43, v32, v11 row_newbcast:12 row_mask:0xf bank_mask:0xf
    s_waitcnt vmcnt(31)
    s_nop 0
    v_mfma_f32_16x16x32_bf16 v[16:19], v[40:43], v[172:175], v[16:19]
    s_waitcnt vmcnt(9)
    buffer_load_dwordx4 v[172:175], v2, s[8:11], s32 offen offset:3072 nt
    v_and_b32_dpp v36, v33, v8 row_newbcast:0 row_mask:0xf bank_mask:0xf
    v_and_b32_dpp v37, v33, v9 row_newbcast:0 row_mask:0xf bank_mask:0xf
    v_and_b32_dpp v38, v33, v10 row_newbcast:0 row_mask:0xf bank_mask:0xf
    v_and_b32_dpp v39, v33, v11 row_newbcast:0 row_mask:0xf bank_mask:0xf
    s_waitcnt vmcnt(31)
    s_nop 0
    v_mfma_f32_16x16x32_bf16 v[16:19], v[36:39], v[176:179], v[16:19]
    s_waitcnt vmcnt(9)
    buffer_load_dwordx4 v[176:179], v3, s[8:11], s32 offen offset:0 nt
    v_and_b32_dpp v40, v33, v8 row_newbcast:4 row_mask:0xf bank_mask:0xf
    v_and_b32_dpp v41, v33, v9 row_newbcast:4 row_mask:0xf bank_mask:0xf
    v_and_b32_dpp v42, v33, v10 row_newbcast:4 row_mask:0xf bank_mask:0xf
    v_and_b32_dpp v43, v33, v11 row_newbcast:4 row_mask:0xf bank_mask:0xf
    s_waitcnt vmcnt(31)
    s_nop 0
    v_mfma_f32_16x16x32_bf16 v[16:19], v[40:43], v[180:183], v[16:19]
    s_waitcnt vmcnt(9)
    buffer_load_dwordx4 v[180:183], v3, s[8:11], s32 offen offset:1024 nt
    v_and_b32_dpp v36, v33, v8 row_newbcast:8 row_mask:0xf bank_mask:0xf
    v_and_b32_dpp v37, v33, v9 row_newbcast:8 row_mask:0xf bank_mask:0xf
    v_and_b32_dpp v38, v33, v10 row_newbcast:8 row_mask:0xf bank_mask:0xf
    v_and_b32_dpp v39, v33, v11 row_newbcast:8 row_mask:0xf bank_mask:0xf
    s_waitcnt vmcnt(31)
    s_nop 0
    v_mfma_f32_16x16x32_bf16 v[16:19], v[36:39], v[184:187], v[16:19]
    s_waitcnt vmcnt(9)
    buffer_load_dwordx4 v[184:187], v3, s[8:11], s32 offen offset:2048 nt
    v_and_b32_dpp v40, v33, v8 row_newbcast:12 row_mask:0xf bank_mask:0xf
    v_and_b32_dpp v41, v33, v9 row_newbcast:12 row_mask:0xf bank_mask:0xf
    v_and_b32_dpp v42, v33, v10 row_newbcast:12 row_mask:0xf bank_mask:0xf
    v_and_b32_dpp v43, v33, v11 row_newbcast:12 row_mask:0xf bank_mask:0xf
    s_waitcnt vmcnt(31)
    s_nop 0
    v_mfma_f32_16x16x32_bf16 v[16:19], v[40:43], v[188:191], v[16:19]
    s_waitcnt vmcnt(9)
    buffer_load_dwordx4 v[188:191], v3, s[8:11], s32 offen offset:3072 nt
    s_add_u32 s32, s32, 32768
    s_waitcnt lgkmcnt(0)
    v_sub_f32 v30, v34, v28
    v_sub_f32 v31, v35, v28
    ds_read_b64 v[34:35], v117
    v_add_u32 v117, 512, v117
    v_mul_f32 v30, s46, v30
    v_mul_f32 v31, s46, v31
    v_exp_f32 v30, v30
    v_exp_f32 v31, v31
    v_cvt_pk_bf16_f32 v32, v30, v30
    v_cvt_pk_bf16_f32 v33, v31, v31
    v_add_f32 v29, v29, v30
    v_add_f32 v29, v29, v31
    v_and_b32_dpp v36, v32, v8 row_newbcast:0 row_mask:0xf bank_mask:0xf
    v_and_b32_dpp v37, v32, v9 row_newbcast:0 row_mask:0xf bank_mask:0xf
    v_and_b32_dpp v38, v32, v10 row_newbcast:0 row_mask:0xf bank_mask:0xf
    v_and_b32_dpp v39, v32, v11 row_newbcast:0 row_mask:0xf bank_mask:0xf
    s_waitcnt vmcnt(31)
    s_nop 0
    v_mfma_f32_16x16x32_bf16 v[16:19], v[36:39], v[192:195], v[16:19]
    s_waitcnt vmcnt(9)
    buffer_load_dwordx4 v[192:195], v2, s[8:11], s32 offen offset:0 nt
    v_and_b32_dpp v40, v32, v8 row_newbcast:4 row_mask:0xf bank_mask:0xf
    v_and_b32_dpp v41, v32, v9 row_newbcast:4 row_mask:0xf bank_mask:0xf
    v_and_b32_dpp v42, v32, v10 row_newbcast:4 row_mask:0xf bank_mask:0xf
    v_and_b32_dpp v43, v32, v11 row_newbcast:4 row_mask:0xf bank_mask:0xf
    s_waitcnt vmcnt(31)
    s_nop 0
    v_mfma_f32_16x16x32_bf16 v[16:19], v[40:43], v[196:199], v[16:19]
    s_waitcnt vmcnt(9)
    buffer_load_dwordx4 v[196:199], v2, s[8:11], s32 offen offset:1024 nt
    v_and_b32_dpp v36, v32, v8 row_newbcast:8 row_mask:0xf bank_mask:0xf
    v_and_b32_dpp v37, v32, v9 row_newbcast:8 row_mask:0xf bank_mask:0xf
    v_and_b32_dpp v38, v32, v10 row_newbcast:8 row_mask:0xf bank_mask:0xf
    v_and_b32_dpp v39, v32, v11 row_newbcast:8 row_mask:0xf bank_mask:0xf
    s_waitcnt vmcnt(31)
    s_nop 0
    v_mfma_f32_16x16x32_bf16 v[16:19], v[36:39], v[200:203], v[16:19]
    s_waitcnt vmcnt(9)
    buffer_load_dwordx4 v[200:203], v2, s[8:11], s32 offen offset:2048 nt
    v_and_b32_dpp v40, v32, v8 row_newbcast:12 row_mask:0xf bank_mask:0xf
    v_and_b32_dpp v41, v32, v9 row_newbcast:12 row_mask:0xf bank_mask:0xf
    v_and_b32_dpp v42, v32, v10 row_newbcast:12 row_mask:0xf bank_mask:0xf
    v_and_b32_dpp v43, v32, v11 row_newbcast:12 row_mask:0xf bank_mask:0xf
    s_waitcnt vmcnt(31)
    s_nop 0
    v_mfma_f32_16x16x32_bf16 v[16:19], v[40:43], v[204:207], v[16:19]
    s_waitcnt vmcnt(9)
    buffer_load_dwordx4 v[204:207], v2, s[8:11], s32 offen offset:3072 nt
    v_and_b32_dpp v36, v33, v8 row_newbcast:0 row_mask:0xf bank_mask:0xf
    v_and_b32_dpp v37, v33, v9 row_newbcast:0 row_mask:0xf bank_mask:0xf
    v_and_b32_dpp v38, v33, v10 row_newbcast:0 row_mask:0xf bank_mask:0xf
    v_and_b32_dpp v39, v33, v11 row_newbcast:0 row_mask:0xf bank_mask:0xf
    s_waitcnt vmcnt(31)
    s_nop 0
    v_mfma_f32_16x16x32_bf16 v[16:19], v[36:39], v[208:211], v[16:19]
    s_waitcnt vmcnt(9)
    buffer_load_dwordx4 v[208:211], v3, s[8:11], s32 offen offset:0 nt
    v_and_b32_dpp v40, v33, v8 row_newbcast:4 row_mask:0xf bank_mask:0xf
    v_and_b32_dpp v41, v33, v9 row_newbcast:4 row_mask:0xf bank_mask:0xf
    v_and_b32_dpp v42, v33, v10 row_newbcast:4 row_mask:0xf bank_mask:0xf
    v_and_b32_dpp v43, v33, v11 row_newbcast:4 row_mask:0xf bank_mask:0xf
    s_waitcnt vmcnt(31)
    s_nop 0
    v_mfma_f32_16x16x32_bf16 v[16:19], v[40:43], v[212:215], v[16:19]
    s_waitcnt vmcnt(9)
    buffer_load_dwordx4 v[212:215], v3, s[8:11], s32 offen offset:1024 nt
    v_and_b32_dpp v36, v33, v8 row_newbcast:8 row_mask:0xf bank_mask:0xf
    v_and_b32_dpp v37, v33, v9 row_newbcast:8 row_mask:0xf bank_mask:0xf
    v_and_b32_dpp v38, v33, v10 row_newbcast:8 row_mask:0xf bank_mask:0xf
    v_and_b32_dpp v39, v33, v11 row_newbcast:8 row_mask:0xf bank_mask:0xf
    s_waitcnt vmcnt(31)
    s_nop 0
    v_mfma_f32_16x16x32_bf16 v[16:19], v[36:39], v[216:219], v[16:19]
    s_waitcnt vmcnt(9)
    buffer_load_dwordx4 v[216:219], v3, s[8:11], s32 offen offset:2048 nt
    v_and_b32_dpp v40, v33, v8 row_newbcast:12 row_mask:0xf bank_mask:0xf
    v_and_b32_dpp v41, v33, v9 row_newbcast:12 row_mask:0xf bank_mask:0xf
    v_and_b32_dpp v42, v33, v10 row_newbcast:12 row_mask:0xf bank_mask:0xf
    v_and_b32_dpp v43, v33, v11 row_newbcast:12 row_mask:0xf bank_mask:0xf
    s_waitcnt vmcnt(31)
    s_nop 0
    v_mfma_f32_16x16x32_bf16 v[16:19], v[40:43], v[220:223], v[16:19]
    s_waitcnt vmcnt(9)
    buffer_load_dwordx4 v[220:223], v3, s[8:11], s32 offen offset:3072 nt
    s_add_u32 s32, s32, 32768
    s_waitcnt lgkmcnt(0)
    v_sub_f32 v30, v34, v28
    v_sub_f32 v31, v35, v28
    ds_read_b64 v[34:35], v117
    v_add_u32 v117, 512, v117
    v_mul_f32 v30, s46, v30
    v_mul_f32 v31, s46, v31
    v_exp_f32 v30, v30
    v_exp_f32 v31, v31
    v_cvt_pk_bf16_f32 v32, v30, v30
    v_cvt_pk_bf16_f32 v33, v31, v31
    v_add_f32 v29, v29, v30
    v_add_f32 v29, v29, v31
    v_and_b32_dpp v36, v32, v8 row_newbcast:0 row_mask:0xf bank_mask:0xf
    v_and_b32_dpp v37, v32, v9 row_newbcast:0 row_mask:0xf bank_mask:0xf
    v_and_b32_dpp v38, v32, v10 row_newbcast:0 row_mask:0xf bank_mask:0xf
    v_and_b32_dpp v39, v32, v11 row_newbcast:0 row_mask:0xf bank_mask:0xf
    s_waitcnt vmcnt(31)
    s_nop 0
    v_mfma_f32_16x16x32_bf16 v[16:19], v[36:39], v[224:227], v[16:19]
    s_waitcnt vmcnt(9)
    buffer_load_dwordx4 v[224:227], v2, s[8:11], s32 offen offset:0 nt
    v_and_b32_dpp v40, v32, v8 row_newbcast:4 row_mask:0xf bank_mask:0xf
    v_and_b32_dpp v41, v32, v9 row_newbcast:4 row_mask:0xf bank_mask:0xf
    v_and_b32_dpp v42, v32, v10 row_newbcast:4 row_mask:0xf bank_mask:0xf
    v_and_b32_dpp v43, v32, v11 row_newbcast:4 row_mask:0xf bank_mask:0xf
    s_waitcnt vmcnt(31)
    s_nop 0
    v_mfma_f32_16x16x32_bf16 v[16:19], v[40:43], v[228:231], v[16:19]
    s_waitcnt vmcnt(9)
    buffer_load_dwordx4 v[228:231], v2, s[8:11], s32 offen offset:1024 nt
    v_and_b32_dpp v36, v32, v8 row_newbcast:8 row_mask:0xf bank_mask:0xf
    v_and_b32_dpp v37, v32, v9 row_newbcast:8 row_mask:0xf bank_mask:0xf
    v_and_b32_dpp v38, v32, v10 row_newbcast:8 row_mask:0xf bank_mask:0xf
    v_and_b32_dpp v39, v32, v11 row_newbcast:8 row_mask:0xf bank_mask:0xf
    s_waitcnt vmcnt(31)
    s_nop 0
    v_mfma_f32_16x16x32_bf16 v[16:19], v[36:39], v[232:235], v[16:19]
    s_waitcnt vmcnt(9)
    buffer_load_dwordx4 v[232:235], v2, s[8:11], s32 offen offset:2048 nt
    v_and_b32_dpp v40, v32, v8 row_newbcast:12 row_mask:0xf bank_mask:0xf
    v_and_b32_dpp v41, v32, v9 row_newbcast:12 row_mask:0xf bank_mask:0xf
    v_and_b32_dpp v42, v32, v10 row_newbcast:12 row_mask:0xf bank_mask:0xf
    v_and_b32_dpp v43, v32, v11 row_newbcast:12 row_mask:0xf bank_mask:0xf
    s_waitcnt vmcnt(31)
    s_nop 0
    v_mfma_f32_16x16x32_bf16 v[16:19], v[40:43], v[236:239], v[16:19]
    s_waitcnt vmcnt(9)
    buffer_load_dwordx4 v[236:239], v2, s[8:11], s32 offen offset:3072 nt
    v_and_b32_dpp v36, v33, v8 row_newbcast:0 row_mask:0xf bank_mask:0xf
    v_and_b32_dpp v37, v33, v9 row_newbcast:0 row_mask:0xf bank_mask:0xf
    v_and_b32_dpp v38, v33, v10 row_newbcast:0 row_mask:0xf bank_mask:0xf
    v_and_b32_dpp v39, v33, v11 row_newbcast:0 row_mask:0xf bank_mask:0xf
    s_waitcnt vmcnt(31)
    s_nop 0
    v_mfma_f32_16x16x32_bf16 v[16:19], v[36:39], v[240:243], v[16:19]
    s_waitcnt vmcnt(9)
    buffer_load_dwordx4 v[240:243], v3, s[8:11], s32 offen offset:0 nt
    v_and_b32_dpp v40, v33, v8 row_newbcast:4 row_mask:0xf bank_mask:0xf
    v_and_b32_dpp v41, v33, v9 row_newbcast:4 row_mask:0xf bank_mask:0xf
    v_and_b32_dpp v42, v33, v10 row_newbcast:4 row_mask:0xf bank_mask:0xf
    v_and_b32_dpp v43, v33, v11 row_newbcast:4 row_mask:0xf bank_mask:0xf
    s_waitcnt vmcnt(31)
    s_nop 0
    v_mfma_f32_16x16x32_bf16 v[16:19], v[40:43], v[244:247], v[16:19]
    s_waitcnt vmcnt(9)
    buffer_load_dwordx4 v[244:247], v3, s[8:11], s32 offen offset:1024 nt
    v_and_b32_dpp v36, v33, v8 row_newbcast:8 row_mask:0xf bank_mask:0xf
    v_and_b32_dpp v37, v33, v9 row_newbcast:8 row_mask:0xf bank_mask:0xf
    v_and_b32_dpp v38, v33, v10 row_newbcast:8 row_mask:0xf bank_mask:0xf
    v_and_b32_dpp v39, v33, v11 row_newbcast:8 row_mask:0xf bank_mask:0xf
    s_waitcnt vmcnt(31)
    s_nop 0
    v_mfma_f32_16x16x32_bf16 v[16:19], v[36:39], v[248:251], v[16:19]
    s_waitcnt vmcnt(9)
    buffer_load_dwordx4 v[248:251], v3, s[8:11], s32 offen offset:2048 nt
    v_and_b32_dpp v40, v33, v8 row_newbcast:12 row_mask:0xf bank_mask:0xf
    v_and_b32_dpp v41, v33, v9 row_newbcast:12 row_mask:0xf bank_mask:0xf
    v_and_b32_dpp v42, v33, v10 row_newbcast:12 row_mask:0xf bank_mask:0xf
    v_and_b32_dpp v43, v33, v11 row_newbcast:12 row_mask:0xf bank_mask:0xf
    s_waitcnt vmcnt(31)
    s_nop 0
    v_mfma_f32_16x16x32_bf16 v[16:19], v[40:43], v[252:255], v[16:19]
    s_waitcnt vmcnt(9)
    buffer_load_dwordx4 v[252:255], v3, s[8:11], s32 offen offset:3072 nt
    s_add_u32 s32, s32, 32768
    s_sub_u32 s37, s37, 1
    s_cmp_lg_u32 s37, 0
    s_cbranch_scc1 L_vend
    s_waitcnt lgkmcnt(0)
    v_sub_f32 v30, v34, v28
    v_sub_f32 v31, v35, v28
    ds_read_b64 v[34:35], v117
    v_add_u32 v117, 512, v117
    v_mul_f32 v30, s46, v30
    v_mul_f32 v31, s46, v31
    v_exp_f32 v30, v30
    v_exp_f32 v31, v31
    v_cvt_pk_bf16_f32 v32, v30, v30
    v_cvt_pk_bf16_f32 v33, v31, v31
    v_add_f32 v29, v29, v30
    v_add_f32 v29, v29, v31
    v_and_b32_dpp v36, v32, v8 row_newbcast:0 row_mask:0xf bank_mask:0xf
    v_and_b32_dpp v37, v32, v9 row_newbcast:0 row_mask:0xf bank_mask:0xf
    v_and_b32_dpp v38, v32, v10 row_newbcast:0 row_mask:0xf bank_mask:0xf
    v_and_b32_dpp v39, v32, v11 row_newbcast:0 row_mask:0xf bank_mask:0xf
    s_waitcnt vmcnt(31)
    s_nop 0
    v_mfma_f32_16x16x32_bf16 v[16:19], v[36:39], v[128:131], v[16:19]
    v_and_b32_dpp v40, v32, v8 row_newbcast:4 row_mask:0xf bank_mask:0xf
    v_and_b32_dpp v41, v32, v9 row_newbcast:4 row_mask:0xf bank_mask:0xf
    v_and_b32_dpp v42, v32, v10 row_newbcast:4 row_mask:0xf bank_mask:0xf
    v_and_b32_dpp v43, v32, v11 row_newbcast:4 row_mask:0xf bank_mask:0xf
    s_waitcnt vmcnt(30)
    s_nop 0
    v_mfma_f32_16x16x32_bf16 v[16:19], v[40:43], v[132:135], v[16:19]
    v_and_b32_dpp v36, v32, v8 row_newbcast:8 row_mask:0xf bank_mask:0xf
    v_and_b32_dpp v37, v32, v9 row_newbcast:8 row_mask:0xf bank_mask:0xf
    v_and_b32_dpp v38, v32, v10 row_newbcast:8 row_mask:0xf bank_mask:0xf
    v_and_b32_dpp v39, v32, v11 row_newbcast:8 row_mask:0xf bank_mask:0xf
    s_waitcnt vmcnt(29)
    s_nop 0
    v_mfma_f32_16x16x32_bf16 v[16:19], v[36:39], v[136:139], v[16:19]
    v_and_b32_dpp v40, v32, v8 row_newbcast:12 row_mask:0xf bank_mask:0xf
    v_and_b32_dpp v41, v32, v9 row_newbcast:12 row_mask:0xf bank_mask:0xf
    v_and_b32_dpp v42, v32, v10 row_newbcast:12 row_mask:0xf bank_mask:0xf
    v_and_b32_dpp v43, v32, v11 row_newbcast:12 row_mask:0xf bank_mask:0xf
    s_waitcnt vmcnt(28)
    s_nop 0
    v_mfma_f32_16x16x32_bf16 v[16:19], v[40:43], v[140:143], v[16:19]
    v_and_b32_dpp v36, v33, v8 row_newbcast:0 row_mask:0xf bank_mask:0xf
    v_and_b32_dpp v37, v33, v9 row_newbcast:0 row_mask:0xf bank_mask:0xf
    v_and_b32_dpp v38, v33, v10 row_newbcast:0 row_mask:0xf bank_mask:0xf
    v_and_b32_dpp v39, v33, v11 row_newbcast:0 row_mask:0xf bank_mask:0xf
    s_waitcnt vmcnt(27)
    s_nop 0
    v_mfma_f32_16x16x32_bf16 v[16:19], v[36:39], v[144:147], v[16:19]
    v_and_b32_dpp v40, v33, v8 row_newbcast:4 row_mask:0xf bank_mask:0xf
    v_and_b32_dpp v41, v33, v9 row_newbcast:4 row_mask:0xf bank_mask:0xf
    v_and_b32_dpp v42, v33, v10 row_newbcast:4 row_mask:0xf bank_mask:0xf
    v_and_b32_dpp v43, v33, v11 row_newbcast:4 row_mask:0xf bank_mask:0xf
    s_waitcnt vmcnt(26)
    s_nop 0
    v_mfma_f32_16x16x32_bf16 v[16:19], v[40:43], v[148:151], v[16:19]
    v_and_b32_dpp v36, v33, v8 row_newbcast:8 row_mask:0xf bank_mask:0xf
    v_and_b32_dpp v37, v33, v9 row_newbcast:8 row_mask:0xf bank_mask:0xf
    v_and_b32_dpp v38, v33, v10 row_newbcast:8 row_mask:0xf bank_mask:0xf
    v_and_b32_dpp v39, v33, v11 row_newbcast:8 row_mask:0xf bank_mask:0xf
    s_waitcnt vmcnt(25)
    s_nop 0
    v_mfma_f32_16x16x32_bf16 v[16:19], v[36:39], v[152:155], v[16:19]
    v_and_b32_dpp v40, v33, v8 row_newbcast:12 row_mask:0xf bank_mask:0xf
    v_and_b32_dpp v41, v33, v9 row_newbcast:12 row_mask:0xf bank_mask:0xf
    v_and_b32_dpp v42, v33, v10 row_newbcast:12 row_mask:0xf bank_mask:0xf
    v_and_b32_dpp v43, v33, v11 row_newbcast:12 row_mask:0xf bank_mask:0xf
    s_waitcnt vmcnt(24)
    s_nop 0
    v_mfma_f32_16x16x32_bf16 v[16:19], v[40:43], v[156:159], v[16:19]
    s_waitcnt lgkmcnt(0)
    v_sub_f32 v30, v34, v28
    v_sub_f32 v31, v35, v28
    ds_read_b64 v[34:35], v117
    v_add_u32 v117, 512, v117
    v_mul_f32 v30, s46, v30
    v_mul_f32 v31, s46, v31
    v_exp_f32 v30, v30
    v_exp_f32 v31, v31
    v_cvt_pk_bf16_f32 v32, v30, v30
    v_cvt_pk_bf16_f32 v33, v31, v31
    v_add_f32 v29, v29, v30
    v_add_f32 v29, v29, v31
    v_and_b32_dpp v36, v32, v8 row_newbcast:0 row_mask:0xf bank_mask:0xf
    v_and_b32_dpp v37, v32, v9 row_newbcast:0 row_mask:0xf bank_mask:0xf
    v_and_b32_dpp v38, v32, v10 row_newbcast:0 row_mask:0xf bank_mask:0xf
    v_and_b32_dpp v39, v32, v11 row_newbcast:0 row_mask:0xf bank_mask:0xf
    s_waitcnt vmcnt(23)
    s_nop 0
    v_mfma_f32_16x16x32_bf16 v[16:19], v[36:39], v[160:163], v[16:19]
    v_and_b32_dpp v40, v32, v8 row_newbcast:4 row_mask:0xf bank_mask:0xf
    v_and_b32_dpp v41, v32, v9 row_newbcast:4 row_mask:0xf bank_mask:0xf
    v_and_b32_dpp v42, v32, v10 row_newbcast:4 row_mask:0xf bank_mask:0xf
    v_and_b32_dpp v43, v32, v11 row_newbcast:4 row_mask:0xf bank_mask:0xf
    s_waitcnt vmcnt(22)
    s_nop 0
    v_mfma_f32_16x16x32_bf16 v[16:19], v[40:43], v[164:167], v[16:19]
    v_and_b32_dpp v36, v32, v8 row_newbcast:8 row_mask:0xf bank_mask:0xf
    v_and_b32_dpp v37, v32, v9 row_newbcast:8 row_mask:0xf bank_mask:0xf
    v_and_b32_dpp v38, v32, v10 row_newbcast:8 row_mask:0xf bank_mask:0xf
    v_and_b32_dpp v39, v32, v11 row_newbcast:8 row_mask:0xf bank_mask:0xf
    s_waitcnt vmcnt(21)
    s_nop 0
    v_mfma_f32_16x16x32_bf16 v[16:19], v[36:39], v[168:171], v[16:19]
    v_and_b32_dpp v40, v32, v8 row_newbcast:12 row_mask:0xf bank_mask:0xf
    v_and_b32_dpp v41, v32, v9 row_newbcast:12 row_mask:0xf bank_mask:0xf
    v_and_b32_dpp v42, v32, v10 row_newbcast:12 row_mask:0xf bank_mask:0xf
    v_and_b32_dpp v43, v32, v11 row_newbcast:12 row_mask:0xf bank_mask:0xf
    s_waitcnt vmcnt(20)
    s_nop 0
    v_mfma_f32_16x16x32_bf16 v[16:19], v[40:43], v[172:175], v[16:19]
    v_and_b32_dpp v36, v33, v8 row_newbcast:0 row_mask:0xf bank_mask:0xf
    v_and_b32_dpp v37, v33, v9 row_newbcast:0 row_mask:0xf bank_mask:0xf
    v_and_b32_dpp v38, v33, v10 row_newbcast:0 row_mask:0xf bank_mask:0xf
    v_and_b32_dpp v39, v33, v11 row_newbcast:0 row_mask:0xf bank_mask:0xf
    s_waitcnt vmcnt(19)
    s_nop 0
    v_mfma_f32_16x16x32_bf16 v[16:19], v[36:39], v[176:179], v[16:19]
    v_and_b32_dpp v40, v33, v8 row_newbcast:4 row_mask:0xf bank_mask:0xf
    v_and_b32_dpp v41, v33, v9 row_newbcast:4 row_mask:0xf bank_mask:0xf
    v_and_b32_dpp v42, v33, v10 row_newbcast:4 row_mask:0xf bank_mask:0xf
    v_and_b32_dpp v43, v33, v11 row_newbcast:4 row_mask:0xf bank_mask:0xf
    s_waitcnt vmcnt(18)
    s_nop 0
    v_mfma_f32_16x16x32_bf16 v[16:19], v[40:43], v[180:183], v[16:19]
    v_and_b32_dpp v36, v33, v8 row_newbcast:8 row_mask:0xf bank_mask:0xf
    v_and_b32_dpp v37, v33, v9 row_newbcast:8 row_mask:0xf bank_mask:0xf
    v_and_b32_dpp v38, v33, v10 row_newbcast:8 row_mask:0xf bank_mask:0xf
    v_and_b32_dpp v39, v33, v11 row_newbcast:8 row_mask:0xf bank_mask:0xf
    s_waitcnt vmcnt(17)
    s_nop 0
    v_mfma_f32_16x16x32_bf16 v[16:19], v[36:39], v[184:187], v[16:19]
    v_and_b32_dpp v40, v33, v8 row_newbcast:12 row_mask:0xf bank_mask:0xf
    v_and_b32_dpp v41, v33, v9 row_newbcast:12 row_mask:0xf bank_mask:0xf
    v_and_b32_dpp v42, v33, v10 row_newbcast:12 row_mask:0xf bank_mask:0xf
    v_and_b32_dpp v43, v33, v11 row_newbcast:12 row_mask:0xf bank_mask:0xf
    s_waitcnt vmcnt(16)
    s_nop 0
    v_mfma_f32_16x16x32_bf16 v[16:19], v[40:43], v[188:191], v[16:19]
    s_waitcnt lgkmcnt(0)
    v_sub_f32 v30, v34, v28
    v_sub_f32 v31, v35, v28
    ds_read_b64 v[34:35], v117
    v_add_u32 v117, 512, v117
    v_mul_f32 v30, s46, v30
    v_mul_f32 v31, s46, v31
    v_exp_f32 v30, v30
    v_exp_f32 v31, v31
    v_cvt_pk_bf16_f32 v32, v30, v30
    v_cvt_pk_bf16_f32 v33, v31, v31
    v_add_f32 v29, v29, v30
    v_add_f32 v29, v29, v31
    v_and_b32_dpp v36, v32, v8 row_newbcast:0 row_mask:0xf bank_mask:0xf
    v_and_b32_dpp v37, v32, v9 row_newbcast:0 row_mask:0xf bank_mask:0xf
    v_and_b32_dpp v38, v32, v10 row_newbcast:0 row_mask:0xf bank_mask:0xf
    v_and_b32_dpp v39, v32, v11 row_newbcast:0 row_mask:0xf bank_mask:0xf
    s_waitcnt vmcnt(15)
    s_nop 0
    v_mfma_f32_16x16x32_bf16 v[16:19], v[36:39], v[192:195], v[16:19]
    v_and_b32_dpp v40, v32, v8 row_newbcast:4 row_mask:0xf bank_mask:0xf
    v_and_b32_dpp v41, v32, v9 row_newbcast:4 row_mask:0xf bank_mask:0xf
    v_and_b32_dpp v42, v32, v10 row_newbcast:4 row_mask:0xf bank_mask:0xf
    v_and_b32_dpp v43, v32, v11 row_newbcast:4 row_mask:0xf bank_mask:0xf
    s_waitcnt vmcnt(14)
    s_nop 0
    v_mfma_f32_16x16x32_bf16 v[16:19], v[40:43], v[196:199], v[16:19]
    v_and_b32_dpp v36, v32, v8 row_newbcast:8 row_mask:0xf bank_mask:0xf
    v_and_b32_dpp v37, v32, v9 row_newbcast:8 row_mask:0xf bank_mask:0xf
    v_and_b32_dpp v38, v32, v10 row_newbcast:8 row_mask:0xf bank_mask:0xf
    v_and_b32_dpp v39, v32, v11 row_newbcast:8 row_mask:0xf bank_mask:0xf
    s_waitcnt vmcnt(13)
    s_nop 0
    v_mfma_f32_16x16x32_bf16 v[16:19], v[36:39], v[200:203], v[16:19]
    v_and_b32_dpp v40, v32, v8 row_newbcast:12 row_mask:0xf bank_mask:0xf
    v_and_b32_dpp v41, v32, v9 row_newbcast:12 row_mask:0xf bank_mask:0xf
    v_and_b32_dpp v42, v32, v10 row_newbcast:12 row_mask:0xf bank_mask:0xf
    v_and_b32_dpp v43, v32, v11 row_newbcast:12 row_mask:0xf bank_mask:0xf
    s_waitcnt vmcnt(12)
    s_nop 0
    v_mfma_f32_16x16x32_bf16 v[16:19], v[40:43], v[204:207], v[16:19]
    v_and_b32_dpp v36, v33, v8 row_newbcast:0 row_mask:0xf bank_mask:0xf
    v_and_b32_dpp v37, v33, v9 row_newbcast:0 row_mask:0xf bank_mask:0xf
    v_and_b32_dpp v38, v33, v10 row_newbcast:0 row_mask:0xf bank_mask:0xf
    v_and_b32_dpp v39, v33, v11 row_newbcast:0 row_mask:0xf bank_mask:0xf
    s_waitcnt vmcnt(11)
    s_nop 0
    v_mfma_f32_16x16x32_bf16 v[16:19], v[36:39], v[208:211], v[16:19]
    v_and_b32_dpp v40, v33, v8 row_newbcast:4 row_mask:0xf bank_mask:0xf
    v_and_b32_dpp v41, v33, v9 row_newbcast:4 row_mask:0xf bank_mask:0xf
    v_and_b32_dpp v42, v33, v10 row_newbcast:4 row_mask:0xf bank_mask:0xf
    v_and_b32_dpp v43, v33, v11 row_newbcast:4 row_mask:0xf bank_mask:0xf
    s_waitcnt vmcnt(10)
    s_nop 0
    v_mfma_f32_16x16x32_bf16 v[16:19], v[40:43], v[212:215], v[16:19]
    v_and_b32_dpp v36, v33, v8 row_newbcast:8 row_mask:0xf bank_mask:0xf
    v_and_b32_dpp v37, v33, v9 row_newbcast:8 row_mask:0xf bank_mask:0xf
    v_and_b32_dpp v38, v33, v10 row_newbcast:8 row_mask:0xf bank_mask:0xf
    v_and_b32_dpp v39, v33, v11 row_newbcast:8 row_mask:0xf bank_mask:0xf
    s_waitcnt vmcnt(9)
    s_nop 0
    v_mfma_f32_16x16x32_bf16 v[16:19], v[36:39], v[216:219], v[16:19]
    v_and_b32_dpp v40, v33, v8 row_newbcast:12 row_mask:0xf bank_mask:0xf
    v_and_b32_dpp v41, v33, v9 row_newbcast:12 row_mask:0xf bank_mask:0xf
    v_and_b32_dpp v42, v33, v10 row_newbcast:12 row_mask:0xf bank_mask:0xf
    v_and_b32_dpp v43, v33, v11 row_newbcast:12 row_mask:0xf bank_mask:0xf
    s_waitcnt vmcnt(8)
    s_nop 0
    v_mfma_f32_16x16x32_bf16 v[16:19], v[40:43], v[220:223], v[16:19]
    s_waitcnt lgkmcnt(0)
    v_sub_f32 v30, v34, v28
    v_sub_f32 v31, v35, v28
    v_mul_f32 v30, s46, v30
    v_mul_f32 v31, s46, v31
    v_exp_f32 v30, v30
    v_exp_f32 v31, v31
    v_cvt_pk_bf16_f32 v32, v30, v30
    v_cvt_pk_bf16_f32 v33, v31, v31
    v_add_f32 v29, v29, v30
    v_add_f32 v29, v29, v31
    s_nop 1
    v_add_f32_dpp v29, v29, v29 row_half_mirror row_mask:0xf bank_mask:0xf
    s_nop 1
    v_add_f32_dpp v29, v29, v29 row_mirror row_mask:0xf bank_mask:0xf
    s_nop 1
    v_add_f32_dpp v29, v29, v29 row_bcast:15 row_mask:0xa bank_mask:0xf
    s_nop 1
    v_add_f32_dpp v29, v29, v29 row_bcast:31 row_mask:0xc bank_mask:0xf
    s_mov_b32 exec_lo, 0
    s_mov_b32 exec_hi, 0x80000000
    ds_write_b64 v4, v[28:29] offset:10240
    s_mov_b64 exec, -1
    v_and_b32_dpp v36, v32, v8 row_newbcast:0 row_mask:0xf bank_mask:0xf
    v_and_b32_dpp v37, v32, v9 row_newbcast:0 row_mask:0xf bank_mask:0xf
    v_and_b32_dpp v38, v32, v10 row_newbcast:0 row_mask:0xf bank_mask:0xf
    v_and_b32_dpp v39, v32, v11 row_newbcast:0 row_mask:0xf bank_mask:0xf
    s_waitcnt vmcnt(7)
    s_nop 0
    v_mfma_f32_16x16x32_bf16 v[16:19], v[36:39], v[224:227], v[16:19]
    v_and_b32_dpp v40, v32, v8 row_newbcast:4 row_mask:0xf bank_mask:0xf
    v_and_b32_dpp v41, v32, v9 row_newbcast:4 row_mask:0xf bank_mask:0xf
    v_and_b32_dpp v42, v32, v10 row_newbcast:4 row_mask:0xf bank_mask:0xf
    v_and_b32_dpp v43, v32, v11 row_newbcast:4 row_mask:0xf bank_mask:0xf
    s_waitcnt vmcnt(6)
    s_nop 0
    v_mfma_f32_16x16x32_bf16 v[16:19], v[40:43], v[228:231], v[16:19]
    v_and_b32_dpp v36, v32, v8 row_newbcast:8 row_mask:0xf bank_mask:0xf
    v_and_b32_dpp v37, v32, v9 row_newbcast:8 row_mask:0xf bank_mask:0xf
    v_and_b32_dpp v38, v32, v10 row_newbcast:8 row_mask:0xf bank_mask:0xf
    v_and_b32_dpp v39, v32, v11 row_newbcast:8 row_mask:0xf bank_mask:0xf
    s_waitcnt vmcnt(5)
    s_nop 0
    v_mfma_f32_16x16x32_bf16 v[16:19], v[36:39], v[232:235], v[16:19]
    v_and_b32_dpp v40, v32, v8 row_newbcast:12 row_mask:0xf bank_mask:0xf
    v_and_b32_dpp v41, v32, v9 row_newbcast:12 row_mask:0xf bank_mask:0xf
    v_and_b32_dpp v42, v32, v10 row_newbcast:12 row_mask:0xf bank_mask:0xf
    v_and_b32_dpp v43, v32, v11 row_newbcast:12 row_mask:0xf bank_mask:0xf
    s_waitcnt vmcnt(4)
    s_nop 0
    v_mfma_f32_16x16x32_bf16 v[16:19], v[40:43], v[236:239], v[16:19]
    v_and_b32_dpp v36, v33, v8 row_newbcast:0 row_mask:0xf bank_mask:0xf
    v_and_b32_dpp v37, v33, v9 row_newbcast:0 row_mask:0xf bank_mask:0xf
    v_and_b32_dpp v38, v33, v10 row_newbcast:0 row_mask:0xf bank_mask:0xf
    v_and_b32_dpp v39, v33, v11 row_newbcast:0 row_mask:0xf bank_mask:0xf
    s_waitcnt vmcnt(3)
    s_nop 0
    v_mfma_f32_16x16x32_bf16 v[16:19], v[36:39], v[240:243], v[16:19]
    v_and_b32_dpp v40, v33, v8 row_newbcast:4 row_mask:0xf bank_mask:0xf
    v_and_b32_dpp v41, v33, v9 row_newbcast:4 row_mask:0xf bank_mask:0xf
    v_and_b32_dpp v42, v33, v10 row_newbcast:4 row_mask:0xf bank_mask:0xf
    v_and_b32_dpp v43, v33, v11 row_newbcast:4 row_mask:0xf bank_mask:0xf
    s_waitcnt vmcnt(2)
    s_nop 0
    v_mfma_f32_16x16x32_bf16 v[16:19], v[40:43], v[244:247], v[16:19]
    v_and_b32_dpp v36, v33, v8 row_newbcast:8 row_mask:0xf bank_mask:0xf
    v_and_b32_dpp v37, v33, v9 row_newbcast:8 row_mask:0xf bank_mask:0xf
    v_and_b32_dpp v38, v33, v10 row_newbcast:8 row_mask:0xf bank_mask:0xf
    v_and_b32_dpp v39, v33, v11 row_newbcast:8 row_mask:0xf bank_mask:0xf
    s_waitcnt vmcnt(1)
    s_nop 0
    v_mfma_f32_16x16x32_bf16 v[16:19], v[36:39], v[248:251], v[16:19]
    v_and_b32_dpp v40, v33, v8 row_newbcast:12 row_mask:0xf bank_mask:0xf
    v_and_b32_dpp v41, v33, v9 row_newbcast:12 row_mask:0xf bank_mask:0xf
    v_and_b32_dpp v42, v33, v10 row_newbcast:12 row_mask:0xf bank_mask:0xf
    v_and_b32_dpp v43, v33, v11 row_newbcast:12 row_mask:0xf bank_mask:0xf
    s_waitcnt vmcnt(0)
    s_nop 0
    v_mfma_f32_16x16x32_bf16 v[16:19], v[40:43], v[252:255], v[16:19]
    s_mov_b32 exec_hi, 0
    s_nop 6
    ds_write_b128 v51, v[16:19] offset:8192
    s_mov_b64 exec, -1
    s_waitcnt lgkmcnt(0)
    s_barrier
    v_mov_b32 v84, 0
    ds_read_b128 v[72:75], v84 offset:10240
    ds_read_b128 v[76:79], v84 offset:10256
    ds_read_b32 v80, v107 offset:8192
    ds_read_b32 v81, v107 offset:8704
    ds_read_b32 v82, v107 offset:9216
    ds_read_b32 v83, v107 offset:9728
    s_waitcnt lgkmcnt(0)
    v_max3_f32 v84, v72, v74, v76
    v_max_f32 v84, v84, v78
    v_sub_f32 v72, v72, v84
    v_sub_f32 v74, v74, v84
    v_sub_f32 v76, v76, v84
    v_sub_f32 v78, v78, v84
    v_mul_f32 v72, s46, v72
    v_mul_f32 v74, s46, v74
    v_mul_f32 v76, s46, v76
    v_mul_f32 v78, s46, v78
    v_exp_f32 v72, v72
    v_exp_f32 v74, v74
    v_exp_f32 v76, v76
    v_exp_f32 v78, v78
    v_mul_f32 v84, v72, v73
    v_mul_f32 v85, v72, v80
    v_fmac_f32 v84, v74, v75
    v_fmac_f32 v85, v74, v81
    v_fmac_f32 v84, v76, v77
    v_fmac_f32 v85, v76, v82
    v_fmac_f32 v84, v78, v79
    v_fmac_f32 v85, v78, v83
    v_rcp_f32 v84, v84
    s_nop 0
    v_mul_f32 v85, v85, v84
    v_cvt_pk_bf16_f32 v50, v85, v85
    s_nop 1
    v_and_b32_dpp v36, v50, v8 row_newbcast:0 row_mask:0xf bank_mask:0xf
    v_and_b32_dpp v37, v50, v9 row_newbcast:0 row_mask:0xf bank_mask:0xf
    v_and_b32_dpp v38, v50, v10 row_newbcast:0 row_mask:0xf bank_mask:0xf
    v_and_b32_dpp v39, v50, v11 row_newbcast:0 row_mask:0xf bank_mask:0xf
    s_nop 1
    v_mfma_f32_16x16x32_bf16 v[52:55], v[36:39], a[0:3], v[52:55]
    v_and_b32_dpp v40, v50, v8 row_newbcast:1 row_mask:0xf bank_mask:0xf
    v_and_b32_dpp v41, v50, v9 row_newbcast:1 row_mask:0xf bank_mask:0xf
    v_mfma_f32_16x16x32_bf16 v[56:59], v[36:39], a[4:7], v[56:59]
    v_and_b32_dpp v42, v50, v10 row_newbcast:1 row_mask:0xf bank_mask:0xf
    v_and_b32_dpp v43, v50, v11 row_newbcast:1 row_mask:0xf bank_mask:0xf
    v_mfma_f32_16x16x32_bf16 v[60:63], v[36:39], a[8:11], v[60:63]
    v_mfma_f32_16x16x32_bf16 v[64:67], v[36:39], a[12:15], v[64:67]
    v_mfma_f32_16x16x32_bf16 v[68:71], v[36:39], a[16:19], v[68:71]
    v_mfma_f32_16x16x32_bf16 v[52:55], v[40:43], a[20:23], v[52:55]
    v_and_b32_dpp v36, v50, v8 row_newbcast:2 row_mask:0xf bank_mask:0xf
    v_and_b32_dpp v37, v50, v9 row_newbcast:2 row_mask:0xf bank_mask:0xf
    v_mfma_f32_16x16x32_bf16 v[56:59], v[40:43], a[24:27], v[56:59]
    v_and_b32_dpp v38, v50, v10 row_newbcast:2 row_mask:0xf bank_mask:0xf
    v_and_b32_dpp v39, v50, v11 row_newbcast:2 row_mask:0xf bank_mask:0xf
    v_mfma_f32_16x16x32_bf16 v[60:63], v[40:43], a[28:31], v[60:63]
    v_mfma_f32_16x16x32_bf16 v[64:67], v[40:43], a[32:35], v[64:67]
    v_mfma_f32_16x16x32_bf16 v[68:71], v[40:43], a[36:39], v[68:71]
    v_mfma_f32_16x16x32_bf16 v[52:55], v[36:39], a[40:43], v[52:55]
    v_and_b32_dpp v40, v50, v8 row_newbcast:3 row_mask:0xf bank_mask:0xf
    v_and_b32_dpp v41, v50, v9 row_newbcast:3 row_mask:0xf bank_mask:0xf
    v_mfma_f32_16x16x32_bf16 v[56:59], v[36:39], a[44:47], v[56:59]
    v_and_b32_dpp v42, v50, v10 row_newbcast:3 row_mask:0xf bank_mask:0xf
    v_and_b32_dpp v43, v50, v11 row_newbcast:3 row_mask:0xf bank_mask:0xf
    v_mfma_f32_16x16x32_bf16 v[60:63], v[36:39], a[48:51], v[60:63]
    v_mfma_f32_16x16x32_bf16 v[64:67], v[36:39], a[52:55], v[64:67]
    v_mfma_f32_16x16x32_bf16 v[68:71], v[36:39], a[56:59], v[68:71]
    v_mfma_f32_16x16x32_bf16 v[52:55], v[40:43], a[60:63], v[52:55]
    v_and_b32_dpp v36, v50, v8 row_newbcast:4 row_mask:0xf bank_mask:0xf
    v_and_b32_dpp v37, v50, v9 row_newbcast:4 row_mask:0xf bank_mask:0xf
    v_mfma_f32_16x16x32_bf16 v[56:59], v[40:43], a[64:67], v[56:59]
    v_and_b32_dpp v38, v50, v10 row_newbcast:4 row_mask:0xf bank_mask:0xf
    v_and_b32_dpp v39, v50, v11 row_newbcast:4 row_mask:0xf bank_mask:0xf
    v_mfma_f32_16x16x32_bf16 v[60:63], v[40:43], a[68:71], v[60:63]
    v_mfma_f32_16x16x32_bf16 v[64:67], v[40:43], a[72:75], v[64:67]
    v_mfma_f32_16x16x32_bf16 v[68:71], v[40:43], a[76:79], v[68:71]
    v_mfma_f32_16x16x32_bf16 v[52:55], v[36:39], a[80:83], v[52:55]
    v_and_b32_dpp v40, v50, v8 row_newbcast:5 row_mask:0xf bank_mask:0xf
    v_and_b32_dpp v41, v50, v9 row_newbcast:5 row_mask:0xf bank_mask:0xf
    v_mfma_f32_16x16x32_bf16 v[56:59], v[36:39], a[84:87], v[56:59]
    v_and_b32_dpp v42, v50, v10 row_newbcast:5 row_mask:0xf bank_mask:0xf
    v_and_b32_dpp v43, v50, v11 row_newbcast:5 row_mask:0xf bank_mask:0xf
    v_mfma_f32_16x16x32_bf16 v[60:63], v[36:39], a[88:91], v[60:63]
    v_mfma_f32_16x16x32_bf16 v[64:67], v[36:39], a[92:95], v[64:67]
    v_mfma_f32_16x16x32_bf16 v[68:71], v[36:39], a[96:99], v[68:71]
    v_mfma_f32_16x16x32_bf16 v[52:55], v[40:43], a[100:103], v[52:55]
    v_and_b32_dpp v36, v50, v8 row_newbcast:6 row_mask:0xf bank_mask:0xf
    v_and_b32_dpp v37, v50, v9 row_newbcast:6 row_mask:0xf bank_mask:0xf
    v_mfma_f32_16x16x32_bf16 v[56:59], v[40:43], a[104:107], v[56:59]
    v_and_b32_dpp v38, v50, v10 row_newbcast:6 row_mask:0xf bank_mask:0xf
    v_and_b32_dpp v39, v50, v11 row_newbcast:6 row_mask:0xf bank_mask:0xf
    v_mfma_f32_16x16x32_bf16 v[60:63], v[40:43], a[108:111], v[60:63]
    v_mfma_f32_16x16x32_bf16 v[64:67], v[40:43], a[112:115], v[64:67]
    v_mfma_f32_16x16x32_bf16 v[68:71], v[40:43], a[116:119], v[68:71]
    v_mfma_f32_16x16x32_bf16 v[52:55], v[36:39], a[120:123], v[52:55]
    v_and_b32_dpp v40, v50, v8 row_newbcast:7 row_mask:0xf bank_mask:0xf
    v_and_b32_dpp v41, v50, v9 row_newbcast:7 row_mask:0xf bank_mask:0xf
    v_mfma_f32_16x16x32_bf16 v[56:59], v[36:39], a[124:127], v[56:59]
    v_and_b32_dpp v42, v50, v10 row_newbcast:7 row_mask:0xf bank_mask:0xf
    v_and_b32_dpp v43, v50, v11 row_newbcast:7 row_mask:0xf bank_mask:0xf
    v_mfma_f32_16x16x32_bf16 v[60:63], v[36:39], a[128:131], v[60:63]
    v_mfma_f32_16x16x32_bf16 v[64:67], v[36:39], a[132:135], v[64:67]
    v_mfma_f32_16x16x32_bf16 v[68:71], v[36:39], a[136:139], v[68:71]
    v_mfma_f32_16x16x32_bf16 v[52:55], v[40:43], a[140:143], v[52:55]
    v_mfma_f32_16x16x32_bf16 v[56:59], v[40:43], a[144:147], v[56:59]
    v_mfma_f32_16x16x32_bf16 v[60:63], v[40:43], a[148:151], v[60:63]
    v_mfma_f32_16x16x32_bf16 v[64:67], v[40:43], a[152:155], v[64:67]
    v_mfma_f32_16x16x32_bf16 v[68:71], v[40:43], a[156:159], v[68:71]
    s_mov_b32 exec_hi, 0
    s_nop 2
    ds_write_b128 v108, v[52:55] offset:22528
    ds_write_b128 v108, v[56:59] offset:23040
    ds_write_b128 v108, v[60:63] offset:23552
    ds_write_b128 v108, v[64:67] offset:24064
    ds_write_b128 v108, v[68:71] offset:24576
    s_mov_b64 exec, -1
    s_waitcnt lgkmcnt(0)
    s_barrier
    v_cmp_gt_u32 vcc, 160, v0
    s_nop 0
    s_and_saveexec_b64 s[4:5], vcc
    s_cbranch_execz L_sk134
    v_lshlrev_b32 v88, 4, v0
    ds_read_b128 v[72:75], v88 offset:22528
    ds_read_b128 v[76:79], v88 offset:25088
    ds_read_b128 v[80:83], v88 offset:27648
    ds_read_b128 v[84:87], v88 offset:30208
    s_mul_i32 s3, s2, 5120
    s_waitcnt lgkmcnt(0)
    v_add_f32 v72, v72, v76
    v_add_f32 v73, v73, v77
    v_add_f32 v74, v74, v78
    v_add_f32 v75, v75, v79
    v_add_f32 v72, v72, v80
    v_add_f32 v73, v73, v81
    v_add_f32 v74, v74, v82
    v_add_f32 v75, v75, v83
    v_add_f32 v72, v72, v84
    v_add_f32 v73, v73, v85
    v_add_f32 v74, v74, v86
    v_add_f32 v75, v75, v87
    buffer_store_dwordx4 v[72:75], v88, s[48:51], s3 offen offset:2560
L_sk134:
    s_mov_b64 exec, -1
L_end:
    s_endpgm
L_alt5:
    s_waitcnt vmcnt(5)
    s_cmp_gt_u32 s52, 5
    s_cbranch_scc1 L_go4
    s_waitcnt vmcnt(3)
    s_branch L_go4
L_alt8:
    s_waitcnt vmcnt(6)
    s_cmp_gt_u32 s53, 5
    s_cbranch_scc1 L_go7
    s_waitcnt vmcnt(4)
    s_branch L_go7
L_alt10:
    s_waitcnt vmcnt(6)
    s_cmp_gt_u32 s54, 5
    s_cbranch_scc1 L_go9
    s_waitcnt vmcnt(4)
    s_branch L_go9
L_alt12:
    s_waitcnt vmcnt(6)
    s_cmp_gt_u32 s55, 5
    s_cbranch_scc1 L_go11
    s_waitcnt vmcnt(4)
    s_branch L_go11
L_alt14:
    s_waitcnt vmcnt(6)
    s_cmp_gt_u32 s52, 5
    s_cbranch_scc1 L_go13
    s_waitcnt vmcnt(4)
    s_branch L_go13
L_alt16:
    s_waitcnt vmcnt(6)
    s_cmp_gt_u32 s53, 5
    s_cbranch_scc1 L_go15
    s_waitcnt vmcnt(3)
    s_branch L_go15
L_alt18:
    s_waitcnt vmcnt(6)
    s_cmp_gt_u32 s54, 5
    s_cbranch_scc1 L_go17
    s_waitcnt vmcnt(3)
    s_branch L_go17
L_alt20:
    s_waitcnt vmcnt(5)
    s_cmp_gt_u32 s55, 5
    s_cbranch_scc1 L_go19
    s_waitcnt vmcnt(3)
    s_branch L_go19
L_alt22:
    s_waitcnt vmcnt(5)
    s_cmp_gt_u32 s52, 5
    s_cbranch_scc1 L_go21
    s_waitcnt vmcnt(3)
    s_branch L_go21
L_alt24:
    s_waitcnt vmcnt(5)
    s_cmp_gt_u32 s53, 5
    s_cbranch_scc1 L_go23
    s_waitcnt vmcnt(3)
    s_branch L_go23
L_alt26:
    s_waitcnt vmcnt(5)
    s_cmp_gt_u32 s54, 5
    s_cbranch_scc1 L_go25
    s_waitcnt vmcnt(3)
    s_branch L_go25
L_alt28:
    s_waitcnt vmcnt(5)
    s_cmp_gt_u32 s55, 5
    s_cbranch_scc1 L_go27
    s_waitcnt vmcnt(3)
    s_branch L_go27
L_alt30:
    s_waitcnt vmcnt(5)
    s_cmp_gt_u32 s52, 5
    s_cbranch_scc1 L_go29
    s_waitcnt vmcnt(3)
    s_branch L_go29
L_alt32:
    s_waitcnt vmcnt(5)
    s_cmp_gt_u32 s53, 5
    s_cbranch_scc1 L_go31
    s_waitcnt vmcnt(3)
    s_branch L_go31
L_alt34:
    s_waitcnt vmcnt(5)
    s_cmp_gt_u32 s54, 5
    s_cbranch_scc1 L_go33
    s_waitcnt vmcnt(3)
    s_branch L_go33
L_alt36:
    s_waitcnt vmcnt(5)
    s_cmp_gt_u32 s55, 5
    s_cbranch_scc1 L_go35
    s_waitcnt vmcnt(3)
    s_branch L_go35
L_alt38:
    s_waitcnt vmcnt(5)
    s_cmp_gt_u32 s52, 5
    s_cbranch_scc1 L_go37
    s_waitcnt vmcnt(3)
    s_branch L_go37
L_alt40:
    s_waitcnt vmcnt(5)
    s_cmp_gt_u32 s53, 5
    s_cbranch_scc1 L_go39
    s_waitcnt vmcnt(3)
    s_branch L_go39
L_alt42:
    s_waitcnt vmcnt(5)
    s_cmp_gt_u32 s54, 5
    s_cbranch_scc1 L_go41
    s_waitcnt vmcnt(3)
    s_branch L_go41
L_alt44:
    s_waitcnt vmcnt(5)
    s_cmp_gt_u32 s55, 5
    s_cbranch_scc1 L_go43
    s_waitcnt vmcnt(3)
    s_branch L_go43
L_alt46:
    s_waitcnt vmcnt(5)
    s_cmp_gt_u32 s52, 5
    s_cbranch_scc1 L_go45
    s_waitcnt vmcnt(3)
    s_branch L_go45
L_alt48:
    s_waitcnt vmcnt(5)
    s_cmp_gt_u32 s53, 5
    s_cbranch_scc1 L_go47
    s_waitcnt vmcnt(3)
    s_branch L_go47
L_alt50:
    s_waitcnt vmcnt(5)
    s_cmp_gt_u32 s54, 5
    s_cbranch_scc1 L_go49
    s_waitcnt vmcnt(3)
    s_branch L_go49
L_alt52:
    s_waitcnt vmcnt(5)
    s_cmp_gt_u32 s55, 5
    s_cbranch_scc1 L_go51
    s_waitcnt vmcnt(3)
    s_branch L_go51
L_alt54:
    s_waitcnt vmcnt(5)
    s_cmp_gt_u32 s52, 5
    s_cbranch_scc1 L_go53
    s_waitcnt vmcnt(3)
    s_branch L_go53
L_alt56:
    s_waitcnt vmcnt(5)
    s_cmp_gt_u32 s53, 5
    s_cbranch_scc1 L_go55
    s_waitcnt vmcnt(3)
    s_branch L_go55
L_alt58:
    s_waitcnt vmcnt(5)
    s_cmp_gt_u32 s54, 5
    s_cbranch_scc1 L_go57
    s_waitcnt vmcnt(3)
    s_branch L_go57
L_alt60:
    s_waitcnt vmcnt(5)
    s_cmp_gt_u32 s55, 5
    s_cbranch_scc1 L_go59
    s_waitcnt vmcnt(3)
    s_branch L_go59
L_alt62:
    s_waitcnt vmcnt(5)
    s_cmp_gt_u32 s52, 5
    s_cbranch_scc1 L_go61
    s_waitcnt vmcnt(3)
    s_branch L_go61
L_alt64:
    s_waitcnt vmcnt(5)
    s_cmp_gt_u32 s53, 5
    s_cbranch_scc1 L_go63
    s_waitcnt vmcnt(3)
    s_branch L_go63
L_alt66:
    s_waitcnt vmcnt(5)
    s_cmp_gt_u32 s54, 5
    s_cbranch_scc1 L_go65
    s_waitcnt vmcnt(3)
    s_branch L_go65
L_alt68:
    s_waitcnt vmcnt(5)
    s_cmp_gt_u32 s55, 5
    s_cbranch_scc1 L_go67
    s_waitcnt vmcnt(3)
    s_branch L_go67
L_alt70:
    s_waitcnt vmcnt(5)
    s_cmp_gt_u32 s52, 5
    s_cbranch_scc1 L_go69
    s_waitcnt vmcnt(3)
    s_branch L_go69
L_alt73:
    s_waitcnt vmcnt(6)
    s_cmp_gt_u32 s53, 5
    s_cbranch_scc1 L_go72
    s_waitcnt vmcnt(4)
    s_branch L_go72
L_alt75:
    s_waitcnt vmcnt(6)
    s_cmp_gt_u32 s54, 5
    s_cbranch_scc1 L_go74
    s_waitcnt vmcnt(4)
    s_branch L_go74
L_alt77:
    s_waitcnt vmcnt(6)
    s_cmp_gt_u32 s55, 5
    s_cbranch_scc1 L_go76
    s_waitcnt vmcnt(4)
    s_branch L_go76
L_alt79:
    s_waitcnt vmcnt(6)
    s_cmp_gt_u32 s52, 5
    s_cbranch_scc1 L_go78
    s_waitcnt vmcnt(4)
    s_branch L_go78
L_alt81:
    s_waitcnt vmcnt(6)
    s_cmp_gt_u32 s53, 5
    s_cbranch_scc1 L_go80
    s_waitcnt vmcnt(3)
    s_branch L_go80
L_alt83:
    s_waitcnt vmcnt(6)
    s_cmp_gt_u32 s54, 5
    s_cbranch_scc1 L_go82
    s_waitcnt vmcnt(3)
    s_branch L_go82
L_alt85:
    s_waitcnt vmcnt(5)
    s_cmp_gt_u32 s55, 5
    s_cbranch_scc1 L_go84
    s_waitcnt vmcnt(3)
    s_branch L_go84
L_alt87:
    s_waitcnt vmcnt(5)
    s_cmp_gt_u32 s52, 5
    s_cbranch_scc1 L_go86
    s_waitcnt vmcnt(3)
    s_branch L_go86
L_alt89:
    s_waitcnt vmcnt(5)
    s_cmp_gt_u32 s53, 5
    s_cbranch_scc1 L_go88
    s_waitcnt vmcnt(3)
    s_branch L_go88
L_alt91:
    s_waitcnt vmcnt(5)
    s_cmp_gt_u32 s54, 5
    s_cbranch_scc1 L_go90
    s_waitcnt vmcnt(3)
    s_branch L_go90
L_alt93:
    s_waitcnt vmcnt(5)
    s_cmp_gt_u32 s55, 5
    s_cbranch_scc1 L_go92
    s_waitcnt vmcnt(3)
    s_branch L_go92
L_alt95:
    s_waitcnt vmcnt(5)
    s_cmp_gt_u32 s52, 5
    s_cbranch_scc1 L_go94
    s_waitcnt vmcnt(3)
    s_branch L_go94
L_alt97:
    s_waitcnt vmcnt(5)
    s_cmp_gt_u32 s53, 5
    s_cbranch_scc1 L_go96
    s_waitcnt vmcnt(3)
    s_branch L_go96
L_alt99:
    s_waitcnt vmcnt(5)
    s_cmp_gt_u32 s54, 5
    s_cbranch_scc1 L_go98
    s_waitcnt vmcnt(3)
    s_branch L_go98
L_alt101:
    s_waitcnt vmcnt(5)
    s_cmp_gt_u32 s55, 5
    s_cbranch_scc1 L_go100
    s_waitcnt vmcnt(3)
    s_branch L_go100
L_alt103:
    s_waitcnt vmcnt(5)
    s_cmp_gt_u32 s52, 5
    s_cbranch_scc1 L_go102
    s_waitcnt vmcnt(3)
    s_branch L_go102
L_alt105:
    s_waitcnt vmcnt(5)
    s_cmp_gt_u32 s53, 5
    s_cbranch_scc1 L_go104
    s_waitcnt vmcnt(3)
    s_branch L_go104
L_alt107:
    s_waitcnt vmcnt(5)
    s_cmp_gt_u32 s54, 5
    s_cbranch_scc1 L_go106
    s_waitcnt vmcnt(3)
    s_branch L_go106
L_alt109:
    s_waitcnt vmcnt(5)
    s_cmp_gt_u32 s55, 5
    s_cbranch_scc1 L_go108
    s_waitcnt vmcnt(3)
    s_branch L_go108
L_alt111:
    s_waitcnt vmcnt(5)
    s_cmp_gt_u32 s52, 5
    s_cbranch_scc1 L_go110
    s_waitcnt vmcnt(3)
    s_branch L_go110
L_alt113:
    s_waitcnt vmcnt(5)
    s_cmp_gt_u32 s53, 5
    s_cbranch_scc1 L_go112
    s_waitcnt vmcnt(3)
    s_branch L_go112
L_alt115:
    s_waitcnt vmcnt(5)
    s_cmp_gt_u32 s54, 5
    s_cbranch_scc1 L_go114
    s_waitcnt vmcnt(3)
    s_branch L_go114
L_alt117:
    s_waitcnt vmcnt(5)
    s_cmp_gt_u32 s55, 5
    s_cbranch_scc1 L_go116
    s_waitcnt vmcnt(3)
    s_branch L_go116
L_alt119:
    s_waitcnt vmcnt(5)
    s_cmp_gt_u32 s52, 5
    s_cbranch_scc1 L_go118
    s_waitcnt vmcnt(3)
    s_branch L_go118
L_alt121:
    s_waitcnt vmcnt(5)
    s_cmp_gt_u32 s53, 5
    s_cbranch_scc1 L_go120
    s_waitcnt vmcnt(3)
    s_branch L_go120
L_alt123:
    s_waitcnt vmcnt(5)
    s_cmp_gt_u32 s54, 5
    s_cbranch_scc1 L_go122
    s_waitcnt vmcnt(3)
    s_branch L_go122
L_alt125:
    s_waitcnt vmcnt(5)
    s_cmp_gt_u32 s55, 5
    s_cbranch_scc1 L_go124
    s_waitcnt vmcnt(3)
    s_branch L_go124
L_alt127:
    s_waitcnt vmcnt(5)
    s_cmp_gt_u32 s52, 5
    s_cbranch_scc1 L_go126
    s_waitcnt vmcnt(3)
    s_branch L_go126
L_alt129:
    s_waitcnt vmcnt(5)
    s_cmp_gt_u32 s53, 5
    s_cbranch_scc1 L_go128
    s_waitcnt vmcnt(3)
    s_branch L_go128
L_alt131:
    s_waitcnt vmcnt(5)
    s_cmp_gt_u32 s54, 5
    s_cbranch_scc1 L_go130
    s_waitcnt vmcnt(3)
    s_branch L_go130
L_alt133:
    s_waitcnt vmcnt(5)
    s_cmp_gt_u32 s55, 5
    s_cbranch_scc1 L_go132
    s_waitcnt vmcnt(3)
    s_branch L_go132
.p2align 8
.globl reduce_kernel
.type reduce_kernel,@function
reduce_kernel:
    s_cmp_ge_u32 s2, 160
    s_cbranch_scc1 L_rend
    s_load_dwordx2 s[4:5], s[0:1], 96
    s_load_dwordx2 s[8:9], s[0:1], 80
    s_lshl_b32 s3, s2, 4
    v_and_b32 v1, 15, v0
    v_add_u32 v5, s3, v1
    s_mul_i32 s12, s2, 3277
    s_lshr_b32 s12, s12, 16
    s_mul_i32 s14, s12, 20
    s_sub_u32 s14, s2, s14
    s_mul_i32 s13, s12, 163840
    s_lshl_b32 s14, s14, 8
    s_add_u32 s13, s13, s14
    v_lshrrev_b32 v2, 4, v0
    v_mul_u32_u24 v3, 40960, v2
    v_lshl_add_u32 v3, v1, 4, v3
    v_lshlrev_b32 v4, 3, v5
    s_mov_b32 s6, 1310720
    s_mov_b32 s7, 0x20000
    s_mov_b32 s10, 20480
    s_mov_b32 s11, 0x20000
    s_waitcnt lgkmcnt(0)
    buffer_load_dwordx4 v[8:11], v3, s[4:7], s13 offen
    s_add_u32 s13, s13, 5120
    buffer_load_dwordx4 v[12:15], v3, s[4:7], s13 offen
    s_add_u32 s13, s13, 5120
    buffer_load_dwordx4 v[16:19], v3, s[4:7], s13 offen
    s_add_u32 s13, s13, 5120
    buffer_load_dwordx4 v[20:23], v3, s[4:7], s13 offen
    s_add_u32 s13, s13, 5120
    buffer_load_dwordx4 v[24:27], v3, s[4:7], s13 offen
    s_add_u32 s13, s13, 5120
    buffer_load_dwordx4 v[28:31], v3, s[4:7], s13 offen
    s_add_u32 s13, s13, 5120
    buffer_load_dwordx4 v[32:35], v3, s[4:7], s13 offen
    s_add_u32 s13, s13, 5120
    buffer_load_dwordx4 v[36:39], v3, s[4:7], s13 offen
    s_add_u32 s13, s13, 5120
    s_waitcnt vmcnt(6)
    v_add_f32 v8, v8, v12
    v_add_f32 v9, v9, v13
    v_add_f32 v10, v10, v14
    v_add_f32 v11, v11, v15
    s_waitcnt vmcnt(5)
    v_add_f32 v8, v8, v16
    v_add_f32 v9, v9, v17
    v_add_f32 v10, v10, v18
    v_add_f32 v11, v11, v19
    s_waitcnt vmcnt(4)
    v_add_f32 v8, v8, v20
    v_add_f32 v9, v9, v21
    v_add_f32 v10, v10, v22
    v_add_f32 v11, v11, v23
    s_waitcnt vmcnt(3)
    v_add_f32 v8, v8, v24
    v_add_f32 v9, v9, v25
    v_add_f32 v10, v10, v26
    v_add_f32 v11, v11, v27
    s_waitcnt vmcnt(2)
    v_add_f32 v8, v8, v28
    v_add_f32 v9, v9, v29
    v_add_f32 v10, v10, v30
    v_add_f32 v11, v11, v31
    s_waitcnt vmcnt(1)
    v_add_f32 v8, v8, v32
    v_add_f32 v9, v9, v33
    v_add_f32 v10, v10, v34
    v_add_f32 v11, v11, v35
    s_waitcnt vmcnt(0)
    v_add_f32 v8, v8, v36
    v_add_f32 v9, v9, v37
    v_add_f32 v10, v10, v38
    v_add_f32 v11, v11, v39
    v_mov_b32 v12, v8
    v_mov_b32 v13, v9
    v_mov_b32 v14, v10
    v_mov_b32 v15, v11
    v_permlane32_swap_b32 v12, v8
    v_permlane32_swap_b32 v13, v9
    v_permlane32_swap_b32 v14, v10
    v_permlane32_swap_b32 v15, v11
    v_add_f32 v8, v8, v12
    v_add_f32 v9, v9, v13
    v_add_f32 v10, v10, v14
    v_add_f32 v11, v11, v15
    v_mov_b32 v12, v8
    v_mov_b32 v13, v9
    v_mov_b32 v14, v10
    v_mov_b32 v15, v11
    v_permlane16_swap_b32 v12, v8
    v_permlane16_swap_b32 v13, v9
    v_permlane16_swap_b32 v14, v10
    v_permlane16_swap_b32 v15, v11
    v_add_f32 v8, v8, v12
    v_add_f32 v9, v9, v13
    v_add_f32 v10, v10, v14
    v_add_f32 v11, v11, v15
    v_cvt_pk_bf16_f32 v8, v8, v9
    v_cvt_pk_bf16_f32 v9, v10, v11
    s_mov_b64 exec, 0xffff
    buffer_store_dwordx2 v[8:9], v4, s[8:11], 0 offen
L_rend:
    s_endpgm
.section .rodata,"a"
.p2align 6
.amdhsa_kernel concat_heads__sliding_block_cached__mha_block_cached__decode_kernel
  .amdhsa_next_free_vgpr 512
  .amdhsa_next_free_sgpr 100
  .amdhsa_accum_offset 256
  .amdhsa_group_segment_fixed_size 0
  .amdhsa_kernarg_size 104
  .amdhsa_user_sgpr_count 2
  .amdhsa_user_sgpr_kernarg_segment_ptr 1
  .amdhsa_system_sgpr_workgroup_id_x 1
.end_amdhsa_kernel
.section .rodata,"a"
.p2align 6
.amdhsa_kernel reduce_kernel
  .amdhsa_next_free_vgpr 40
  .amdhsa_next_free_sgpr 24
  .amdhsa_accum_offset 40
  .amdhsa_group_segment_fixed_size 0
  .amdhsa_kernarg_size 104
  .amdhsa_user_sgpr_count 2
  .amdhsa_user_sgpr_kernarg_segment_ptr 1
  .amdhsa_system_sgpr_workgroup_id_x 1
.end_amdhsa_kernel
```
